```python
import torch

def _softmax(x, axis=-1):
    return torch.softmax(x, dim=axis)
def _gelu(x):
    return torch.nn.functional.gelu(x, approximate="tanh")
def _silu(x):
    return torch.nn.functional.silu(x)
def _sigmoid(x):
    return torch.sigmoid(x)
def _layernorm(x, axis=-1, eps=1e-5):
    m = x.mean(dim=axis, keepdim=True)
    v = x.var(dim=axis, keepdim=True, unbiased=False)
    return (x - m) / torch.sqrt(v + eps)
def _scatter_add(tgt, idx, src, axis=0):
    return tgt.clone().index_add_(axis, idx, src)
def _segment_sum(src, seg, n):
    out = torch.zeros((n,) + src.shape[1:], dtype=src.dtype)
    return out.index_add_(0, seg, src)
def _pad(x, pw):
    flat = tuple(v for pair in reversed(pw) for v in pair)
    return torch.nn.functional.pad(x, flat)

kernel_name = 'sequential_preLN__grouped_kv_mqa__glu_gated_geglu__prompt'

def setup_inputs():

    _w = (lambda a: (lambda t: t.to(torch.bfloat16) if t.is_floating_point() else t)(torch.as_tensor(a)))
    def _A_setup():
        B, S, D, H = 1, 2048, 640, 32
        Dh = D // H
        return {
            "x": _w((lambda *s: torch.randn(*s, dtype=torch.bfloat16) * 0.05)(B, S, D)),
            "wq": _w((lambda *s: torch.randn(*s, dtype=torch.bfloat16) * 0.05)(D, H * Dh)),
            "wk": _w((lambda *s: torch.randn(*s, dtype=torch.bfloat16) * 0.05)(D, Dh)),
            "wv": _w((lambda *s: torch.randn(*s, dtype=torch.bfloat16) * 0.05)(D, Dh)),
            "wo": _w((lambda *s: torch.randn(*s, dtype=torch.bfloat16) * 0.05)(H * Dh, D)),
        }
    _A_in = _A_setup()

    def _B_setup():
        B, S, Dm, Df = 1, 2048, 640, 1536
        return {
            "x": _w((lambda *s: torch.randn(*s, dtype=torch.bfloat16) * 0.05)(B, S, Dm)),
            "w_gate": _w((lambda *s: torch.randn(*s, dtype=torch.bfloat16) * 0.8)(Dm, Df) * (Dm ** -0.5)),
            "w_up": _w((lambda *s: torch.randn(*s, dtype=torch.bfloat16) * 0.8)(Dm, Df) * (Dm ** -0.5)),
            "w_down": _w((lambda *s: torch.randn(*s, dtype=torch.bfloat16) * 0.8)(Df, Dm) * (Df ** -0.5)),
        }
    _B_in = _B_setup()

    return {
        "A_x": _A_in["x"],
        "A_wq": _A_in["wq"],
        "A_wk": _A_in["wk"],
        "A_wv": _A_in["wv"],
        "A_wo": _A_in["wo"],
        "B_x": _B_in["x"],
        "B_w_gate": _B_in["w_gate"],
        "B_w_up": _B_in["w_up"],
        "B_w_down": _B_in["w_down"],
    }

def reference(A_x, A_wq, A_wk, A_wv, A_wo, B_x, B_w_gate, B_w_up, B_w_down):
    def _A_ref(x, wq, wk, wv, wo):
        B, S, D = x.shape
        H = 32
        Dh = D // H
        q = (lambda x, *d: x.permute(*d))((x @ wq).reshape(B, S, H, Dh), 0, 2, 1, 3)
        k = x @ wk
        v = x @ wv
        scores = torch.einsum("bhqd,bkd->bhqk", q, k) * (Dh ** -0.5)
        p = _softmax(scores, axis=-1)
        o = torch.einsum("bhqk,bkd->bhqd", p, v)
        return (lambda x, *d: x.permute(*d))(o, 0, 2, 1, 3).reshape(B, S, H * Dh) @ wo

    def _B_ref(x, w_gate, w_up, w_down):
        g = torch.einsum("bsd,df->bsf", x, w_gate)
        u = torch.einsum("bsd,df->bsf", x, w_up)
        h = _gelu(g) * u
        return torch.einsum("bsf,fd->bsd", h, w_down)

    x = A_x
    h = x + _A_ref(_layernorm(x, axis=-1), A_wq, A_wk, A_wv, A_wo)
    h2 = h + _B_ref(_layernorm(h, axis=-1), B_w_gate, B_w_up, B_w_down)
    return h2
```

```asm
; @launch grid=(256,1,1) block=(512,1,1) lds=163840
.amdgcn_target "amdgcn-amd-amdhsa--gfx950"
.text
.globl sequential_preLN__grouped_kv_mqa__glu_gated_geglu__prompt_kernel
.p2align 8
.type sequential_preLN__grouped_kv_mqa__glu_gated_geglu__prompt_kernel,@function
sequential_preLN__grouped_kv_mqa__glu_gated_geglu__prompt_kernel:
    s_cmp_ge_u32 s2, 256
    s_cbranch_scc1 L_end
    s_load_dwordx16 s[8:23], s[0:1], 0
    s_load_dwordx8 s[24:31], s[0:1], 64
    s_getpc_b64 s[86:87]
L_pc:
    s_lshr_b32 s70, s2, 3
    v_lshrrev_b32 v1, 6, v0
    s_lshl_b32 s83, s70, 4
    v_add_u32 v5, s83, v0
    v_lshlrev_b32 v5, 7, v5
    v_readfirstlane_b32 s68, v1
    v_min_u32 v5, L_end-L_pc, v5
    s_cmp_lg_u32 s68, 0
    s_cbranch_scc1 L_p0
    s_mov_b64 exec, 0xffff
    global_load_dword v255, v5, s[86:87]
    s_mov_b64 exec, -1
L_p0:
    v_and_b32 v0, 63, v0
    s_and_b32 s69, s2, 7
    s_lshr_b32 s71, s70, 3
    s_and_b32 s72, s70, 7
    s_lshl2_add_u32 s73, s69, s71
    s_lshr_b32 s77, s68, 2
    s_add_u32 s78, s68, s77
    s_and_b32 s78, s78, 3
    s_sub_u32 s79, s78, s72
    s_and_b32 s79, s79, 3
    v_and_b32 v1, 15, v0
    v_lshrrev_b32 v2, 4, v0
    v_lshlrev_b32 v3, 4, v0
    s_mul_i32 s80, s77, 3
    s_add_u32 s80, s80, s79
    s_sub_u32 s80, s80, 1
    s_cmp_eq_u32 s79, 0
    s_cselect_b32 s79, 7, s80
    s_lshl2_add_u32 s81, s73, s78
    s_xor_b32 s75, s77, s71
    s_and_b32 s75, s75, 1
    s_lshl_b32 s81, s81, 5
    s_add_u32 s81, s81, s75
    s_mulk_i32 s81, 640
    s_add_u32 s85, s81, 10240
    v_lshrrev_b32 v4, 3, v0
    v_xor_b32 v6, v0, v2
    v_and_b32 v6, 7, v6
    v_mul_u32_u24 v4, 1280, v4
    v_lshl_add_u32 v240, v6, 4, v4
    s_add_u32 s80, s77, 6
    s_min_u32 s82, s80, s79
    s_mulk_i32 s82, 10304
    s_add_u32 s82, s82, 51200
    v_mov_b32 v7, 0
    v_mov_b32 v15, 163728
    ds_write2_b32 v15, v7, v7 offset0:1 offset1:3
    s_mov_b32 s34, 2621440
    s_mov_b32 s35, 0x20000
    s_cmp_eq_u32 s79, 7
    s_waitcnt lgkmcnt(0)
    s_barrier
    s_mov_b32 s32, s8
    s_mov_b32 s33, s9
    s_cbranch_scc0 L_p1a
    s_setprio 3
    s_mov_b32 m0, s82
    s_nop 0
    buffer_load_dwordx4 v240, s[32:35], s81 offen offset:0 lds
    s_addk_i32 m0, 896
    s_nop 0
    buffer_load_dwordx4 v240, s[32:35], s81 offen offset:128 lds
    s_addk_i32 m0, 896
    s_nop 0
    buffer_load_dwordx4 v240, s[32:35], s81 offen offset:256 lds
    s_addk_i32 m0, 896
    s_nop 0
    buffer_load_dwordx4 v240, s[32:35], s81 offen offset:384 lds
    s_addk_i32 m0, 896
    s_nop 0
    buffer_load_dwordx4 v240, s[32:35], s81 offen offset:512 lds
    s_addk_i32 m0, 1600
    s_nop 0
    buffer_load_dwordx4 v240, s[32:35], s85 offen offset:0 lds
    s_addk_i32 m0, 896
    s_nop 0
    buffer_load_dwordx4 v240, s[32:35], s85 offen offset:128 lds
    s_addk_i32 m0, 896
    s_nop 0
    buffer_load_dwordx4 v240, s[32:35], s85 offen offset:256 lds
    s_addk_i32 m0, 896
    s_nop 0
    buffer_load_dwordx4 v240, s[32:35], s85 offen offset:384 lds
    s_addk_i32 m0, 896
    s_nop 0
    buffer_load_dwordx4 v240, s[32:35], s85 offen offset:512 lds
    s_movk_i32 s42, 25600
    s_mov_b32 s43, s35
    s_cmp_lt_u32 s72, 4
    s_cselect_b32 s40, s12, s14
    s_cselect_b32 s41, s13, s15
    s_mul_i32 s83, s75, 12288
    s_add_u32 m0, s83, 133632
    s_nop 0
    buffer_load_dwordx4 v3, s[40:43], s83 offen offset:0 lds
    buffer_load_dwordx4 v3, s[40:43], s83 offen offset:1024 lds
    buffer_load_dwordx4 v3, s[40:43], s83 offen offset:2048 lds
    buffer_load_dwordx4 v3, s[40:43], s83 offen offset:3072 lds
    s_add_u32 s83, s83, 4096
    s_add_u32 m0, m0, 4096
    s_nop 0
    buffer_load_dwordx4 v3, s[40:43], s83 offen offset:0 lds
    buffer_load_dwordx4 v3, s[40:43], s83 offen offset:1024 lds
    buffer_load_dwordx4 v3, s[40:43], s83 offen offset:2048 lds
    buffer_load_dwordx4 v3, s[40:43], s83 offen offset:3072 lds
    s_add_u32 s83, s83, 4096
    s_add_u32 m0, m0, 4096
    s_nop 0
    buffer_load_dwordx4 v3, s[40:43], s83 offen offset:0 lds
    buffer_load_dwordx4 v3, s[40:43], s83 offen offset:1024 lds
    buffer_load_dwordx4 v3, s[40:43], s83 offen offset:2048 lds
    buffer_load_dwordx4 v3, s[40:43], s83 offen offset:3072 lds
    s_add_u32 s83, s83, 4096
    s_add_u32 m0, m0, 4096
    s_nop 0
    buffer_load_dwordx4 v3, s[40:43], s83 offen offset:0 lds
    s_branch L_p1
L_p1a:
    s_cmp_lt_u32 s79, 5
    s_cbranch_scc1 L_ld
    s_movk_i32 s42, 25600
    s_mov_b32 s43, s35
    s_cmp_lt_u32 s72, 4
    s_cselect_b32 s40, s12, s14
    s_cselect_b32 s41, s13, s15
    s_and_b32 s83, s72, 3
    s_lshl2_add_u32 s83, s71, s83
    s_mul_i32 s83, s83, 1664
    v_min_u32 v5, 12, v0
    v_lshlrev_b32 v5, 7, v5
    buffer_load_dword v255, v5, s[40:43], s83 offen
L_p1:
    s_mov_b32 s64, s30
    s_mov_b32 s65, s31
    s_mov_b32 s66, 20971520
    s_mov_b32 s67, 0x20000
    s_mov_b32 s60, s28
    s_mov_b32 s61, s29
    s_mov_b32 s62, 256
    s_mov_b32 s63, 0x20000
    s_cmp_eq_u32 s79, 5
    s_cbranch_scc0 L_p2
    s_cmp_lg_u32 s2, 0
    s_cbranch_scc1 L_p2
    s_setprio 3
    v_mov_b32 v8, 0
    v_mov_b32 v9, 0
    v_mov_b32 v10, 0
    v_mov_b32 v11, 0
    s_movk_i32 s83, 0
    buffer_store_dwordx4 v[8:11], v3, s[64:67], s83 offen offset:0 sc1
    buffer_store_dwordx4 v[8:11], v3, s[64:67], s83 offen offset:1024 sc1
    buffer_store_dwordx4 v[8:11], v3, s[64:67], s83 offen offset:2048 sc1
    buffer_store_dwordx4 v[8:11], v3, s[64:67], s83 offen offset:3072 sc1
    s_movk_i32 s83, 4096
    buffer_store_dwordx4 v[8:11], v3, s[64:67], s83 offen offset:0 sc1
    buffer_store_dwordx4 v[8:11], v3, s[64:67], s83 offen offset:1024 sc1
    buffer_store_dwordx4 v[8:11], v3, s[64:67], s83 offen offset:2048 sc1
    buffer_store_dwordx4 v[8:11], v3, s[64:67], s83 offen offset:3072 sc1
    s_movk_i32 s83, 8192
    buffer_store_dwordx4 v[8:11], v3, s[64:67], s83 offen offset:0 sc1
    buffer_store_dwordx4 v[8:11], v3, s[64:67], s83 offen offset:1024 sc1
    buffer_store_dwordx4 v[8:11], v3, s[64:67], s83 offen offset:2048 sc1
    buffer_store_dwordx4 v[8:11], v3, s[64:67], s83 offen offset:3072 sc1
    s_movk_i32 s83, 12288
    buffer_store_dwordx4 v[8:11], v3, s[64:67], s83 offen offset:0 sc1
    buffer_store_dwordx4 v[8:11], v3, s[64:67], s83 offen offset:1024 sc1
    buffer_store_dwordx4 v[8:11], v3, s[64:67], s83 offen offset:2048 sc1
    buffer_store_dwordx4 v[8:11], v3, s[64:67], s83 offen offset:3072 sc1
L_p2:
    s_mov_b32 s44, s16
    s_mov_b32 s45, s17
    s_mov_b32 s46, 819200
    s_mov_b32 s47, 0x20000
    s_bitcmp1_b32 s68, 0
    s_cselect_b32 s48, s22, s20
    s_cselect_b32 s49, s23, s21
    s_mov_b32 s50, 1966080
    s_mov_b32 s51, 0x20000
    s_mov_b32 s52, s24
    s_mov_b32 s53, s25
    s_mov_b32 s54, 1966080
    s_mov_b32 s55, 0x20000
    s_mov_b32 s56, s26
    s_mov_b32 s57, s27
    s_mov_b32 s58, 2621440
    s_mov_b32 s59, 0x20000
    s_getreg_b32 s76, hwreg(HW_REG_XCC_ID)
    s_and_b32 s76, s76, 7
    s_lshr_b32 s80, s71, 1
    s_lshl1_add_u32 s75, s75, s80
    v_lshrrev_b32 v5, 1, v1
    v_xor_b32 v5, v5, v2
    v_and_b32 v5, 3, v5
    v_lshl_add_u32 v5, v1, 3, v5
    v_lshrrev_b32 v6, 3, v1
    v_mul_u32_u24 v6, 4160, v6
    v_lshl_add_u32 v5, v5, 4, v6
    v_add_u32 v5, s82, v5
    s_mul_i32 s83, s80, 2112
    v_add_u32 v241, s83, v5
    s_sub_u32 s83, 2112, s83
    v_add_u32 v243, s83, v5
    s_mul_i32 s83, s80, 3008
    s_add_u32 s80, s83, 64
    v_add_u32 v242, s80, v5
    s_sub_u32 s83, 3072, s83
    v_add_u32 v244, s83, v5
    v_mov_b32 v124, 0x3f803f80
    v_mov_b32 v128, 0
    v_mov_b32 v125, 0x3f803f80
    v_mov_b32 v129, 0
    v_mov_b32 v126, 0x3f803f80
    v_mov_b32 v130, 0
    v_mov_b32 v127, 0x3f803f80
    v_mov_b32 v131, 0
    s_mov_b32 s36, s10
    s_mov_b32 s37, s11
    s_mov_b32 s38, 819200
    s_mov_b32 s39, 0x20000
    s_cmp_eq_u32 s79, 7
    s_cbranch_scc1 L_kv
    s_branch L_aux
L_ld:
    s_mov_b32 s36, s10
    s_mov_b32 s37, s11
    s_mov_b32 s38, 819200
    s_mov_b32 s39, 0x20000
    s_mul_i32 s8, s72, 160
    s_mul_i32 s83, s79, 40960
    s_add_u32 s8, s8, s83
    s_mul_i32 s10, s79, 5120
    s_lshr_b32 s83, s71, 1
    s_lshl_b32 s15, s71, 1
    s_and_b32 s15, s15, 2
    s_or_b32 s15, s15, s83
    s_mul_i32 s83, s15, 204800
    s_add_u32 s12, s8, s83
    s_movk_i32 s13, 1120
    s_movk_i32 s14, 5120
    v_mul_u32_u24 v4, 6554, v0
    s_mov_b32 s64, s30
    s_mov_b32 s65, s31
    s_mov_b32 s66, 20971520
    s_mov_b32 s67, 0x20000
    s_mov_b32 s60, s28
    s_mov_b32 s61, s29
    s_mov_b32 s62, 256
    s_mov_b32 s63, 0x20000
    s_mov_b32 s44, s16
    s_mov_b32 s45, s17
    s_mov_b32 s46, 819200
    s_mov_b32 s47, 0x20000
    s_bitcmp1_b32 s68, 0
    s_cselect_b32 s48, s22, s20
    s_cselect_b32 s49, s23, s21
    s_mov_b32 s50, 1966080
    s_mov_b32 s51, 0x20000
    s_mov_b32 s52, s24
    s_mov_b32 s53, s25
    s_mov_b32 s54, 1966080
    s_mov_b32 s55, 0x20000
    s_mov_b32 s56, s26
    s_mov_b32 s57, s27
    s_mov_b32 s58, 2621440
    s_mov_b32 s59, 0x20000
    s_getreg_b32 s76, hwreg(HW_REG_XCC_ID)
    s_and_b32 s76, s76, 7
    s_lshr_b32 s80, s71, 1
    s_lshl1_add_u32 s75, s75, s80
    v_lshrrev_b32 v56, 1, v1
    v_xor_b32 v56, v56, v2
    v_and_b32 v56, 3, v56
    v_lshl_add_u32 v56, v1, 3, v56
    v_lshrrev_b32 v57, 3, v1
    v_mul_u32_u24 v57, 4160, v57
    v_lshl_add_u32 v56, v56, 4, v57
    v_add_u32 v56, s82, v56
    s_mul_i32 s83, s80, 2112
    v_add_u32 v241, s83, v56
    s_sub_u32 s83, 2112, s83
    v_add_u32 v243, s83, v56
    s_mul_i32 s83, s80, 3008
    s_add_u32 s80, s83, 64
    v_add_u32 v242, s80, v56
    s_sub_u32 s83, 3072, s83
    v_add_u32 v244, s83, v56
    v_mov_b32 v124, 0x3f803f80
    v_mov_b32 v128, 0
    v_mov_b32 v125, 0x3f803f80
    v_mov_b32 v129, 0
    v_mov_b32 v126, 0x3f803f80
    v_mov_b32 v130, 0
    v_mov_b32 v127, 0x3f803f80
    v_mov_b32 v131, 0
    s_lshl_b32 s74, s69, 5
    s_add_u32 s74, s74, s70
    s_mov_b32 s4, 0x000fffff
    s_mov_b32 s5, 0x000fffff
    s_mov_b32 s6, 0x05040100
    s_mov_b32 s7, 0x07060302
    v_and_b32 v61, 31, v0
    v_lshrrev_b32 v62, 5, v0
    s_and_b32 s80, s68, 3
    s_mul_i32 s80, s80, 80
    s_mul_i32 s83, s77, 10752
    s_add_u32 s83, s83, s80
    s_add_u32 s83, s83, 118784
    v_mul_u32_u24 v57, 336, v61
    s_setprio 2
    v_lshrrev_b32 v5, 16, v4
    v_bfe_u32 v6, v4, 18, 1
    v_bfe_u32 v7, v4, 19, 1
    v_mad_u32_u24 v5, v5, s13, v3
    v_sub_u32 v6, v6, v7
    v_mad_i32_i24 v248, v6, s14, v5
    v_add_u32 v4, 419456, v4
    s_add_u32 m0, s10, 0
    s_nop 0
    buffer_load_dwordx4 v248, s[36:39], s12 offen offset:0 lds
    v_lshrrev_b32 v5, 16, v4
    v_bfe_u32 v6, v4, 18, 1
    v_bfe_u32 v7, v4, 19, 1
    v_mad_u32_u24 v5, v5, s13, v3
    v_sub_u32 v6, v6, v7
    v_mad_i32_i24 v249, v6, s14, v5
    v_add_u32 v4, 419456, v4
    buffer_load_dwordx4 v249, s[36:39], s12 offen offset:1024 lds
    v_lshrrev_b32 v5, 16, v4
    v_bfe_u32 v6, v4, 18, 1
    v_bfe_u32 v7, v4, 19, 1
    v_mad_u32_u24 v5, v5, s13, v3
    v_sub_u32 v6, v6, v7
    v_mad_i32_i24 v250, v6, s14, v5
    v_add_u32 v4, 419456, v4
    buffer_load_dwordx4 v250, s[36:39], s12 offen offset:2048 lds
    v_lshrrev_b32 v5, 16, v4
    v_bfe_u32 v6, v4, 18, 1
    v_bfe_u32 v7, v4, 19, 1
    v_mad_u32_u24 v5, v5, s13, v3
    v_sub_u32 v6, v6, v7
    v_mad_i32_i24 v251, v6, s14, v5
    v_add_u32 v4, 419456, v4
    buffer_load_dwordx4 v251, s[36:39], s12 offen offset:3072 lds
    v_lshrrev_b32 v5, 16, v4
    v_bfe_u32 v6, v4, 18, 1
    v_bfe_u32 v7, v4, 19, 1
    v_mad_u32_u24 v5, v5, s13, v3
    v_sub_u32 v6, v6, v7
    v_mad_i32_i24 v252, v6, s14, v5
    v_add_u32 v252, 4096, v252
    s_add_u32 m0, s10, 4096
    s_nop 0
    buffer_load_dwordx4 v252, s[36:39], s12 offen offset:0 lds
    s_setprio 1
    s_mov_b32 m0, s82
    s_nop 0
    buffer_load_dwordx4 v240, s[32:35], s81 offen offset:0 lds
    s_mul_i32 s11, s79, 10304
    s_xor_b32 s13, s15, 2
    s_mul_i32 s13, s13, 204800
    s_add_u32 s13, s8, s13
    s_xor_b32 s14, s15, 1
    s_mul_i32 s14, s14, 204800
    s_add_u32 s14, s8, s14
    s_xor_b32 s15, s15, 3
    s_mul_i32 s15, s15, 204800
    s_add_u32 s15, s8, s15
    v_add_u32 v150, s83, v57
    v_lshl_add_u32 v149, v62, 5, v150
    s_add_u32 s80, s80, 161792
    v_mov_b32 v151, s80
    v_lshl_add_u32 v152, v62, 5, v151
    s_lshl_b32 s80, s77, 8
    s_add_u32 s80, s80, 162432
    v_lshl_add_u32 v153, v61, 3, s80
    v_mov_b32 v136, v3
    v_lshlrev_b32 v137, 3, v61
    v_add_u32 v137, 1024, v137
    v_and_b32 v57, 0x13, v1
    v_and_b32 v58, 4, v1
    v_lshl_or_b32 v57, v58, 1, v57
    v_and_b32 v58, 8, v1
    v_lshrrev_b32 v58, 1, v58
    v_or_b32 v57, v57, v58
    s_addk_i32 m0, 896
    s_nop 0
    buffer_load_dwordx4 v240, s[32:35], s81 offen offset:128 lds
    v_lshlrev_b32 v58, 2, v62
    v_xor_b32 v57, v57, v58
    v_lshl_add_u32 v57, v62, 4, v57
    v_add3_u32 v58, v58, v61, 16
    v_cmp_gt_u32 vcc, 16, v61
    s_nop 1
    v_cndmask_b32 v57, v58, v57, vcc
    v_lshlrev_b32 v138, 4, v57
    v_add_u32 v138, 1280, v138
    s_lshl_b32 s80, s73, 1
    s_add_u32 s80, s80, s68
    s_lshr_b32 s83, s73, 3
    s_add_u32 s83, s83, 64
    s_and_b32 s84, s73, 7
    s_lshl_b32 s84, s84, 3
    s_add_u32 s84, s84, s68
    s_cmp_lt_u32 s68, 2
    s_cselect_b32 s25, s80, s83
    s_cselect_b32 s22, 2, s84
    s_addk_i32 m0, 896
    s_nop 0
    buffer_load_dwordx4 v240, s[32:35], s81 offen offset:256 lds
    s_mul_i32 s80, s25, 52
    s_lshr_b32 s80, s80, 8
    s_mul_i32 s18, s80, 204800
    s_mul_i32 s80, s80, 5
    s_sub_u32 s80, s25, s80
    s_and_b32 s83, s80, 3
    s_mul_i32 s83, s83, 51200
    s_add_u32 s18, s18, s83
    v_lshrrev_b32 v59, 1, v2
    v_mul_u32_u24 v59, 25600, v59
    v_and_b32 v60, 1, v2
    v_mul_u32_u24 v60, 10240, v60
    v_add_u32 v59, v59, v60
    v_mul_u32_u24 v60, 51200, v2
    v_add_u32 v60, 20480, v60
    s_movk_i32 s19, 5120
    s_cmp_lt_u32 s80, 4
    s_cselect_b64 vcc, -1, 0
    s_cselect_b32 s19, s19, 25600
    v_cndmask_b32 v59, v60, v59, vcc
    s_addk_i32 m0, 896
    s_nop 0
    buffer_load_dwordx4 v240, s[32:35], s81 offen offset:384 lds
    v_mul_u32_u24 v60, 10240, v2
    s_sub_u32 s83, s25, 20
    s_mul_i32 s83, s83, 40960
    s_cmp_lt_u32 s25, 20
    s_cselect_b64 vcc, -1, 0
    s_cselect_b32 s18, s18, s83
    s_cselect_b32 s19, s19, 5120
    s_cselect_b32 s44, s44, s52
    s_cselect_b32 s45, s45, s53
    s_cselect_b32 s46, s46, s54
    v_cndmask_b32 v59, v60, v59, vcc
    s_add_u32 s19, s19, s18
    s_lshl_b32 s80, s72, 7
    v_lshl_add_u32 v57, v1, 3, s80
    s_lshl_b32 s83, s72, 5
    s_add_u32 s83, s83, 1024
    v_lshl_add_u32 v58, v1, 1, s83
    s_addk_i32 m0, 896
    s_nop 0
    buffer_load_dwordx4 v240, s[32:35], s81 offen offset:512 lds
    v_add_u32 v139, v59, v57
    v_add_u32 v140, v59, v58
    s_and_b32 s84, s68, 1
    s_lshl_b32 s84, s84, 2
    s_add_u32 s83, s83, s84
    s_lshl_b32 s84, s84, 2
    s_add_u32 s80, s80, s84
    s_lshl_b32 s84, s84, 1
    v_xor_b32 v148, s84, v3
    v_mul_u32_u24 v59, 1280, v1
    v_lshl_add_u32 v57, v2, 5, v59
    v_lshl_add_u32 v58, v2, 3, v59
    v_add_u32 v57, s80, v57
    v_add_u32 v58, s83, v58
    s_lshl_b32 s80, s73, 2
    s_lshr_b32 s83, s68, 1
    s_add_u32 s80, s80, s83
    s_addk_i32 m0, 1600
    s_nop 0
    buffer_load_dwordx4 v240, s[32:35], s85 offen offset:0 lds
    s_mul_i32 s80, s80, 20480
    v_add_u32 v146, s80, v57
    v_add_u32 v147, s80, v58
    s_and_b32 s80, s68, 1
    s_lshl_b32 s83, s80, 2
    s_mul_i32 s84, s70, 96
    v_add_u32 v56, 0, v0
    v_mul_u32_u24 v57, 10923, v56
    v_lshrrev_b32 v57, 16, v57
    v_mul_u32_u24 v58, 6, v57
    v_sub_u32 v56, v56, v58
    v_xor_b32 v57, s83, v57
    v_mul_u32_u24 v57, 3072, v57
    v_lshl_add_u32 v56, v56, 4, v57
    v_add_u32 v143, s84, v56
    v_add_u32 v56, 64, v0
    v_mul_u32_u24 v57, 10923, v56
    s_addk_i32 m0, 896
    s_nop 0
    buffer_load_dwordx4 v240, s[32:35], s85 offen offset:128 lds
    v_lshrrev_b32 v57, 16, v57
    v_mul_u32_u24 v58, 6, v57
    v_sub_u32 v56, v56, v58
    v_xor_b32 v57, s83, v57
    v_mul_u32_u24 v57, 3072, v57
    v_lshl_add_u32 v56, v56, 4, v57
    v_add_u32 v144, s84, v56
    v_add_u32 v56, 128, v0
    v_mul_u32_u24 v57, 10923, v56
    v_lshrrev_b32 v57, 16, v57
    v_mul_u32_u24 v58, 6, v57
    v_sub_u32 v56, v56, v58
    v_xor_b32 v57, s83, v57
    v_mul_u32_u24 v57, 3072, v57
    v_lshl_add_u32 v56, v56, 4, v57
    v_add_u32 v145, s84, v56
    s_lshr_b32 s83, s68, 1
    s_addk_i32 m0, 896
    s_nop 0
    buffer_load_dwordx4 v240, s[32:35], s85 offen offset:256 lds
    s_mul_i32 s16, s83, 98304
    s_mul_i32 s17, s83, 6144
    s_mul_i32 s80, s80, 3072
    s_add_u32 s17, s17, s80
    v_add_u32 v142, s17, v3
    v_add_u32 v142, 73728, v142
    v_lshlrev_b32 v141, 7, v0
    s_mul_i32 s80, s72, 348160
    s_add_u32 s80, s80, 16777216
    s_mul_i32 s83, s25, 5120
    s_add_u32 s20, s80, s83
    s_and_b32 s84, s68, 3
    s_mul_i32 s83, s84, 25600
    s_add_u32 s21, s80, s83
    s_lshl_b32 s23, s71, 3
    s_add_u32 s23, s23, s68
    s_mul_i32 s83, s23, 3200
    s_addk_i32 m0, 896
    s_nop 0
    buffer_load_dwordx4 v240, s[32:35], s85 offen offset:384 lds
    s_add_u32 s26, s80, s83
    s_add_u32 s80, s80, 102400
    s_mul_i32 s83, s23, 7680
    s_add_u32 s23, s80, s83
    s_mul_i32 s83, s68, 30720
    s_add_u32 s24, s80, s83
    s_lshl_b32 s80, s72, 9
    s_add_u32 s80, s80, 12288
    s_lshl_b32 s25, s25, 2
    s_add_u32 s25, s25, s80
    v_min_u32 v56, 33, v0
    v_lshl_add_u32 v154, v56, 3, s80
    s_lshl_b32 s80, s74, 3
    s_add_u32 s80, s80, s68
    s_mul_i32 s83, s80, 1280
    v_add_u32 v56, s83, v141
    s_mul_i32 s83, s80, 3072
    s_addk_i32 m0, 896
    s_nop 0
    buffer_load_dwordx4 v240, s[32:35], s85 offen offset:512 lds
    s_add_u32 s83, s83, 5765888
    v_add_u32 v57, s83, v141
    v_cmp_gt_u32 vcc, 10, v0
    s_nop 1
    v_cndmask_b32 v56, v57, v56, vcc
    s_lshl_b32 s83, s73, 3
    s_add_u32 s83, s83, s68
    s_lshl_b32 s83, s83, 7
    v_mov_b32 v57, s72
    v_lshl_add_u32 v57, v57, 15, s83
    v_add_u32 v57, 5505024, v57
    v_cmp_gt_u32 vcc, 34, v0
    s_nop 1
    v_cndmask_b32 v56, v57, v56, vcc
    s_lshl_b32 s80, s80, 2
    s_add_u32 s27, s80, 4096
    v_mov_b32 v57, s27
    v_cmp_gt_u32 vcc, 35, v0
    s_nop 1
    v_cndmask_b32 v155, v57, v56, vcc
    s_setprio 0
    s_add_u32 m0, s10, 25600
    s_nop 0
    buffer_load_dwordx4 v248, s[36:39], s13 offen offset:0 lds
    s_lshl_b32 s80, s72, 2
    s_add_u32 s80, s80, s84
    s_lshl_b32 s83, s73, 1
    s_add_u32 s83, s83, s77
    s_mul_i32 s83, s83, 98304
    s_add_u32 s83, s83, 5767168
    s_lshl_b32 s84, s80, 9
    s_add_u32 s28, s83, s84
    s_lshr_b32 s84, s80, 1
    s_lshl_b32 s84, s84, 8
    s_add_u32 s83, s83, s84
    s_and_b32 s80, s80, 1
    s_lshl_b32 s80, s80, 3
    s_add_u32 s83, s83, s80
    s_add_u32 s29, s83, 16384
    v_lshrrev_b32 v56, 1, v2
    v_lshlrev_b32 v56, 4, v56
    buffer_load_dwordx4 v249, s[36:39], s13 offen offset:1024 lds
    v_and_b32 v57, 1, v2
    v_lshl_add_u32 v56, v57, 2, v56
    v_lshrrev_b32 v57, 2, v1
    v_add_u32 v56, v56, v57
    v_mul_u32_u24 v56, 160, v56
    v_and_b32 v57, 3, v0
    v_lshl_add_u32 v56, v57, 3, v56
    s_mul_i32 s80, s77, 25600
    v_add_u32 v56, s80, v56
    s_lshl_b32 s80, s77, 2
    s_add_u32 s80, s80, s78
    s_mul_i32 s80, s80, 5376
    s_add_u32 s80, s80, 118784
    v_mul_u32_u24 v57, 336, v1
    v_lshl_add_u32 v57, v2, 4, v57
    v_add_u32 v57, s80, v57
    s_mul_i32 s84, s77, 20480
    buffer_load_dwordx4 v250, s[36:39], s13 offen offset:2048 lds
    s_sub_u32 s84, 51200, s84
    s_xor_b32 s80, s78, 0
    s_lshl_b32 s80, s80, 5
    v_add_u32 v8, s80, v56
    v_add_u32 v156, s84, v8
    v_lshl_add_u32 v161, s80, 1, v57
    s_xor_b32 s80, s78, 1
    s_lshl_b32 s80, s80, 5
    v_add_u32 v9, s80, v56
    v_add_u32 v157, s84, v9
    v_lshl_add_u32 v162, s80, 1, v57
    s_xor_b32 s80, s78, 2
    s_lshl_b32 s80, s80, 5
    v_add_u32 v10, s80, v56
    v_add_u32 v158, s84, v10
    v_lshl_add_u32 v163, s80, 1, v57
    s_xor_b32 s80, s78, 3
    buffer_load_dwordx4 v251, s[36:39], s13 offen offset:3072 lds
    s_lshl_b32 s80, s80, 5
    v_add_u32 v11, s80, v56
    v_add_u32 v159, s84, v11
    v_lshl_add_u32 v164, s80, 1, v57
    s_movk_i32 s80, 128
    v_add_u32 v12, s80, v56
    v_add_u32 v160, s84, v12
    v_lshl_add_u32 v165, s80, 1, v57
    s_mul_i32 s83, s77, 320
    s_add_u32 s83, s83, 161792
    v_lshl_add_u32 v167, v2, 4, s83
    s_lshl_b32 s80, s78, 6
    v_add_u32 v166, s80, v167
    v_and_b32 v133, 31, v0
    v_lshlrev_b32 v133, 7, v133
    s_mul_i32 s80, s70, 5120
    s_add_u32 s80, s80, 16384
    s_add_u32 m0, s10, 29696
    s_nop 0
    buffer_load_dwordx4 v252, s[36:39], s13 offen offset:0 lds
    v_min_u32 v134, 39, v0
    v_lshl_add_u32 v134, v134, 7, s80
    v_mov_b32 v135, 163712
    v_mov_b32 v7, 0
    s_branch L_ldb
L_aux:
    v_mov_b32 v248, 0
    v_mov_b32 v249, 0
    v_mov_b32 v250, 0
    v_mov_b32 v251, 0
    v_mov_b32 v252, 0
    s_cmp_lg_u32 s2, 0
    s_cbranch_scc1 L_aux2
    v_mov_b32 v13, 1
    s_waitcnt vmcnt(0)
    s_mov_b64 exec, 1
    buffer_store_dword v13, v7, s[60:63], 0 offen sc1
    s_mov_b64 exec, -1
L_aux2:
    s_setprio 1
    s_mov_b32 m0, s82
    s_nop 0
    buffer_load_dwordx4 v240, s[32:35], s81 offen offset:0 lds
    s_addk_i32 m0, 896
    s_nop 0
    buffer_load_dwordx4 v240, s[32:35], s81 offen offset:128 lds
    s_addk_i32 m0, 896
    s_nop 0
    buffer_load_dwordx4 v240, s[32:35], s81 offen offset:256 lds
    s_addk_i32 m0, 896
    s_nop 0
    buffer_load_dwordx4 v240, s[32:35], s81 offen offset:384 lds
    s_addk_i32 m0, 896
    s_nop 0
    buffer_load_dwordx4 v240, s[32:35], s81 offen offset:512 lds
    s_addk_i32 m0, 1600
    s_nop 0
    buffer_load_dwordx4 v240, s[32:35], s85 offen offset:0 lds
    s_addk_i32 m0, 896
    s_nop 0
    buffer_load_dwordx4 v240, s[32:35], s85 offen offset:128 lds
    s_addk_i32 m0, 896
    s_nop 0
    buffer_load_dwordx4 v240, s[32:35], s85 offen offset:256 lds
    s_addk_i32 m0, 896
    s_nop 0
    buffer_load_dwordx4 v240, s[32:35], s85 offen offset:384 lds
    s_addk_i32 m0, 896
    s_nop 0
    buffer_load_dwordx4 v240, s[32:35], s85 offen offset:512 lds
    s_setprio 0
L_setup:
    s_lshl_b32 s74, s69, 5
    s_add_u32 s74, s74, s70
    s_mov_b32 s4, 0x000fffff
    s_mov_b32 s5, 0x000fffff
    s_mov_b32 s6, 0x05040100
    s_mov_b32 s7, 0x07060302
    v_and_b32 v61, 31, v0
    v_lshrrev_b32 v62, 5, v0
    s_and_b32 s80, s68, 3
    s_mul_i32 s80, s80, 80
    s_mul_i32 s83, s77, 10752
    s_add_u32 s83, s83, s80
    s_add_u32 s83, s83, 118784
    v_mul_u32_u24 v57, 336, v61
    v_add_u32 v150, s83, v57
    v_lshl_add_u32 v149, v62, 5, v150
    s_add_u32 s80, s80, 161792
    v_mov_b32 v151, s80
    v_lshl_add_u32 v152, v62, 5, v151
    s_lshl_b32 s80, s77, 8
    s_add_u32 s80, s80, 162432
    v_lshl_add_u32 v153, v61, 3, s80
    v_mov_b32 v136, v3
    v_lshlrev_b32 v137, 3, v61
    v_add_u32 v137, 1024, v137
    v_and_b32 v57, 0x13, v1
    v_and_b32 v58, 4, v1
    v_lshl_or_b32 v57, v58, 1, v57
    v_and_b32 v58, 8, v1
    v_lshrrev_b32 v58, 1, v58
    v_or_b32 v57, v57, v58
    v_lshlrev_b32 v58, 2, v62
    v_xor_b32 v57, v57, v58
    v_lshl_add_u32 v57, v62, 4, v57
    v_add3_u32 v58, v58, v61, 16
    v_cmp_gt_u32 vcc, 16, v61
    s_nop 1
    v_cndmask_b32 v57, v58, v57, vcc
    v_lshlrev_b32 v138, 4, v57
    v_add_u32 v138, 1280, v138
    s_lshl_b32 s80, s73, 1
    s_add_u32 s80, s80, s68
    s_lshr_b32 s83, s73, 3
    s_add_u32 s83, s83, 64
    s_and_b32 s84, s73, 7
    s_lshl_b32 s84, s84, 3
    s_add_u32 s84, s84, s68
    s_cmp_lt_u32 s68, 2
    s_cselect_b32 s25, s80, s83
    s_cselect_b32 s22, 2, s84
    s_mul_i32 s80, s25, 52
    s_lshr_b32 s80, s80, 8
    s_mul_i32 s18, s80, 204800
    s_mul_i32 s80, s80, 5
    s_sub_u32 s80, s25, s80
    s_and_b32 s83, s80, 3
    s_mul_i32 s83, s83, 51200
    s_add_u32 s18, s18, s83
    v_lshrrev_b32 v59, 1, v2
    v_mul_u32_u24 v59, 25600, v59
    v_and_b32 v60, 1, v2
    v_mul_u32_u24 v60, 10240, v60
    v_add_u32 v59, v59, v60
    v_mul_u32_u24 v60, 51200, v2
    v_add_u32 v60, 20480, v60
    s_movk_i32 s19, 5120
    s_cmp_lt_u32 s80, 4
    s_cselect_b64 vcc, -1, 0
    s_cselect_b32 s19, s19, 25600
    v_cndmask_b32 v59, v60, v59, vcc
    v_mul_u32_u24 v60, 10240, v2
    s_sub_u32 s83, s25, 20
    s_mul_i32 s83, s83, 40960
    s_cmp_lt_u32 s25, 20
    s_cselect_b64 vcc, -1, 0
    s_cselect_b32 s18, s18, s83
    s_cselect_b32 s19, s19, 5120
    s_cselect_b32 s44, s44, s52
    s_cselect_b32 s45, s45, s53
    s_cselect_b32 s46, s46, s54
    v_cndmask_b32 v59, v60, v59, vcc
    s_add_u32 s19, s19, s18
    s_lshl_b32 s80, s72, 7
    v_lshl_add_u32 v57, v1, 3, s80
    s_lshl_b32 s83, s72, 5
    s_add_u32 s83, s83, 1024
    v_lshl_add_u32 v58, v1, 1, s83
    v_add_u32 v139, v59, v57
    v_add_u32 v140, v59, v58
    s_and_b32 s84, s68, 1
    s_lshl_b32 s84, s84, 2
    s_add_u32 s83, s83, s84
    s_lshl_b32 s84, s84, 2
    s_add_u32 s80, s80, s84
    s_lshl_b32 s84, s84, 1
    v_xor_b32 v148, s84, v3
    v_mul_u32_u24 v59, 1280, v1
    v_lshl_add_u32 v57, v2, 5, v59
    v_lshl_add_u32 v58, v2, 3, v59
    v_add_u32 v57, s80, v57
    v_add_u32 v58, s83, v58
    s_lshl_b32 s80, s73, 2
    s_lshr_b32 s83, s68, 1
    s_add_u32 s80, s80, s83
    s_mul_i32 s80, s80, 20480
    v_add_u32 v146, s80, v57
    v_add_u32 v147, s80, v58
    s_and_b32 s80, s68, 1
    s_lshl_b32 s83, s80, 2
    s_mul_i32 s84, s70, 96
    v_add_u32 v56, 0, v0
    v_mul_u32_u24 v57, 10923, v56
    v_lshrrev_b32 v57, 16, v57
    v_mul_u32_u24 v58, 6, v57
    v_sub_u32 v56, v56, v58
    v_xor_b32 v57, s83, v57
    v_mul_u32_u24 v57, 3072, v57
    v_lshl_add_u32 v56, v56, 4, v57
    v_add_u32 v143, s84, v56
    v_add_u32 v56, 64, v0
    v_mul_u32_u24 v57, 10923, v56
    v_lshrrev_b32 v57, 16, v57
    v_mul_u32_u24 v58, 6, v57
    v_sub_u32 v56, v56, v58
    v_xor_b32 v57, s83, v57
    v_mul_u32_u24 v57, 3072, v57
    v_lshl_add_u32 v56, v56, 4, v57
    v_add_u32 v144, s84, v56
    v_add_u32 v56, 128, v0
    v_mul_u32_u24 v57, 10923, v56
    v_lshrrev_b32 v57, 16, v57
    v_mul_u32_u24 v58, 6, v57
    v_sub_u32 v56, v56, v58
    v_xor_b32 v57, s83, v57
    v_mul_u32_u24 v57, 3072, v57
    v_lshl_add_u32 v56, v56, 4, v57
    v_add_u32 v145, s84, v56
    s_lshr_b32 s83, s68, 1
    s_mul_i32 s16, s83, 98304
    s_mul_i32 s17, s83, 6144
    s_mul_i32 s80, s80, 3072
    s_add_u32 s17, s17, s80
    v_add_u32 v142, s17, v3
    v_add_u32 v142, 73728, v142
    v_lshlrev_b32 v141, 7, v0
    s_mul_i32 s80, s72, 348160
    s_add_u32 s80, s80, 16777216
    s_mul_i32 s83, s25, 5120
    s_add_u32 s20, s80, s83
    s_and_b32 s84, s68, 3
    s_mul_i32 s83, s84, 25600
    s_add_u32 s21, s80, s83
    s_lshl_b32 s23, s71, 3
    s_add_u32 s23, s23, s68
    s_mul_i32 s83, s23, 3200
    s_add_u32 s26, s80, s83
    s_add_u32 s80, s80, 102400
    s_mul_i32 s83, s23, 7680
    s_add_u32 s23, s80, s83
    s_mul_i32 s83, s68, 30720
    s_add_u32 s24, s80, s83
    s_lshl_b32 s80, s72, 9
    s_add_u32 s80, s80, 12288
    s_lshl_b32 s25, s25, 2
    s_add_u32 s25, s25, s80
    v_min_u32 v56, 33, v0
    v_lshl_add_u32 v154, v56, 3, s80
    s_lshl_b32 s80, s74, 3
    s_add_u32 s80, s80, s68
    s_mul_i32 s83, s80, 1280
    v_add_u32 v56, s83, v141
    s_mul_i32 s83, s80, 3072
    s_add_u32 s83, s83, 5765888
    v_add_u32 v57, s83, v141
    v_cmp_gt_u32 vcc, 10, v0
    s_nop 1
    v_cndmask_b32 v56, v57, v56, vcc
    s_lshl_b32 s83, s73, 3
    s_add_u32 s83, s83, s68
    s_lshl_b32 s83, s83, 7
    v_mov_b32 v57, s72
    v_lshl_add_u32 v57, v57, 15, s83
    v_add_u32 v57, 5505024, v57
    v_cmp_gt_u32 vcc, 34, v0
    s_nop 1
    v_cndmask_b32 v56, v57, v56, vcc
    s_lshl_b32 s80, s80, 2
    s_cmp_eq_u32 s79, 7
    s_cbranch_scc0 L_nat
    s_waitcnt vmcnt(0)
    s_movk_i32 s85, 0x7fff
    v_cmp_le_u32 vcc, 1, v15
    s_nop 0
    s_cmp_eq_u64 vcc, exec
    s_cbranch_scc1 L_pdone_2
L_poll_1:
    buffer_load_dword v15, v7, s[60:63], 0 offen offset:0 sc1
    s_sub_u32 s85, s85, 1
    s_waitcnt vmcnt(0)
    s_cbranch_scc1 L_pdone_2
    v_cmp_le_u32 vcc, 1, v15
    s_nop 0
    s_cmp_eq_u64 vcc, exec
    s_nop 1
    s_cbranch_scc0 L_poll_1
L_pdone_2:
    s_mov_b64 exec, 1
    buffer_atomic_add_x2 v[110:111], v7, s[64:67], s82 offen sc1
    s_mov_b64 exec, -1
L_nat:
    s_add_u32 s27, s80, 4096
    v_mov_b32 v57, s27
    v_cmp_gt_u32 vcc, 35, v0
    s_nop 1
    v_cndmask_b32 v155, v57, v56, vcc
    s_lshl_b32 s80, s72, 2
    s_add_u32 s80, s80, s84
    s_lshl_b32 s83, s73, 1
    s_add_u32 s83, s83, s77
    s_mul_i32 s83, s83, 98304
    s_add_u32 s83, s83, 5767168
    s_lshl_b32 s84, s80, 9
    s_add_u32 s28, s83, s84
    s_lshr_b32 s84, s80, 1
    s_lshl_b32 s84, s84, 8
    s_add_u32 s83, s83, s84
    s_and_b32 s80, s80, 1
    s_lshl_b32 s80, s80, 3
    s_add_u32 s83, s83, s80
    s_add_u32 s29, s83, 16384
    v_lshrrev_b32 v56, 1, v2
    v_lshlrev_b32 v56, 4, v56
    v_and_b32 v57, 1, v2
    v_lshl_add_u32 v56, v57, 2, v56
    v_lshrrev_b32 v57, 2, v1
    v_add_u32 v56, v56, v57
    v_mul_u32_u24 v56, 160, v56
    v_and_b32 v57, 3, v0
    v_lshl_add_u32 v56, v57, 3, v56
    s_mul_i32 s80, s77, 25600
    v_add_u32 v56, s80, v56
    s_lshl_b32 s80, s77, 2
    s_add_u32 s80, s80, s78
    s_mul_i32 s80, s80, 5376
    s_add_u32 s80, s80, 118784
    v_mul_u32_u24 v57, 336, v1
    v_lshl_add_u32 v57, v2, 4, v57
    v_add_u32 v57, s80, v57
    s_mul_i32 s84, s77, 20480
    s_sub_u32 s84, 51200, s84
    s_xor_b32 s80, s78, 0
    s_lshl_b32 s80, s80, 5
    v_add_u32 v8, s80, v56
    v_add_u32 v156, s84, v8
    v_lshl_add_u32 v161, s80, 1, v57
    s_xor_b32 s80, s78, 1
    s_lshl_b32 s80, s80, 5
    v_add_u32 v9, s80, v56
    v_add_u32 v157, s84, v9
    v_lshl_add_u32 v162, s80, 1, v57
    s_xor_b32 s80, s78, 2
    s_lshl_b32 s80, s80, 5
    v_add_u32 v10, s80, v56
    v_add_u32 v158, s84, v10
    v_lshl_add_u32 v163, s80, 1, v57
    s_xor_b32 s80, s78, 3
    s_lshl_b32 s80, s80, 5
    v_add_u32 v11, s80, v56
    v_add_u32 v159, s84, v11
    v_lshl_add_u32 v164, s80, 1, v57
    s_movk_i32 s80, 128
    v_add_u32 v12, s80, v56
    v_add_u32 v160, s84, v12
    v_lshl_add_u32 v165, s80, 1, v57
    s_mul_i32 s83, s77, 320
    s_add_u32 s83, s83, 161792
    v_lshl_add_u32 v167, v2, 4, s83
    s_lshl_b32 s80, s78, 6
    v_add_u32 v166, s80, v167
    v_and_b32 v133, 31, v0
    v_lshlrev_b32 v133, 7, v133
    s_mul_i32 s80, s70, 5120
    s_add_u32 s80, s80, 16384
    v_min_u32 v134, 39, v0
    v_lshl_add_u32 v134, v134, 7, s80
    v_mov_b32 v135, 163712
    v_mov_b32 v7, 0
    s_cmp_eq_u32 s79, 7
    s_cbranch_scc1 L_kvb
    s_branch L_auxb
L_ldb:
    s_waitcnt vmcnt(5)
    ds_read_b128 v[16:19], v241 offset:0
    ds_read_b128 v[20:23], v242 offset:0
    ds_read_b128 v[24:27], v241 offset:1024
    ds_read_b128 v[28:31], v242 offset:1024
    ds_read_b128 v[32:35], v241 offset:2048
    ds_read_b128 v[36:39], v243 offset:0
    ds_read_b128 v[40:43], v244 offset:0
    ds_read_b128 v[44:47], v243 offset:1024
    ds_read_b128 v[48:51], v244 offset:1024
    ds_read_b128 v[52:55], v243 offset:2048
    s_waitcnt lgkmcnt(0)
    s_add_u32 m0, s11, 51200
    s_nop 0
    buffer_load_dwordx4 v248, s[36:39], s14 offen offset:0 lds
    buffer_load_dwordx4 v249, s[36:39], s14 offen offset:1024 lds
    buffer_load_dwordx4 v250, s[36:39], s14 offen offset:2048 lds
    buffer_load_dwordx4 v251, s[36:39], s14 offen offset:3072 lds
    s_add_u32 m0, s11, 55296
    s_nop 0
    buffer_load_dwordx4 v252, s[36:39], s14 offen offset:0 lds
    v_dot2c_f32_bf16 v128, v16, v124
    v_dot2c_f32_bf16 v129, v16, v16
    v_dot2c_f32_bf16 v128, v17, v124
    v_dot2c_f32_bf16 v129, v17, v17
    v_dot2c_f32_bf16 v128, v18, v124
    v_dot2c_f32_bf16 v129, v18, v18
    v_dot2c_f32_bf16 v128, v19, v124
    v_dot2c_f32_bf16 v129, v19, v19
    v_dot2c_f32_bf16 v128, v20, v124
    v_dot2c_f32_bf16 v129, v20, v20
    v_dot2c_f32_bf16 v128, v21, v124
    v_dot2c_f32_bf16 v129, v21, v21
    v_dot2c_f32_bf16 v128, v22, v124
    v_dot2c_f32_bf16 v129, v22, v22
    v_dot2c_f32_bf16 v128, v23, v124
    v_dot2c_f32_bf16 v129, v23, v23
    v_dot2c_f32_bf16 v128, v24, v124
    v_dot2c_f32_bf16 v129, v24, v24
    v_dot2c_f32_bf16 v128, v25, v124
    v_dot2c_f32_bf16 v129, v25, v25
    v_dot2c_f32_bf16 v128, v26, v124
    v_dot2c_f32_bf16 v129, v26, v26
    v_dot2c_f32_bf16 v128, v27, v124
    v_dot2c_f32_bf16 v129, v27, v27
    v_dot2c_f32_bf16 v128, v28, v124
    v_dot2c_f32_bf16 v129, v28, v28
    v_dot2c_f32_bf16 v128, v29, v124
    v_dot2c_f32_bf16 v129, v29, v29
    v_dot2c_f32_bf16 v128, v30, v124
    v_dot2c_f32_bf16 v129, v30, v30
    v_dot2c_f32_bf16 v128, v31, v124
    v_dot2c_f32_bf16 v129, v31, v31
    v_dot2c_f32_bf16 v128, v32, v124
    v_dot2c_f32_bf16 v129, v32, v32
    v_dot2c_f32_bf16 v128, v33, v124
    v_dot2c_f32_bf16 v129, v33, v33
    v_dot2c_f32_bf16 v128, v34, v124
    v_dot2c_f32_bf16 v129, v34, v34
    v_dot2c_f32_bf16 v128, v35, v124
    v_dot2c_f32_bf16 v129, v35, v35
    v_dot2c_f32_bf16 v128, v36, v124
    v_dot2c_f32_bf16 v129, v36, v36
    v_dot2c_f32_bf16 v128, v37, v124
    v_dot2c_f32_bf16 v129, v37, v37
    v_dot2c_f32_bf16 v128, v38, v124
    v_dot2c_f32_bf16 v129, v38, v38
    v_dot2c_f32_bf16 v128, v39, v124
    v_dot2c_f32_bf16 v129, v39, v39
    v_dot2c_f32_bf16 v128, v40, v124
    v_dot2c_f32_bf16 v129, v40, v40
    v_dot2c_f32_bf16 v128, v41, v124
    v_dot2c_f32_bf16 v129, v41, v41
    v_dot2c_f32_bf16 v128, v42, v124
    v_dot2c_f32_bf16 v129, v42, v42
    v_dot2c_f32_bf16 v128, v43, v124
    v_dot2c_f32_bf16 v129, v43, v43
    v_dot2c_f32_bf16 v128, v44, v124
    v_dot2c_f32_bf16 v129, v44, v44
    v_dot2c_f32_bf16 v128, v45, v124
    v_dot2c_f32_bf16 v129, v45, v45
    v_dot2c_f32_bf16 v128, v46, v124
    v_dot2c_f32_bf16 v129, v46, v46
    v_dot2c_f32_bf16 v128, v47, v124
    v_dot2c_f32_bf16 v129, v47, v47
    v_dot2c_f32_bf16 v128, v48, v124
    v_dot2c_f32_bf16 v129, v48, v48
    v_dot2c_f32_bf16 v128, v49, v124
    v_dot2c_f32_bf16 v129, v49, v49
    v_dot2c_f32_bf16 v128, v50, v124
    v_dot2c_f32_bf16 v129, v50, v50
    v_dot2c_f32_bf16 v128, v51, v124
    v_dot2c_f32_bf16 v129, v51, v51
    v_dot2c_f32_bf16 v128, v52, v124
    v_dot2c_f32_bf16 v129, v52, v52
    v_dot2c_f32_bf16 v128, v53, v124
    v_dot2c_f32_bf16 v129, v53, v53
    v_dot2c_f32_bf16 v128, v54, v124
    v_dot2c_f32_bf16 v129, v54, v54
    v_dot2c_f32_bf16 v128, v55, v124
    v_dot2c_f32_bf16 v129, v55, v55
    s_nop 1
    v_mov_b32 v132, v128
    s_nop 1
    v_permlane16_swap_b32 v132, v128
    v_add_f32 v128, v128, v132
    v_mov_b32 v132, v128
    s_nop 1
    v_permlane32_swap_b32 v132, v128
    v_add_f32 v128, v128, v132
    v_mov_b32 v132, v129
    s_nop 1
    v_permlane16_swap_b32 v132, v129
    v_add_f32 v129, v129, v132
    v_mov_b32 v132, v129
    s_nop 1
    v_permlane32_swap_b32 v132, v129
    v_add_f32 v129, v129, v132
    s_lshl_b32 s80, s77, 2
    s_add_u32 s80, s80, s78
    s_lshl_b32 s80, s80, 7
    s_add_u32 s80, s80, 162432
    v_lshl_add_u32 v132, v1, 3, s80
    ds_write_b64 v132, v[128:129]
    s_waitcnt vmcnt(5)
    s_barrier
    s_branch L_q
L_auxb:
    s_waitcnt vmcnt(0)
    ds_read_b128 v[16:19], v241 offset:0
    ds_read_b128 v[20:23], v242 offset:0
    ds_read_b128 v[24:27], v241 offset:1024
    ds_read_b128 v[28:31], v242 offset:1024
    ds_read_b128 v[32:35], v241 offset:2048
    ds_read_b128 v[36:39], v243 offset:0
    ds_read_b128 v[40:43], v244 offset:0
    ds_read_b128 v[44:47], v243 offset:1024
    ds_read_b128 v[48:51], v244 offset:1024
    ds_read_b128 v[52:55], v243 offset:2048
    s_waitcnt lgkmcnt(0)
    v_dot2c_f32_bf16 v128, v16, v124
    v_dot2c_f32_bf16 v129, v16, v16
    v_dot2c_f32_bf16 v128, v17, v124
    v_dot2c_f32_bf16 v129, v17, v17
    v_dot2c_f32_bf16 v128, v18, v124
    v_dot2c_f32_bf16 v129, v18, v18
    v_dot2c_f32_bf16 v128, v19, v124
    v_dot2c_f32_bf16 v129, v19, v19
    v_dot2c_f32_bf16 v128, v20, v124
    v_dot2c_f32_bf16 v129, v20, v20
    v_dot2c_f32_bf16 v128, v21, v124
    v_dot2c_f32_bf16 v129, v21, v21
    v_dot2c_f32_bf16 v128, v22, v124
    v_dot2c_f32_bf16 v129, v22, v22
    v_dot2c_f32_bf16 v128, v23, v124
    v_dot2c_f32_bf16 v129, v23, v23
    v_dot2c_f32_bf16 v128, v24, v124
    v_dot2c_f32_bf16 v129, v24, v24
    v_dot2c_f32_bf16 v128, v25, v124
    v_dot2c_f32_bf16 v129, v25, v25
    v_dot2c_f32_bf16 v128, v26, v124
    v_dot2c_f32_bf16 v129, v26, v26
    v_dot2c_f32_bf16 v128, v27, v124
    v_dot2c_f32_bf16 v129, v27, v27
    v_dot2c_f32_bf16 v128, v28, v124
    v_dot2c_f32_bf16 v129, v28, v28
    v_dot2c_f32_bf16 v128, v29, v124
    v_dot2c_f32_bf16 v129, v29, v29
    v_dot2c_f32_bf16 v128, v30, v124
    v_dot2c_f32_bf16 v129, v30, v30
    v_dot2c_f32_bf16 v128, v31, v124
    v_dot2c_f32_bf16 v129, v31, v31
    v_dot2c_f32_bf16 v128, v32, v124
    v_dot2c_f32_bf16 v129, v32, v32
    v_dot2c_f32_bf16 v128, v33, v124
    v_dot2c_f32_bf16 v129, v33, v33
    v_dot2c_f32_bf16 v128, v34, v124
    v_dot2c_f32_bf16 v129, v34, v34
    v_dot2c_f32_bf16 v128, v35, v124
    v_dot2c_f32_bf16 v129, v35, v35
    v_dot2c_f32_bf16 v128, v36, v124
    v_dot2c_f32_bf16 v129, v36, v36
    v_dot2c_f32_bf16 v128, v37, v124
    v_dot2c_f32_bf16 v129, v37, v37
    v_dot2c_f32_bf16 v128, v38, v124
    v_dot2c_f32_bf16 v129, v38, v38
    v_dot2c_f32_bf16 v128, v39, v124
    v_dot2c_f32_bf16 v129, v39, v39
    v_dot2c_f32_bf16 v128, v40, v124
    v_dot2c_f32_bf16 v129, v40, v40
    v_dot2c_f32_bf16 v128, v41, v124
    v_dot2c_f32_bf16 v129, v41, v41
    v_dot2c_f32_bf16 v128, v42, v124
    v_dot2c_f32_bf16 v129, v42, v42
    v_dot2c_f32_bf16 v128, v43, v124
    v_dot2c_f32_bf16 v129, v43, v43
    v_dot2c_f32_bf16 v128, v44, v124
    v_dot2c_f32_bf16 v129, v44, v44
    v_dot2c_f32_bf16 v128, v45, v124
    v_dot2c_f32_bf16 v129, v45, v45
    v_dot2c_f32_bf16 v128, v46, v124
    v_dot2c_f32_bf16 v129, v46, v46
    v_dot2c_f32_bf16 v128, v47, v124
    v_dot2c_f32_bf16 v129, v47, v47
    v_dot2c_f32_bf16 v128, v48, v124
    v_dot2c_f32_bf16 v129, v48, v48
    v_dot2c_f32_bf16 v128, v49, v124
    v_dot2c_f32_bf16 v129, v49, v49
    v_dot2c_f32_bf16 v128, v50, v124
    v_dot2c_f32_bf16 v129, v50, v50
    v_dot2c_f32_bf16 v128, v51, v124
    v_dot2c_f32_bf16 v129, v51, v51
    v_dot2c_f32_bf16 v128, v52, v124
    v_dot2c_f32_bf16 v129, v52, v52
    v_dot2c_f32_bf16 v128, v53, v124
    v_dot2c_f32_bf16 v129, v53, v53
    v_dot2c_f32_bf16 v128, v54, v124
    v_dot2c_f32_bf16 v129, v54, v54
    v_dot2c_f32_bf16 v128, v55, v124
    v_dot2c_f32_bf16 v129, v55, v55
    s_nop 1
    v_mov_b32 v132, v128
    s_nop 1
    v_permlane16_swap_b32 v132, v128
    v_add_f32 v128, v128, v132
    v_mov_b32 v132, v128
    s_nop 1
    v_permlane32_swap_b32 v132, v128
    v_add_f32 v128, v128, v132
    v_mov_b32 v132, v129
    s_nop 1
    v_permlane16_swap_b32 v132, v129
    v_add_f32 v129, v129, v132
    v_mov_b32 v132, v129
    s_nop 1
    v_permlane32_swap_b32 v132, v129
    v_add_f32 v129, v129, v132
    s_lshl_b32 s80, s77, 2
    s_add_u32 s80, s80, s78
    s_lshl_b32 s80, s80, 7
    s_add_u32 s80, s80, 162432
    v_lshl_add_u32 v132, v1, 3, s80
    ds_write_b64 v132, v[128:129]
    s_barrier
    s_branch L_q
L_kv:
    v_lshrrev_b32 v5, 2, v1
    v_lshl_add_u32 v5, v2, 3, v5
    v_mul_u32_u24 v5, 40, v5
    v_and_b32 v6, 3, v0
    v_lshl_add_u32 v5, v6, 3, v5
    s_lshl_b32 s83, s77, 5
    s_add_u32 s83, s83, 133632
    v_add_u32 v5, s83, v5
    s_mul_i32 s84, s75, 6400
    v_add_u32 v248, s84, v5
    s_xor_b32 s83, s75, 1
    s_mul_i32 s84, s83, 6400
    v_add_u32 v249, s84, v5
    s_lshl_b32 s83, s77, 6
    s_sub_u32 s83, 32, s83
    v_add_u32 v250, s83, v248
    v_add_u32 v251, s83, v249
    s_mul_i32 s83, s77, 20608
    s_sub_u32 s83, 10304, s83
    v_add_u32 v114, s82, v3
    v_add_u32 v13, s83, v114
    s_lshl_b32 s83, s77, 3
    v_add_u32 v110, s83, v15
    v_xor_b32 v111, 8, v110
    v_mov_b32 v252, 0
    v_mov_b32 v112, 1
    s_lshl_b32 s81, s73, 1
    s_lshr_b32 s83, s78, 1
    s_add_u32 s81, s81, s83
    s_mul_i32 s81, s81, 2560
    s_add_u32 s81, s81, 16384
    s_and_b32 s83, s78, 1
    v_and_b32 v6, 1, v2
    v_lshrrev_b32 v132, 1, v2
    s_cmp_lt_u32 s72, 4
    s_cbranch_scc0 L_va
    s_lshl_b32 s83, s83, 4
    v_add_u32 v5, s83, v1
    v_lshl_add_u32 v132, v132, 5, v5
    v_lshlrev_b32 v132, 4, v132
    v_lshl_add_u32 v132, v6, 3, v132
    v_lshlrev_b32 v5, 3, v5
    v_add_u32 v5, 1024, v5
    v_mov_b32 v6, 0x7ffffff0
    v_cmp_eq_u32 vcc, 0, v2
    s_nop 1
    v_cndmask_b32 v5, v6, v5, vcc
    s_cmp_eq_u32 s77, 0
    s_cselect_b64 vcc, -1, 0
    v_cndmask_b32 v5, v5, v132, vcc
    s_branch L_kva
L_va:
    s_mul_i32 s83, s83, 640
    s_add_u32 s81, s81, s83
    s_add_u32 s81, s81, 1280
    v_lshlrev_b32 v5, 2, v6
    v_xor_b32 v133, v1, v5
    v_lshl_add_u32 v133, v6, 4, v133
    v_add3_u32 v5, v5, v1, 32
    v_mov_b32 v6, 0x07ffffff
    v_cmp_gt_u32 vcc, 4, v1
    s_nop 1
    v_cndmask_b32 v5, v6, v5, vcc
    s_cmp_eq_u32 s77, 0
    s_cselect_b64 vcc, -1, 0
    v_cndmask_b32 v5, v5, v133, vcc
    v_lshlrev_b32 v5, 4, v5
    v_lshl_add_u32 v5, v132, 3, v5
L_kva:
    s_lshl_b32 s84, s78, 7
    s_add_u32 s84, s84, 162432
    v_lshl_add_u32 v108, v1, 3, s84
    v_lshl_add_u32 v109, v2, 5, s84
    s_movk_i32 s85, 0x7fff
    s_waitcnt vmcnt(13)
    ds_read_b128 v[16:19], v241 offset:0
    ds_read_b128 v[20:23], v242 offset:0
    ds_read_b128 v[24:27], v241 offset:1024
    ds_read_b128 v[28:31], v242 offset:1024
    ds_read_b128 v[32:35], v241 offset:2048
    ds_read_b128 v[36:39], v243 offset:0
    ds_read_b128 v[40:43], v244 offset:0
    ds_read_b128 v[44:47], v243 offset:1024
    ds_read_b128 v[48:51], v244 offset:1024
    ds_read_b128 v[52:55], v243 offset:2048
    s_waitcnt lgkmcnt(9)
    v_dot2c_f32_bf16 v128, v16, v124
    v_dot2c_f32_bf16 v129, v16, v16
    v_dot2c_f32_bf16 v128, v17, v124
    v_dot2c_f32_bf16 v129, v17, v17
    v_dot2c_f32_bf16 v128, v18, v124
    v_dot2c_f32_bf16 v129, v18, v18
    v_dot2c_f32_bf16 v128, v19, v124
    v_dot2c_f32_bf16 v129, v19, v19
    s_waitcnt lgkmcnt(8)
    v_dot2c_f32_bf16 v128, v20, v124
    v_dot2c_f32_bf16 v129, v20, v20
    v_dot2c_f32_bf16 v128, v21, v124
    v_dot2c_f32_bf16 v129, v21, v21
    v_dot2c_f32_bf16 v128, v22, v124
    v_dot2c_f32_bf16 v129, v22, v22
    v_dot2c_f32_bf16 v128, v23, v124
    v_dot2c_f32_bf16 v129, v23, v23
    s_waitcnt lgkmcnt(7)
    v_dot2c_f32_bf16 v128, v24, v124
    v_dot2c_f32_bf16 v129, v24, v24
    v_dot2c_f32_bf16 v128, v25, v124
    v_dot2c_f32_bf16 v129, v25, v25
    v_dot2c_f32_bf16 v128, v26, v124
    v_dot2c_f32_bf16 v129, v26, v26
    v_dot2c_f32_bf16 v128, v27, v124
    v_dot2c_f32_bf16 v129, v27, v27
    s_waitcnt lgkmcnt(6)
    v_dot2c_f32_bf16 v128, v28, v124
    v_dot2c_f32_bf16 v129, v28, v28
    v_dot2c_f32_bf16 v128, v29, v124
    v_dot2c_f32_bf16 v129, v29, v29
    v_dot2c_f32_bf16 v128, v30, v124
    v_dot2c_f32_bf16 v129, v30, v30
    v_dot2c_f32_bf16 v128, v31, v124
    v_dot2c_f32_bf16 v129, v31, v31
    s_waitcnt lgkmcnt(5)
    v_dot2c_f32_bf16 v128, v32, v124
    v_dot2c_f32_bf16 v129, v32, v32
    v_dot2c_f32_bf16 v128, v33, v124
    v_dot2c_f32_bf16 v129, v33, v33
    v_dot2c_f32_bf16 v128, v34, v124
    v_dot2c_f32_bf16 v129, v34, v34
    v_dot2c_f32_bf16 v128, v35, v124
    v_dot2c_f32_bf16 v129, v35, v35
    s_waitcnt lgkmcnt(4)
    v_dot2c_f32_bf16 v128, v36, v124
    v_dot2c_f32_bf16 v129, v36, v36
    v_dot2c_f32_bf16 v128, v37, v124
    v_dot2c_f32_bf16 v129, v37, v37
    v_dot2c_f32_bf16 v128, v38, v124
    v_dot2c_f32_bf16 v129, v38, v38
    v_dot2c_f32_bf16 v128, v39, v124
    v_dot2c_f32_bf16 v129, v39, v39
    s_waitcnt lgkmcnt(3)
    v_dot2c_f32_bf16 v128, v40, v124
    v_dot2c_f32_bf16 v129, v40, v40
    v_dot2c_f32_bf16 v128, v41, v124
    v_dot2c_f32_bf16 v129, v41, v41
    v_dot2c_f32_bf16 v128, v42, v124
    v_dot2c_f32_bf16 v129, v42, v42
    v_dot2c_f32_bf16 v128, v43, v124
    v_dot2c_f32_bf16 v129, v43, v43
    s_waitcnt lgkmcnt(2)
    v_dot2c_f32_bf16 v128, v44, v124
    v_dot2c_f32_bf16 v129, v44, v44
    v_dot2c_f32_bf16 v128, v45, v124
    v_dot2c_f32_bf16 v129, v45, v45
    v_dot2c_f32_bf16 v128, v46, v124
    v_dot2c_f32_bf16 v129, v46, v46
    v_dot2c_f32_bf16 v128, v47, v124
    v_dot2c_f32_bf16 v129, v47, v47
    s_waitcnt lgkmcnt(1)
    v_dot2c_f32_bf16 v128, v48, v124
    v_dot2c_f32_bf16 v129, v48, v48
    v_dot2c_f32_bf16 v128, v49, v124
    v_dot2c_f32_bf16 v129, v49, v49
    v_dot2c_f32_bf16 v128, v50, v124
    v_dot2c_f32_bf16 v129, v50, v50
    v_dot2c_f32_bf16 v128, v51, v124
    v_dot2c_f32_bf16 v129, v51, v51
    s_waitcnt lgkmcnt(0)
    v_dot2c_f32_bf16 v128, v52, v124
    v_dot2c_f32_bf16 v129, v52, v52
    v_dot2c_f32_bf16 v128, v53, v124
    v_dot2c_f32_bf16 v129, v53, v53
    v_dot2c_f32_bf16 v128, v54, v124
    v_dot2c_f32_bf16 v129, v54, v54
    v_dot2c_f32_bf16 v128, v55, v124
    v_dot2c_f32_bf16 v129, v55, v55
    s_nop 1
    v_mov_b32 v132, v128
    s_nop 1
    v_permlane16_swap_b32 v132, v128
    v_add_f32 v128, v128, v132
    v_mov_b32 v132, v128
    s_nop 1
    v_permlane32_swap_b32 v132, v128
    v_add_f32 v128, v128, v132
    v_mov_b32 v132, v129
    s_nop 1
    v_permlane16_swap_b32 v132, v129
    v_add_f32 v129, v129, v132
    v_mov_b32 v132, v129
    s_nop 1
    v_permlane32_swap_b32 v132, v129
    v_add_f32 v129, v129, v132
    s_lshl_b32 s80, s77, 2
    s_add_u32 s80, s80, s78
    s_lshl_b32 s80, s80, 7
    s_add_u32 s80, s80, 162432
    v_lshl_add_u32 v132, v1, 3, s80
    ds_write_b64 v132, v[128:129]
    ds_write_b32 v110, v112 offset:4
    v_mov_b32 v112, 2
    s_waitcnt vmcnt(0)
    ds_read_b64_tr_b16 v[208:209], v248 offset:0
    ds_read_b64_tr_b16 v[210:211], v248 offset:160
    ds_read_b64_tr_b16 v[212:213], v250 offset:0
    ds_read_b64_tr_b16 v[214:215], v250 offset:160
    ds_read_b64_tr_b16 v[216:217], v248 offset:1280
    ds_read_b64_tr_b16 v[218:219], v248 offset:1440
    ds_read_b64_tr_b16 v[220:221], v250 offset:1280
    ds_read_b64_tr_b16 v[222:223], v250 offset:1440
    ds_read_b64_tr_b16 v[224:225], v248 offset:2560
    ds_read_b64_tr_b16 v[226:227], v248 offset:2720
    ds_read_b64_tr_b16 v[228:229], v250 offset:2560
    ds_read_b64_tr_b16 v[230:231], v250 offset:2720
    s_cmp_lt_u32 s72, 4
    s_cbranch_scc0 L_v
    s_waitcnt lgkmcnt(10)
    v_mfma_f32_16x16x32_bf16 v[96:99], v[208:211], v[16:19], 0
    v_mfma_f32_16x16x32_bf16 v[116:119], v[208:211], v[124:127], 0
    s_waitcnt lgkmcnt(8)
    v_mfma_f32_16x16x32_bf16 v[100:103], v[212:215], v[16:19], 0
    v_mfma_f32_16x16x32_bf16 v[120:123], v[212:215], v[124:127], 0
    ds_read_b64_tr_b16 v[232:233], v248 offset:3840
    ds_read_b64_tr_b16 v[234:235], v248 offset:4000
    ds_read_b64_tr_b16 v[236:237], v250 offset:3840
    ds_read_b64_tr_b16 v[238:239], v250 offset:4000
    s_waitcnt lgkmcnt(10)
    v_mfma_f32_16x16x32_bf16 v[96:99], v[216:219], v[20:23], v[96:99]
    v_mfma_f32_16x16x32_bf16 v[116:119], v[216:219], v[124:127], v[116:119]
    s_waitcnt lgkmcnt(8)
    v_mfma_f32_16x16x32_bf16 v[100:103], v[220:223], v[20:23], v[100:103]
    v_mfma_f32_16x16x32_bf16 v[120:123], v[220:223], v[124:127], v[120:123]
    ds_read_b64_tr_b16 v[208:209], v248 offset:5120
    ds_read_b64_tr_b16 v[210:211], v248 offset:5280
    ds_read_b64_tr_b16 v[212:213], v250 offset:5120
    ds_read_b64_tr_b16 v[214:215], v250 offset:5280
    s_waitcnt lgkmcnt(10)
    v_mfma_f32_16x16x32_bf16 v[96:99], v[224:227], v[24:27], v[96:99]
    v_mfma_f32_16x16x32_bf16 v[116:119], v[224:227], v[124:127], v[116:119]
    s_waitcnt lgkmcnt(8)
    v_mfma_f32_16x16x32_bf16 v[100:103], v[228:231], v[24:27], v[100:103]
    v_mfma_f32_16x16x32_bf16 v[120:123], v[228:231], v[124:127], v[120:123]
    ds_read_b64_tr_b16 v[216:217], v249 offset:0
    ds_read_b64_tr_b16 v[218:219], v249 offset:160
    ds_read_b64_tr_b16 v[220:221], v251 offset:0
    ds_read_b64_tr_b16 v[222:223], v251 offset:160
    s_waitcnt lgkmcnt(10)
    v_mfma_f32_16x16x32_bf16 v[96:99], v[232:235], v[28:31], v[96:99]
    v_mfma_f32_16x16x32_bf16 v[116:119], v[232:235], v[124:127], v[116:119]
    s_waitcnt lgkmcnt(8)
    v_mfma_f32_16x16x32_bf16 v[100:103], v[236:239], v[28:31], v[100:103]
    v_mfma_f32_16x16x32_bf16 v[120:123], v[236:239], v[124:127], v[120:123]
    ds_read_b64_tr_b16 v[224:225], v249 offset:1280
    ds_read_b64_tr_b16 v[226:227], v249 offset:1440
    ds_read_b64_tr_b16 v[228:229], v251 offset:1280
    ds_read_b64_tr_b16 v[230:231], v251 offset:1440
    s_waitcnt lgkmcnt(10)
    v_mfma_f32_16x16x32_bf16 v[96:99], v[208:211], v[32:35], v[96:99]
    v_mfma_f32_16x16x32_bf16 v[116:119], v[208:211], v[124:127], v[116:119]
    s_waitcnt lgkmcnt(8)
    v_mfma_f32_16x16x32_bf16 v[100:103], v[212:215], v[32:35], v[100:103]
    v_mfma_f32_16x16x32_bf16 v[120:123], v[212:215], v[124:127], v[120:123]
    ds_read_b64_tr_b16 v[232:233], v249 offset:2560
    ds_read_b64_tr_b16 v[234:235], v249 offset:2720
    ds_read_b64_tr_b16 v[236:237], v251 offset:2560
    ds_read_b64_tr_b16 v[238:239], v251 offset:2720
    s_waitcnt lgkmcnt(10)
    v_mfma_f32_16x16x32_bf16 v[96:99], v[216:219], v[36:39], v[96:99]
    v_mfma_f32_16x16x32_bf16 v[116:119], v[216:219], v[124:127], v[116:119]
    s_waitcnt lgkmcnt(8)
    v_mfma_f32_16x16x32_bf16 v[100:103], v[220:223], v[36:39], v[100:103]
    v_mfma_f32_16x16x32_bf16 v[120:123], v[220:223], v[124:127], v[120:123]
    ds_read_b64_tr_b16 v[208:209], v249 offset:3840
    ds_read_b64_tr_b16 v[210:211], v249 offset:4000
    ds_read_b64_tr_b16 v[212:213], v251 offset:3840
    ds_read_b64_tr_b16 v[214:215], v251 offset:4000
    s_waitcnt lgkmcnt(10)
    v_mfma_f32_16x16x32_bf16 v[96:99], v[224:227], v[40:43], v[96:99]
    v_mfma_f32_16x16x32_bf16 v[116:119], v[224:227], v[124:127], v[116:119]
    s_waitcnt lgkmcnt(8)
    v_mfma_f32_16x16x32_bf16 v[100:103], v[228:231], v[40:43], v[100:103]
    v_mfma_f32_16x16x32_bf16 v[120:123], v[228:231], v[124:127], v[120:123]
    ds_read_b64_tr_b16 v[216:217], v249 offset:5120
    ds_read_b64_tr_b16 v[218:219], v249 offset:5280
    ds_read_b64_tr_b16 v[220:221], v251 offset:5120
    ds_read_b64_tr_b16 v[222:223], v251 offset:5280
    s_waitcnt lgkmcnt(10)
    v_mfma_f32_16x16x32_bf16 v[96:99], v[232:235], v[44:47], v[96:99]
    v_mfma_f32_16x16x32_bf16 v[116:119], v[232:235], v[124:127], v[116:119]
    s_waitcnt lgkmcnt(8)
    v_mfma_f32_16x16x32_bf16 v[100:103], v[236:239], v[44:47], v[100:103]
    v_mfma_f32_16x16x32_bf16 v[120:123], v[236:239], v[124:127], v[120:123]
    ds_read_b32 v113, v111 offset:4
    ds_read_b64 v[64:65], v108
    ds_read_b64 v[72:73], v108 offset:512
    s_waitcnt lgkmcnt(9)
    v_mfma_f32_16x16x32_bf16 v[96:99], v[208:211], v[48:51], v[96:99]
    v_mfma_f32_16x16x32_bf16 v[116:119], v[208:211], v[124:127], v[116:119]
    s_waitcnt lgkmcnt(7)
    v_mfma_f32_16x16x32_bf16 v[100:103], v[212:215], v[48:51], v[100:103]
    v_mfma_f32_16x16x32_bf16 v[120:123], v[212:215], v[124:127], v[120:123]
    s_waitcnt lgkmcnt(3)
    v_mfma_f32_16x16x32_bf16 v[100:103], v[220:223], v[52:55], v[100:103]
    v_mfma_f32_16x16x32_bf16 v[120:123], v[220:223], v[124:127], v[120:123]
    v_mfma_f32_16x16x32_bf16 v[96:99], v[216:219], v[52:55], v[96:99]
    v_mfma_f32_16x16x32_bf16 v[116:119], v[216:219], v[124:127], v[116:119]
    s_branch L_f1b0
L_f10:
    ds_read_b32 v113, v111 offset:4
    ds_read_b64 v[64:65], v108
    ds_read_b64 v[72:73], v108 offset:512
L_f1b0:
    s_sub_u32 s85, s85, 1
    s_waitcnt lgkmcnt(0)
    s_cbranch_scc1 L_f1d0
    v_cmp_le_u32 vcc, 1, v113
    s_nop 3
    s_cbranch_vccz L_f10
L_f1d0:
    v_pk_add_f32 v[64:65], v[64:65], v[72:73]
    ds_write_b128 v114, v[100:103]
    ds_write_b128 v114, v[120:123] offset:1024
    ds_write_b32 v110, v112 offset:4
    v_mul_f32 v72, 0x3acccccd, v64
    v_mul_f32 v80, 0x3acccccd, v65
    v_fma_f32 v80, -v72, v72, v80
    v_max_f32 v80, 0, v80
    v_add_f32 v80, 0x3727c5ac, v80
    v_rsq_f32 v73, v80
L_f20:
    ds_read_b32 v113, v111 offset:4
    ds_read_b128 v[56:59], v13
    ds_read_b128 v[60:63], v13 offset:1024
    s_sub_u32 s85, s85, 1
    s_waitcnt lgkmcnt(0)
    s_cbranch_scc1 L_f20d
    v_cmp_le_u32 vcc, 2, v113
    s_nop 3
    s_cbranch_vccz L_f20
L_f20d:
    v_pk_add_f32 v[116:117], v[116:117], v[60:61]
    v_pk_add_f32 v[118:119], v[118:119], v[62:63]
    v_pk_add_f32 v[96:97], v[96:97], v[56:57]
    v_pk_add_f32 v[98:99], v[98:99], v[58:59]
    v_fma_f32 v96, -v72, v116, v96
    v_fma_f32 v97, -v72, v117, v97
    v_fma_f32 v98, -v72, v118, v98
    v_fma_f32 v99, -v72, v119, v99
    v_mul_f32 v96, v73, v96
    v_mul_f32 v97, v73, v97
    v_mul_f32 v98, v73, v98
    v_mul_f32 v99, v73, v99
    s_branch L_kvst
L_v:
    s_waitcnt lgkmcnt(10)
    v_mfma_f32_16x16x32_bf16 v[96:99], v[16:19], v[208:211], 0
    v_mfma_f32_16x16x32_bf16 v[116:119], v[124:127], v[208:211], 0
    s_waitcnt lgkmcnt(8)
    v_mfma_f32_16x16x32_bf16 v[100:103], v[16:19], v[212:215], 0
    v_mfma_f32_16x16x32_bf16 v[120:123], v[124:127], v[212:215], 0
    ds_read_b64_tr_b16 v[232:233], v248 offset:3840
    ds_read_b64_tr_b16 v[234:235], v248 offset:4000
    ds_read_b64_tr_b16 v[236:237], v250 offset:3840
    ds_read_b64_tr_b16 v[238:239], v250 offset:4000
    s_waitcnt lgkmcnt(10)
    v_mfma_f32_16x16x32_bf16 v[96:99], v[20:23], v[216:219], v[96:99]
    v_mfma_f32_16x16x32_bf16 v[116:119], v[124:127], v[216:219], v[116:119]
    s_waitcnt lgkmcnt(8)
    v_mfma_f32_16x16x32_bf16 v[100:103], v[20:23], v[220:223], v[100:103]
    v_mfma_f32_16x16x32_bf16 v[120:123], v[124:127], v[220:223], v[120:123]
    ds_read_b64_tr_b16 v[208:209], v248 offset:5120
    ds_read_b64_tr_b16 v[210:211], v248 offset:5280
    ds_read_b64_tr_b16 v[212:213], v250 offset:5120
    ds_read_b64_tr_b16 v[214:215], v250 offset:5280
    s_waitcnt lgkmcnt(10)
    v_mfma_f32_16x16x32_bf16 v[96:99], v[24:27], v[224:227], v[96:99]
    v_mfma_f32_16x16x32_bf16 v[116:119], v[124:127], v[224:227], v[116:119]
    s_waitcnt lgkmcnt(8)
    v_mfma_f32_16x16x32_bf16 v[100:103], v[24:27], v[228:231], v[100:103]
    v_mfma_f32_16x16x32_bf16 v[120:123], v[124:127], v[228:231], v[120:123]
    ds_read_b64_tr_b16 v[216:217], v249 offset:0
    ds_read_b64_tr_b16 v[218:219], v249 offset:160
    ds_read_b64_tr_b16 v[220:221], v251 offset:0
    ds_read_b64_tr_b16 v[222:223], v251 offset:160
    s_waitcnt lgkmcnt(10)
    v_mfma_f32_16x16x32_bf16 v[96:99], v[28:31], v[232:235], v[96:99]
    v_mfma_f32_16x16x32_bf16 v[116:119], v[124:127], v[232:235], v[116:119]
    s_waitcnt lgkmcnt(8)
    v_mfma_f32_16x16x32_bf16 v[100:103], v[28:31], v[236:239], v[100:103]
    v_mfma_f32_16x16x32_bf16 v[120:123], v[124:127], v[236:239], v[120:123]
    ds_read_b64_tr_b16 v[224:225], v249 offset:1280
    ds_read_b64_tr_b16 v[226:227], v249 offset:1440
    ds_read_b64_tr_b16 v[228:229], v251 offset:1280
    ds_read_b64_tr_b16 v[230:231], v251 offset:1440
    s_waitcnt lgkmcnt(10)
    v_mfma_f32_16x16x32_bf16 v[96:99], v[32:35], v[208:211], v[96:99]
    v_mfma_f32_16x16x32_bf16 v[116:119], v[124:127], v[208:211], v[116:119]
    s_waitcnt lgkmcnt(8)
    v_mfma_f32_16x16x32_bf16 v[100:103], v[32:35], v[212:215], v[100:103]
    v_mfma_f32_16x16x32_bf16 v[120:123], v[124:127], v[212:215], v[120:123]
    ds_read_b64_tr_b16 v[232:233], v249 offset:2560
    ds_read_b64_tr_b16 v[234:235], v249 offset:2720
    ds_read_b64_tr_b16 v[236:237], v251 offset:2560
    ds_read_b64_tr_b16 v[238:239], v251 offset:2720
    s_waitcnt lgkmcnt(10)
    v_mfma_f32_16x16x32_bf16 v[96:99], v[36:39], v[216:219], v[96:99]
    v_mfma_f32_16x16x32_bf16 v[116:119], v[124:127], v[216:219], v[116:119]
    s_waitcnt lgkmcnt(8)
    v_mfma_f32_16x16x32_bf16 v[100:103], v[36:39], v[220:223], v[100:103]
    v_mfma_f32_16x16x32_bf16 v[120:123], v[124:127], v[220:223], v[120:123]
    ds_read_b64_tr_b16 v[208:209], v249 offset:3840
    ds_read_b64_tr_b16 v[210:211], v249 offset:4000
    ds_read_b64_tr_b16 v[212:213], v251 offset:3840
    ds_read_b64_tr_b16 v[214:215], v251 offset:4000
    s_waitcnt lgkmcnt(10)
    v_mfma_f32_16x16x32_bf16 v[96:99], v[40:43], v[224:227], v[96:99]
    v_mfma_f32_16x16x32_bf16 v[116:119], v[124:127], v[224:227], v[116:119]
    s_waitcnt lgkmcnt(8)
    v_mfma_f32_16x16x32_bf16 v[100:103], v[40:43], v[228:231], v[100:103]
    v_mfma_f32_16x16x32_bf16 v[120:123], v[124:127], v[228:231], v[120:123]
    ds_read_b64_tr_b16 v[216:217], v249 offset:5120
    ds_read_b64_tr_b16 v[218:219], v249 offset:5280
    ds_read_b64_tr_b16 v[220:221], v251 offset:5120
    ds_read_b64_tr_b16 v[222:223], v251 offset:5280
    s_waitcnt lgkmcnt(10)
    v_mfma_f32_16x16x32_bf16 v[96:99], v[44:47], v[232:235], v[96:99]
    v_mfma_f32_16x16x32_bf16 v[116:119], v[124:127], v[232:235], v[116:119]
    s_waitcnt lgkmcnt(8)
    v_mfma_f32_16x16x32_bf16 v[100:103], v[44:47], v[236:239], v[100:103]
    v_mfma_f32_16x16x32_bf16 v[120:123], v[124:127], v[236:239], v[120:123]
    ds_read_b32 v113, v111 offset:4
    ds_read_b128 v[64:67], v109
    ds_read_b128 v[68:71], v109 offset:16
    ds_read_b128 v[72:75], v109 offset:512
    ds_read_b128 v[76:79], v109 offset:528
    s_waitcnt lgkmcnt(11)
    v_mfma_f32_16x16x32_bf16 v[96:99], v[48:51], v[208:211], v[96:99]
    v_mfma_f32_16x16x32_bf16 v[116:119], v[124:127], v[208:211], v[116:119]
    s_waitcnt lgkmcnt(9)
    v_mfma_f32_16x16x32_bf16 v[100:103], v[48:51], v[212:215], v[100:103]
    v_mfma_f32_16x16x32_bf16 v[120:123], v[124:127], v[212:215], v[120:123]
    s_waitcnt lgkmcnt(5)
    v_mfma_f32_16x16x32_bf16 v[100:103], v[52:55], v[220:223], v[100:103]
    v_mfma_f32_16x16x32_bf16 v[120:123], v[124:127], v[220:223], v[120:123]
    v_mfma_f32_16x16x32_bf16 v[96:99], v[52:55], v[216:219], v[96:99]
    v_mfma_f32_16x16x32_bf16 v[116:119], v[124:127], v[216:219], v[116:119]
    s_branch L_f1b1
L_f11:
    ds_read_b32 v113, v111 offset:4
    ds_read_b128 v[64:67], v109
    ds_read_b128 v[68:71], v109 offset:16
    ds_read_b128 v[72:75], v109 offset:512
    ds_read_b128 v[76:79], v109 offset:528
L_f1b1:
    s_sub_u32 s85, s85, 1
    s_waitcnt lgkmcnt(0)
    s_cbranch_scc1 L_f1d1
    v_cmp_le_u32 vcc, 1, v113
    s_nop 3
    s_cbranch_vccz L_f11
L_f1d1:
    v_pk_add_f32 v[64:65], v[64:65], v[72:73]
    v_pk_add_f32 v[66:67], v[66:67], v[74:75]
    v_pk_add_f32 v[68:69], v[68:69], v[76:77]
    v_pk_add_f32 v[70:71], v[70:71], v[78:79]
    ds_write_b128 v114, v[100:103]
    ds_write_b128 v114, v[120:123] offset:1024
    ds_write_b32 v110, v112 offset:4
    v_mul_f32 v72, 0x3acccccd, v64
    v_mul_f32 v80, 0x3acccccd, v65
    v_fma_f32 v80, -v72, v72, v80
    v_max_f32 v80, 0, v80
    v_add_f32 v80, 0x3727c5ac, v80
    v_rsq_f32 v73, v80
    v_mul_f32 v74, 0x3acccccd, v66
    v_mul_f32 v81, 0x3acccccd, v67
    v_fma_f32 v81, -v74, v74, v81
    v_max_f32 v81, 0, v81
    v_add_f32 v81, 0x3727c5ac, v81
    v_rsq_f32 v75, v81
    v_mul_f32 v76, 0x3acccccd, v68
    v_mul_f32 v82, 0x3acccccd, v69
    v_fma_f32 v82, -v76, v76, v82
    v_max_f32 v82, 0, v82
    v_add_f32 v82, 0x3727c5ac, v82
    v_rsq_f32 v77, v82
    v_mul_f32 v78, 0x3acccccd, v70
    v_mul_f32 v83, 0x3acccccd, v71
    v_fma_f32 v83, -v78, v78, v83
    v_max_f32 v83, 0, v83
    v_add_f32 v83, 0x3727c5ac, v83
    v_rsq_f32 v79, v83
L_f21:
    ds_read_b32 v113, v111 offset:4
    ds_read_b128 v[56:59], v13
    ds_read_b128 v[60:63], v13 offset:1024
    s_sub_u32 s85, s85, 1
    s_waitcnt lgkmcnt(0)
    s_cbranch_scc1 L_f21d
    v_cmp_le_u32 vcc, 2, v113
    s_nop 3
    s_cbranch_vccz L_f21
L_f21d:
    v_pk_add_f32 v[116:117], v[116:117], v[60:61]
    v_pk_add_f32 v[118:119], v[118:119], v[62:63]
    v_pk_add_f32 v[96:97], v[96:97], v[56:57]
    v_pk_add_f32 v[98:99], v[98:99], v[58:59]
    v_fma_f32 v96, -v72, v116, v96
    v_fma_f32 v97, -v74, v117, v97
    v_fma_f32 v98, -v76, v118, v98
    v_fma_f32 v99, -v78, v119, v99
    v_mul_f32 v96, v73, v96
    v_mul_f32 v97, v75, v97
    v_mul_f32 v98, v77, v98
    v_mul_f32 v99, v79, v99
L_kvst:
    v_cvt_pk_bf16_f32 v96, v96, v97
    v_cvt_pk_bf16_f32 v97, v98, v99
    buffer_store_dwordx2 v[96:97], v5, s[64:67], s81 offen sc1
    buffer_load_dword v15, v7, s[60:63], 0 offen sc1
    s_lshl_b32 s80, s76, 3
    s_lshl_b64 s[82:83], 1, s80
    v_mov_b32 v110, s82
    v_mov_b32 v111, s83
    s_lshl_b32 s82, s73, 7
    s_nop 0
    s_branch L_setup
L_kvb:
    s_setprio 0
    s_barrier
L_q:
    s_cmp_lt_u32 s79, 5
    ds_read_b64_tr_b16 v[168:169], v8 offset:0
    ds_read_b64_tr_b16 v[170:171], v8 offset:1280
    ds_read_b64_tr_b16 v[172:173], v9 offset:0
    ds_read_b64_tr_b16 v[174:175], v9 offset:1280
    ds_read_b64_tr_b16 v[176:177], v10 offset:0
    ds_read_b64_tr_b16 v[178:179], v10 offset:1280
    ds_read_b64_tr_b16 v[180:181], v11 offset:0
    ds_read_b64_tr_b16 v[182:183], v11 offset:1280
    ds_read_b64_tr_b16 v[184:185], v12 offset:0
    ds_read_b64_tr_b16 v[186:187], v12 offset:1280
    ds_read_b64_tr_b16 v[188:189], v8 offset:5120
    ds_read_b64_tr_b16 v[190:191], v8 offset:6400
    s_waitcnt lgkmcnt(10)
    v_mfma_f32_16x16x32_bf16 v[96:99], v[168:171], v[16:19], 0
    ds_read_b64_tr_b16 v[192:193], v9 offset:5120
    ds_read_b64_tr_b16 v[194:195], v9 offset:6400
    v_mfma_f32_16x16x32_bf16 v[116:119], v[168:171], v[124:127], 0
    s_cbranch_scc0 L_sk15
    s_add_u32 m0, s11, 56320
    s_nop 0
    buffer_load_dwordx4 v248, s[36:39], s15 offen offset:0 lds
    s_cmp_lt_u32 s79, 5
L_sk15:
    s_waitcnt lgkmcnt(10)
    v_mfma_f32_16x16x32_bf16 v[100:103], v[172:175], v[16:19], 0
    ds_read_b64_tr_b16 v[196:197], v10 offset:5120
    ds_read_b64_tr_b16 v[198:199], v10 offset:6400
    s_waitcnt lgkmcnt(10)
    v_mfma_f32_16x16x32_bf16 v[104:107], v[176:179], v[16:19], 0
    ds_read_b64_tr_b16 v[200:201], v11 offset:5120
    ds_read_b64_tr_b16 v[202:203], v11 offset:6400
    s_cbranch_scc0 L_sk16
    buffer_load_dwordx4 v249, s[36:39], s15 offen offset:1024 lds
    s_cmp_lt_u32 s79, 5
L_sk16:
    s_waitcnt lgkmcnt(10)
    v_mfma_f32_16x16x32_bf16 v[108:111], v[180:183], v[16:19], 0
    ds_read_b64_tr_b16 v[204:205], v12 offset:5120
    ds_read_b64_tr_b16 v[206:207], v12 offset:6400
    s_waitcnt lgkmcnt(10)
    v_mfma_f32_16x16x32_bf16 v[112:115], v[184:187], v[16:19], 0
    ds_read_b64_tr_b16 v[168:169], v8 offset:10240
    ds_read_b64_tr_b16 v[170:171], v8 offset:11520
    v_mfma_f32_16x16x32_bf16 v[120:123], v[184:187], v[124:127], 0
    s_cbranch_scc0 L_sk17
    buffer_load_dwordx4 v250, s[36:39], s15 offen offset:2048 lds
    s_cmp_lt_u32 s79, 5
L_sk17:
    s_waitcnt lgkmcnt(10)
    v_mfma_f32_16x16x32_bf16 v[96:99], v[188:191], v[20:23], v[96:99]
    ds_read_b64_tr_b16 v[172:173], v9 offset:10240
    ds_read_b64_tr_b16 v[174:175], v9 offset:11520
    v_mfma_f32_16x16x32_bf16 v[116:119], v[188:191], v[124:127], v[116:119]
    s_waitcnt lgkmcnt(10)
    v_mfma_f32_16x16x32_bf16 v[100:103], v[192:195], v[20:23], v[100:103]
    ds_read_b64_tr_b16 v[176:177], v10 offset:10240
    ds_read_b64_tr_b16 v[178:179], v10 offset:11520
    s_cbranch_scc0 L_sk18
    buffer_load_dwordx4 v251, s[36:39], s15 offen offset:3072 lds
    s_cmp_lt_u32 s79, 5
L_sk18:
    s_waitcnt lgkmcnt(10)
    v_mfma_f32_16x16x32_bf16 v[104:107], v[196:199], v[20:23], v[104:107]
    ds_read_b64_tr_b16 v[180:181], v11 offset:10240
    ds_read_b64_tr_b16 v[182:183], v11 offset:11520
    s_waitcnt lgkmcnt(10)
    v_mfma_f32_16x16x32_bf16 v[108:111], v[200:203], v[20:23], v[108:111]
    ds_read_b64_tr_b16 v[184:185], v12 offset:10240
    ds_read_b64_tr_b16 v[186:187], v12 offset:11520
    s_cbranch_scc0 L_sk19
    s_add_u32 m0, s11, 60416
    s_nop 0
    buffer_load_dwordx4 v252, s[36:39], s15 offen offset:0 lds
    s_cmp_lt_u32 s79, 5
L_sk19:
    s_waitcnt lgkmcnt(10)
    v_mfma_f32_16x16x32_bf16 v[112:115], v[204:207], v[20:23], v[112:115]
    ds_read_b64_tr_b16 v[188:189], v8 offset:15360
    ds_read_b64_tr_b16 v[190:191], v8 offset:16640
    v_mfma_f32_16x16x32_bf16 v[120:123], v[204:207], v[124:127], v[120:123]
    s_waitcnt lgkmcnt(10)
    v_mfma_f32_16x16x32_bf16 v[96:99], v[168:171], v[24:27], v[96:99]
    ds_read_b64_tr_b16 v[192:193], v9 offset:15360
    ds_read_b64_tr_b16 v[194:195], v9 offset:16640
    v_mfma_f32_16x16x32_bf16 v[116:119], v[168:171], v[124:127], v[116:119]
    s_waitcnt lgkmcnt(10)
    v_mfma_f32_16x16x32_bf16 v[100:103], v[172:175], v[24:27], v[100:103]
    ds_read_b64_tr_b16 v[196:197], v10 offset:15360
    ds_read_b64_tr_b16 v[198:199], v10 offset:16640
    s_waitcnt lgkmcnt(10)
    v_mfma_f32_16x16x32_bf16 v[104:107], v[176:179], v[24:27], v[104:107]
    ds_read_b64_tr_b16 v[200:201], v11 offset:15360
    ds_read_b64_tr_b16 v[202:203], v11 offset:16640
    s_waitcnt lgkmcnt(10)
    v_mfma_f32_16x16x32_bf16 v[108:111], v[180:183], v[24:27], v[108:111]
    ds_read_b64_tr_b16 v[204:205], v12 offset:15360
    ds_read_b64_tr_b16 v[206:207], v12 offset:16640
    s_waitcnt lgkmcnt(10)
    v_mfma_f32_16x16x32_bf16 v[112:115], v[184:187], v[24:27], v[112:115]
    ds_read_b64_tr_b16 v[168:169], v8 offset:20480
    ds_read_b64_tr_b16 v[170:171], v8 offset:21760
    v_mfma_f32_16x16x32_bf16 v[120:123], v[184:187], v[124:127], v[120:123]
    s_waitcnt lgkmcnt(10)
    v_mfma_f32_16x16x32_bf16 v[96:99], v[188:191], v[28:31], v[96:99]
    ds_read_b64_tr_b16 v[172:173], v9 offset:20480
    ds_read_b64_tr_b16 v[174:175], v9 offset:21760
    v_mfma_f32_16x16x32_bf16 v[116:119], v[188:191], v[124:127], v[116:119]
    v_and_b32 v4, 31, v0
    v_lshrrev_b32 v5, 5, v0
    v_mov_b32 v6, v146
    v_mov_b32 v7, v147
    s_waitcnt lgkmcnt(10)
    v_mfma_f32_16x16x32_bf16 v[100:103], v[192:195], v[28:31], v[100:103]
    ds_read_b64_tr_b16 v[176:177], v10 offset:20480
    ds_read_b64_tr_b16 v[178:179], v10 offset:21760
    s_waitcnt lgkmcnt(10)
    v_mfma_f32_16x16x32_bf16 v[104:107], v[196:199], v[28:31], v[104:107]
    ds_read_b64_tr_b16 v[180:181], v11 offset:20480
    ds_read_b64_tr_b16 v[182:183], v11 offset:21760
    v_mov_b32 v14, v148
    s_add_u32 s12, s16, 1179648
    v_mov_b32 v60, 0
    v_mov_b32 v61, 1
    s_waitcnt lgkmcnt(10)
    v_mfma_f32_16x16x32_bf16 v[108:111], v[200:203], v[28:31], v[108:111]
    ds_read_b64_tr_b16 v[184:185], v12 offset:20480
    ds_read_b64_tr_b16 v[186:187], v12 offset:21760
    s_waitcnt lgkmcnt(10)
    v_mfma_f32_16x16x32_bf16 v[112:115], v[204:207], v[28:31], v[112:115]
    v_mfma_f32_16x16x32_bf16 v[120:123], v[204:207], v[124:127], v[120:123]
    s_lshl_b32 s8, s68, 10
    s_add_u32 m0, s8, 24576
    s_add_u32 s8, s8, 40960
    s_waitcnt lgkmcnt(8)
    v_mfma_f32_16x16x32_bf16 v[96:99], v[168:171], v[32:35], v[96:99]
    v_mfma_f32_16x16x32_bf16 v[116:119], v[168:171], v[124:127], v[116:119]
    s_waitcnt lgkmcnt(6)
    v_mfma_f32_16x16x32_bf16 v[100:103], v[172:175], v[32:35], v[100:103]
    ds_read_b64 v[68:69], v153
    ds_read_b64 v[70:71], v153 offset:512
    s_waitcnt lgkmcnt(6)
    v_mfma_f32_16x16x32_bf16 v[104:107], v[176:179], v[32:35], v[104:107]
    s_waitcnt lgkmcnt(4)
    v_mfma_f32_16x16x32_bf16 v[108:111], v[180:183], v[32:35], v[108:111]
    s_cmp_eq_u32 s79, 5
    s_cbranch_scc0 L_apr
    s_setprio 2
L_apr:
    s_waitcnt lgkmcnt(2)
    v_mfma_f32_16x16x32_bf16 v[112:115], v[184:187], v[32:35], v[112:115]
    v_mfma_f32_16x16x32_bf16 v[120:123], v[184:187], v[124:127], v[120:123]
    s_waitcnt vmcnt(0)
    s_barrier
    ds_read_b64_tr_b16 v[168:169], v156 offset:0
    ds_read_b64_tr_b16 v[170:171], v156 offset:1280
    ds_read_b64_tr_b16 v[172:173], v156 offset:10304
    ds_read_b64_tr_b16 v[174:175], v156 offset:11584
    ds_read_b64_tr_b16 v[176:177], v156 offset:20608
    ds_read_b64_tr_b16 v[178:179], v156 offset:21888
    ds_read_b64_tr_b16 v[180:181], v156 offset:30912
    ds_read_b64_tr_b16 v[182:183], v156 offset:32192
    ds_read_b64_tr_b16 v[184:185], v156 offset:41216
    ds_read_b64_tr_b16 v[186:187], v156 offset:42496
    ds_read_b64_tr_b16 v[188:189], v160 offset:0
    ds_read_b64_tr_b16 v[190:191], v160 offset:1280
    s_waitcnt lgkmcnt(10)
    v_mfma_f32_16x16x32_bf16 v[96:99], v[168:171], v[36:39], v[96:99]
    ds_read_b64_tr_b16 v[192:193], v160 offset:10304
    ds_read_b64_tr_b16 v[194:195], v160 offset:11584
    v_mfma_f32_16x16x32_bf16 v[116:119], v[168:171], v[124:127], v[116:119]
    s_cmp_eq_u32 s22, 2
    s_cbranch_scc0 L_go
    buffer_load_dwordx2 v[208:209], v139, s[44:47], s18 offen offset:0
    buffer_load_ushort v224, v140, s[44:47], s18 offen offset:0
    buffer_load_dwordx2 v[210:211], v139, s[44:47], s18 offen offset:1280
    buffer_load_ushort v225, v140, s[44:47], s18 offen offset:1280
    buffer_load_dwordx2 v[212:213], v139, s[44:47], s18 offen offset:2560
    buffer_load_ushort v226, v140, s[44:47], s18 offen offset:2560
    buffer_load_dwordx2 v[214:215], v139, s[44:47], s18 offen offset:3840
    buffer_load_ushort v227, v140, s[44:47], s18 offen offset:3840
    buffer_load_dwordx2 v[216:217], v139, s[44:47], s19 offen offset:0
    buffer_load_ushort v228, v140, s[44:47], s19 offen offset:0
    buffer_load_dwordx2 v[218:219], v139, s[44:47], s19 offen offset:1280
    buffer_load_ushort v229, v140, s[44:47], s19 offen offset:1280
    buffer_load_dwordx2 v[220:221], v139, s[44:47], s19 offen offset:2560
    buffer_load_ushort v230, v140, s[44:47], s19 offen offset:2560
    buffer_load_dwordx2 v[222:223], v139, s[44:47], s19 offen offset:3840
    buffer_load_ushort v231, v140, s[44:47], s19 offen offset:3840
L_go:
    s_waitcnt lgkmcnt(10)
    v_mfma_f32_16x16x32_bf16 v[96:99], v[172:175], v[40:43], v[96:99]
    ds_read_b64_tr_b16 v[196:197], v160 offset:20608
    ds_read_b64_tr_b16 v[198:199], v160 offset:21888
    v_mfma_f32_16x16x32_bf16 v[116:119], v[172:175], v[124:127], v[116:119]
    s_waitcnt lgkmcnt(10)
    v_mfma_f32_16x16x32_bf16 v[96:99], v[176:179], v[44:47], v[96:99]
    ds_read_b64_tr_b16 v[200:201], v160 offset:30912
    ds_read_b64_tr_b16 v[202:203], v160 offset:32192
    v_mfma_f32_16x16x32_bf16 v[116:119], v[176:179], v[124:127], v[116:119]
    v_add_f32 v68, v68, v70
    v_add_f32 v69, v69, v71
    v_mul_f32 v64, 0xbacccccd, v68
    v_mul_f32 v69, 0x3acccccd, v69
    s_waitcnt lgkmcnt(10)
    v_mfma_f32_16x16x32_bf16 v[96:99], v[180:183], v[48:51], v[96:99]
    ds_read_b64_tr_b16 v[204:205], v160 offset:41216
    ds_read_b64_tr_b16 v[206:207], v160 offset:42496
    v_mfma_f32_16x16x32_bf16 v[116:119], v[180:183], v[124:127], v[116:119]
    v_fma_f32 v69, -v64, v64, v69
    v_max_f32 v69, 0, v69
    v_add_f32 v69, 0x3727c5ac, v69
    v_rsq_f32 v66, v69
    s_waitcnt lgkmcnt(10)
    v_mfma_f32_16x16x32_bf16 v[96:99], v[184:187], v[52:55], v[96:99]
    ds_read_b64_tr_b16 v[168:169], v157 offset:0
    ds_read_b64_tr_b16 v[170:171], v157 offset:1280
    v_mfma_f32_16x16x32_bf16 v[116:119], v[184:187], v[124:127], v[116:119]
    v_mov_b32 v65, v64
    v_mul_f32 v66, 0x3ea52b5c, v66
    v_mov_b32 v67, v66
    s_waitcnt lgkmcnt(10)
    v_mfma_f32_16x16x32_bf16 v[112:115], v[188:191], v[36:39], v[112:115]
    ds_read_b64_tr_b16 v[172:173], v157 offset:10304
    ds_read_b64_tr_b16 v[174:175], v157 offset:11584
    v_mfma_f32_16x16x32_bf16 v[120:123], v[188:191], v[124:127], v[120:123]
    s_waitcnt lgkmcnt(10)
    v_mfma_f32_16x16x32_bf16 v[112:115], v[192:195], v[40:43], v[112:115]
    ds_read_b64_tr_b16 v[176:177], v157 offset:20608
    ds_read_b64_tr_b16 v[178:179], v157 offset:21888
    v_mfma_f32_16x16x32_bf16 v[120:123], v[192:195], v[124:127], v[120:123]
    s_waitcnt lgkmcnt(10)
    v_mfma_f32_16x16x32_bf16 v[112:115], v[196:199], v[44:47], v[112:115]
    ds_read_b64_tr_b16 v[180:181], v157 offset:30912
    ds_read_b64_tr_b16 v[182:183], v157 offset:32192
    v_mfma_f32_16x16x32_bf16 v[120:123], v[196:199], v[124:127], v[120:123]
    ds_write_b128 v161, v[96:99]
    s_waitcnt lgkmcnt(11)
    v_mfma_f32_16x16x32_bf16 v[112:115], v[200:203], v[48:51], v[112:115]
    ds_read_b64_tr_b16 v[184:185], v157 offset:41216
    ds_read_b64_tr_b16 v[186:187], v157 offset:42496
    v_mfma_f32_16x16x32_bf16 v[120:123], v[200:203], v[124:127], v[120:123]
    s_mov_b32 exec_lo, 0x00010001
    s_mov_b32 exec_hi, 0x00010001
    ds_write_b128 v166, v[116:119]
    s_mov_b64 exec, -1
    s_waitcnt lgkmcnt(12)
    v_mfma_f32_16x16x32_bf16 v[112:115], v[204:207], v[52:55], v[112:115]
    ds_read_b64_tr_b16 v[188:189], v158 offset:0
    ds_read_b64_tr_b16 v[190:191], v158 offset:1280
    v_mfma_f32_16x16x32_bf16 v[120:123], v[204:207], v[124:127], v[120:123]
    s_waitcnt lgkmcnt(12)
    v_mfma_f32_16x16x32_bf16 v[100:103], v[168:171], v[36:39], v[100:103]
    ds_read_b64_tr_b16 v[192:193], v158 offset:10304
    ds_read_b64_tr_b16 v[194:195], v158 offset:11584
    s_waitcnt lgkmcnt(12)
    v_mfma_f32_16x16x32_bf16 v[100:103], v[172:175], v[40:43], v[100:103]
    ds_read_b64_tr_b16 v[196:197], v158 offset:20608
    ds_read_b64_tr_b16 v[198:199], v158 offset:21888
    s_cmp_eq_u32 s79, 5
    s_cbranch_scc0 L_np
    buffer_load_dwordx2 v[252:253], v133, s[64:67], 0 offen sc1
L_np:
    s_waitcnt lgkmcnt(12)
    v_mfma_f32_16x16x32_bf16 v[100:103], v[176:179], v[44:47], v[100:103]
    ds_read_b64_tr_b16 v[200:201], v158 offset:30912
    ds_read_b64_tr_b16 v[202:203], v158 offset:32192
    s_waitcnt lgkmcnt(12)
    v_mfma_f32_16x16x32_bf16 v[100:103], v[180:183], v[48:51], v[100:103]
    ds_read_b64_tr_b16 v[204:205], v158 offset:41216
    ds_read_b64_tr_b16 v[206:207], v158 offset:42496
    s_waitcnt lgkmcnt(11)
    v_mfma_f32_16x16x32_bf16 v[100:103], v[184:187], v[52:55], v[100:103]
    ds_read_b64_tr_b16 v[168:169], v159 offset:0
    ds_read_b64_tr_b16 v[170:171], v159 offset:1280
    ds_write_b128 v165, v[112:115]
    s_waitcnt lgkmcnt(11)
    v_mfma_f32_16x16x32_bf16 v[104:107], v[188:191], v[36:39], v[104:107]
    ds_read_b64_tr_b16 v[172:173], v159 offset:10304
    ds_read_b64_tr_b16 v[174:175], v159 offset:11584
    s_mov_b32 exec_lo, 0x00010001
    s_mov_b32 exec_hi, 0x00010001
    ds_write_b128 v167, v[120:123] offset:256
    s_mov_b64 exec, -1
    s_waitcnt lgkmcnt(12)
    v_mfma_f32_16x16x32_bf16 v[104:107], v[192:195], v[40:43], v[104:107]
    ds_read_b64_tr_b16 v[176:177], v159 offset:20608
    ds_read_b64_tr_b16 v[178:179], v159 offset:21888
    s_waitcnt lgkmcnt(12)
    v_mfma_f32_16x16x32_bf16 v[104:107], v[196:199], v[44:47], v[104:107]
    ds_read_b64_tr_b16 v[180:181], v159 offset:30912
    ds_read_b64_tr_b16 v[182:183], v159 offset:32192
    ds_write_b128 v162, v[100:103]
    s_waitcnt lgkmcnt(13)
    v_mfma_f32_16x16x32_bf16 v[104:107], v[200:203], v[48:51], v[104:107]
    ds_read_b64_tr_b16 v[184:185], v159 offset:41216
    ds_read_b64_tr_b16 v[186:187], v159 offset:42496
    s_waitcnt lgkmcnt(13)
    v_mfma_f32_16x16x32_bf16 v[104:107], v[204:207], v[52:55], v[104:107]
    s_waitcnt lgkmcnt(11)
    v_mfma_f32_16x16x32_bf16 v[108:111], v[168:171], v[36:39], v[108:111]
    s_waitcnt lgkmcnt(8)
    v_mfma_f32_16x16x32_bf16 v[108:111], v[172:175], v[40:43], v[108:111]
    s_waitcnt lgkmcnt(5)
    v_mfma_f32_16x16x32_bf16 v[108:111], v[176:179], v[44:47], v[108:111]
    s_nop 1
    ds_write_b128 v163, v[104:107]
    s_waitcnt lgkmcnt(4)
    v_mfma_f32_16x16x32_bf16 v[108:111], v[180:183], v[48:51], v[108:111]
    s_cmp_eq_u32 s79, 5
    s_cbranch_scc0 L_np2
    buffer_load_dwordx2 v[248:249], v133, s[64:67], 0 offen sc1
L_np2:
    s_waitcnt lgkmcnt(1)
    v_mfma_f32_16x16x32_bf16 v[108:111], v[184:187], v[52:55], v[108:111]
    v_mov_b32 v56, 0x3f803f80
    v_cmp_eq_u32 vcc, 20, v4
    s_movk_i32 s85, 0x7fff
    s_cmp_eq_u32 s79, 5
    v_cndmask_b32 v36, 0, v56, vcc
    v_mov_b32 v37, v36
    v_mov_b32 v38, v36
    v_mov_b32 v39, v36
    v_mov_b32 v40, v36
    v_mov_b32 v41, v36
    v_mov_b32 v42, v36
    v_mov_b32 v43, v36
    ds_write_b128 v164, v[108:111]
    s_cbranch_scc0 L_nos1
    s_waitcnt vmcnt(1)
    v_sad_u8 v251, v252, 0, 0
    v_sad_u8 v251, v253, 0, v251
    v_cmp_eq_u32 vcc, 16, v251
    s_nop 0
    s_cmp_eq_u64 vcc, exec
    s_cbranch_scc1 L_s1d
    s_waitcnt vmcnt(0)
    v_mov_b32 v252, v248
    v_mov_b32 v253, v249
    s_branch L_s1b
L_s1:
    buffer_load_dwordx2 v[252:253], v133, s[64:67], 0 offen sc1
L_s1b:
    s_sub_u32 s85, s85, 1
    s_waitcnt vmcnt(0)
    s_cbranch_scc1 L_s1d
    v_sad_u8 v251, v252, 0, 0
    v_sad_u8 v251, v253, 0, v251
    v_cmp_eq_u32 vcc, 16, v251
    s_nop 0
    s_cmp_eq_u64 vcc, exec
    s_nop 1
    s_cbranch_scc0 L_s1
L_s1d:
    buffer_load_dword v255, v134, s[64:67], 0 offen sc1
    s_movk_i32 m0, 0
    s_mov_b32 s80, 16384
    buffer_load_dwordx4 v3, s[64:67], s80 offen offset:0 sc1 lds
    buffer_load_dwordx4 v3, s[64:67], s80 offen offset:1024 sc1 lds
    buffer_load_dwordx4 v3, s[64:67], s80 offen offset:2048 sc1 lds
    buffer_load_dwordx4 v3, s[64:67], s80 offen offset:3072 sc1 lds
    s_movk_i32 m0, 4096
    s_mov_b32 s80, 20480
    buffer_load_dwordx4 v3, s[64:67], s80 offen offset:0 sc1 lds
    buffer_load_dwordx4 v3, s[64:67], s80 offen offset:1024 sc1 lds
    buffer_load_dwordx4 v3, s[64:67], s80 offen offset:2048 sc1 lds
    buffer_load_dwordx4 v3, s[64:67], s80 offen offset:3072 sc1 lds
    s_movk_i32 m0, 8192
    s_mov_b32 s80, 24576
    buffer_load_dwordx4 v3, s[64:67], s80 offen offset:0 sc1 lds
    buffer_load_dwordx4 v3, s[64:67], s80 offen offset:1024 sc1 lds
    buffer_load_dwordx4 v3, s[64:67], s80 offen offset:2048 sc1 lds
    buffer_load_dwordx4 v3, s[64:67], s80 offen offset:3072 sc1 lds
    s_movk_i32 m0, 12288
    s_mov_b32 s80, 28672
    buffer_load_dwordx4 v3, s[64:67], s80 offen offset:0 sc1 lds
    buffer_load_dwordx4 v3, s[64:67], s80 offen offset:1024 sc1 lds
    buffer_load_dwordx4 v3, s[64:67], s80 offen offset:2048 sc1 lds
    buffer_load_dwordx4 v3, s[64:67], s80 offen offset:3072 sc1 lds
    s_movk_i32 m0, 16384
    s_mov_b32 s80, 32768
    buffer_load_dwordx4 v3, s[64:67], s80 offen offset:0 sc1 lds
    buffer_load_dwordx4 v3, s[64:67], s80 offen offset:1024 sc1 lds
    buffer_load_dwordx4 v3, s[64:67], s80 offen offset:2048 sc1 lds
    buffer_load_dwordx4 v3, s[64:67], s80 offen offset:3072 sc1 lds
    s_movk_i32 m0, 20480
    s_mov_b32 s80, 36864
    buffer_load_dwordx4 v3, s[64:67], s80 offen offset:0 sc1 lds
    buffer_load_dwordx4 v3, s[64:67], s80 offen offset:1024 sc1 lds
    buffer_load_dwordx4 v3, s[64:67], s80 offen offset:2048 sc1 lds
    buffer_load_dwordx4 v3, s[64:67], s80 offen offset:3072 sc1 lds
    s_sub_u32 m0, s8, 16384
L_nos1:
    s_waitcnt lgkmcnt(0)
    s_barrier
    s_cmp_eq_u32 s79, 5
    s_cbranch_scc0 L_nos2
    s_lshl_b32 s80, s76, 3
    v_lshrrev_b64 v[252:253], s80, v[252:253]
    v_and_b32 v252, 0xff, v252
    v_cmp_eq_u32 vcc, 16, v252
    s_lshl_b32 s80, s69, 2
    s_lshr_b32 s80, vcc_lo, s80
    s_and_b32 s80, s80, 15
    s_cmp_eq_u32 s80, 15
    s_cselect_b32 s80, 1, 0
    v_mov_b32 v252, s80
    ds_write_b32 v135, v252
L_nos2:
    ds_read_b128 v[96:99], v152 offset:0
    ds_read_b128 v[100:103], v152 offset:16
    ds_read_b128 v[104:107], v151 offset:64
    ds_read_b128 v[108:111], v152 offset:320
    ds_read_b128 v[112:115], v152 offset:336
    ds_read_b128 v[116:119], v151 offset:384
    ds_read_b128 v[68:71], v149 offset:0
    ds_read_b128 v[72:75], v149 offset:16
    ds_read_b128 v[76:79], v150 offset:64
    ds_read_b128 v[80:83], v149 offset:21504
    ds_read_b128 v[84:87], v149 offset:21520
    ds_read_b128 v[88:91], v150 offset:21568
    v_cmp_eq_u32 vcc, 0, v5
    s_waitcnt lgkmcnt(6)
    v_pk_add_f32 v[96:97], v[96:97], v[108:109]
    v_pk_add_f32 v[98:99], v[98:99], v[110:111]
    v_pk_add_f32 v[100:101], v[100:101], v[112:113]
    v_pk_add_f32 v[102:103], v[102:103], v[114:115]
    v_pk_add_f32 v[104:105], v[104:105], v[116:117]
    v_pk_add_f32 v[106:107], v[106:107], v[118:119]
    s_waitcnt lgkmcnt(3)
    v_pk_fma_f32 v[68:69], v[64:65], v[96:97], v[68:69]
    v_pk_fma_f32 v[70:71], v[64:65], v[98:99], v[70:71]
    v_pk_fma_f32 v[72:73], v[64:65], v[100:101], v[72:73]
    v_pk_fma_f32 v[74:75], v[64:65], v[102:103], v[74:75]
    v_pk_fma_f32 v[76:77], v[64:65], v[104:105], v[76:77]
    v_pk_fma_f32 v[78:79], v[64:65], v[106:107], v[78:79]
    s_waitcnt lgkmcnt(0)
    v_pk_add_f32 v[68:69], v[68:69], v[80:81]
    v_pk_add_f32 v[70:71], v[70:71], v[82:83]
    v_pk_add_f32 v[72:73], v[72:73], v[84:85]
    v_pk_add_f32 v[74:75], v[74:75], v[86:87]
    v_pk_add_f32 v[76:77], v[76:77], v[88:89]
    v_pk_add_f32 v[78:79], v[78:79], v[90:91]
    v_pk_mul_f32 v[68:69], v[68:69], v[66:67]
    v_pk_mul_f32 v[70:71], v[70:71], v[66:67]
    v_pk_mul_f32 v[72:73], v[72:73], v[66:67]
    v_pk_mul_f32 v[74:75], v[74:75], v[66:67]
    v_pk_mul_f32 v[76:77], v[76:77], v[66:67]
    v_pk_mul_f32 v[78:79], v[78:79], v[66:67]
    v_cvt_pk_bf16_f32 v44, v68, v69
    v_cvt_pk_bf16_f32 v45, v70, v71
    v_cvt_pk_bf16_f32 v46, v72, v73
    v_cvt_pk_bf16_f32 v47, v74, v75
    v_cvt_pk_bf16_f32 v50, v76, v77
    v_cvt_pk_bf16_f32 v51, v78, v79
    v_cndmask_b32 v50, 0, v50, vcc
    v_cndmask_b32 v51, 0, v51, vcc
    s_waitcnt vmcnt(0)
    s_barrier
    ds_read_b32 v9, v135
    ds_read_b128 v[32:35], v136 offset:0
    ds_read_b64 v[48:49], v137 offset:0
    s_waitcnt lgkmcnt(1)
    v_readfirstlane_b32 s75, v9
    v_mfma_f32_32x32x16_bf16 v[96:111], v[32:35], v[44:47], 0
    ds_read_b128 v[32:35], v136 offset:2560
    s_waitcnt lgkmcnt(1)
    s_nop 7
    v_mfma_f32_32x32x8_bf16 v[96:111], v[48:49], v[50:51], v[96:111]
    ds_read_b64 v[48:49], v137 offset:2560
    s_mov_b64 exec, s[4:5]
    ds_read_b128 v[36:39], v138 offset:0
    s_mov_b64 exec, -1
    s_setprio 3
    .p2align 3
    s_nop 6
    v_exp_f32 v96, v96
    s_waitcnt lgkmcnt(2)
    v_mfma_f32_32x32x16_bf16 v[120:135], v[32:35], v[44:47], 0
    ds_read_b128 v[32:35], v136 offset:5120
    buffer_load_dwordx4 v3, s[64:67], s8 offen sc1 lds
    s_add_u32 m0, m0, 8192
    s_add_u32 s8, s8, 8192
    .p2align 3
    v_exp_f32 v97, v97
    v_exp_f32 v98, v98
    v_exp_f32 v99, v99
    s_mov_b64 exec, s[4:5]
    ds_read_b128 v[40:43], v138 offset:640
    s_mov_b64 exec, -1
    v_exp_f32 v100, v100
    v_exp_f32 v101, v101
    v_exp_f32 v102, v102
    v_exp_f32 v103, v103
    v_cvt_pk_bf16_f32 v112, v96, v97
    v_cvt_pk_bf16_f32 v113, v98, v99
    v_exp_f32 v104, v104
    s_waitcnt lgkmcnt(3)
    v_mfma_f32_32x32x8_bf16 v[120:135], v[48:49], v[50:51], v[120:135]
    ds_read_b64 v[48:49], v137 offset:5120
    buffer_load_dwordx4 v3, s[64:67], s8 offen sc1 lds
    s_add_u32 m0, m0, 8192
    s_add_u32 s8, s8, 8192
    .p2align 3
    v_cvt_pk_bf16_f32 v114, v100, v101
    v_cvt_pk_bf16_f32 v115, v102, v103
    v_exp_f32 v105, v105
    v_exp_f32 v106, v106
    v_exp_f32 v107, v107
    s_waitcnt lgkmcnt(3)
    v_mfma_f32_32x32x16_bf16 v[16:31], v[36:39], v[112:115], 0
    s_mov_b64 exec, s[4:5]
    ds_read_b128 v[36:39], v138 offset:2560
    s_mov_b64 exec, -1
    buffer_load_dwordx4 v3, s[64:67], s8 offen sc1 lds
    s_add_u32 m0, m0, 8192
    s_add_u32 s8, s8, 8192
    .p2align 3
    v_exp_f32 v108, v108
    v_exp_f32 v109, v109
    v_exp_f32 v110, v110
    v_exp_f32 v111, v111
    v_cvt_pk_bf16_f32 v116, v104, v105
    v_cvt_pk_bf16_f32 v117, v106, v107
    v_cvt_pk_bf16_f32 v118, v108, v109
    v_cvt_pk_bf16_f32 v119, v110, v111
    .p2align 3
    v_exp_f32 v120, v120
    s_waitcnt lgkmcnt(3)
    v_mfma_f32_32x32x16_bf16 v[96:111], v[32:35], v[44:47], 0
    ds_read_b128 v[32:35], v136 offset:7680
    buffer_load_dwordx4 v3, s[64:67], s8 offen sc1 lds
    s_add_u32 m0, m0, 8192
    s_add_u32 s8, s8, 8192
    .p2align 3
    v_exp_f32 v121, v121
    v_exp_f32 v122, v122
    v_exp_f32 v123, v123
    s_waitcnt lgkmcnt(3)
    v_mfma_f32_32x32x16_bf16 v[16:31], v[40:43], v[116:119], v[16:31]
    s_mov_b64 exec, s[4:5]
    ds_read_b128 v[40:43], v138 offset:3200
    s_mov_b64 exec, -1
    v_exp_f32 v124, v124
    v_exp_f32 v125, v125
    v_exp_f32 v126, v126
    v_exp_f32 v127, v127
    v_cvt_pk_bf16_f32 v112, v120, v121
    v_cvt_pk_bf16_f32 v113, v122, v123
    v_exp_f32 v128, v128
    s_waitcnt lgkmcnt(3)
    v_mfma_f32_32x32x8_bf16 v[96:111], v[48:49], v[50:51], v[96:111]
    ds_read_b64 v[48:49], v137 offset:7680
    buffer_load_dwordx4 v3, s[64:67], s8 offen sc1 lds
    s_add_u32 m0, m0, 8192
    s_add_u32 s8, s8, 8192
    .p2align 3
    v_cvt_pk_bf16_f32 v114, v124, v125
    v_cvt_pk_bf16_f32 v115, v126, v127
    v_exp_f32 v129, v129
    v_exp_f32 v130, v130
    v_exp_f32 v131, v131
    s_waitcnt lgkmcnt(3)
    v_mfma_f32_32x32x16_bf16 v[16:31], v[36:39], v[112:115], v[16:31]
    s_mov_b64 exec, s[4:5]
    ds_read_b128 v[36:39], v138 offset:5120
    s_mov_b64 exec, -1
    buffer_load_dwordx4 v3, s[64:67], s8 offen sc1 lds
    s_add_u32 m0, m0, 8192
    s_add_u32 s8, s8, 8192
    .p2align 3
    v_exp_f32 v132, v132
    v_exp_f32 v133, v133
    v_exp_f32 v134, v134
    v_exp_f32 v135, v135
    v_cvt_pk_bf16_f32 v116, v128, v129
    v_cvt_pk_bf16_f32 v117, v130, v131
    v_cvt_pk_bf16_f32 v118, v132, v133
    v_cvt_pk_bf16_f32 v119, v134, v135
    .p2align 3
    v_exp_f32 v96, v96
    s_waitcnt lgkmcnt(3)
    v_mfma_f32_32x32x16_bf16 v[120:135], v[32:35], v[44:47], 0
    ds_read_b128 v[32:35], v136 offset:10240
    buffer_load_dwordx4 v3, s[64:67], s8 offen sc1 lds
    s_add_u32 m0, m0, 8192
    s_add_u32 s8, s8, 8192
    .p2align 3
    v_exp_f32 v97, v97
    v_exp_f32 v98, v98
    v_exp_f32 v99, v99
    s_waitcnt lgkmcnt(3)
    v_mfma_f32_32x32x16_bf16 v[16:31], v[40:43], v[116:119], v[16:31]
    s_mov_b64 exec, s[4:5]
    ds_read_b128 v[40:43], v138 offset:5760
    s_mov_b64 exec, -1
    v_exp_f32 v100, v100
    v_exp_f32 v101, v101
    v_exp_f32 v102, v102
    v_exp_f32 v103, v103
    v_cvt_pk_bf16_f32 v112, v96, v97
    v_cvt_pk_bf16_f32 v113, v98, v99
    v_exp_f32 v104, v104
    s_waitcnt lgkmcnt(3)
    v_mfma_f32_32x32x8_bf16 v[120:135], v[48:49], v[50:51], v[120:135]
    ds_read_b64 v[48:49], v137 offset:10240
    buffer_load_dwordx4 v3, s[64:67], s8 offen sc1 lds
    s_add_u32 m0, m0, 8192
    s_add_u32 s8, s8, 8192
    .p2align 3
    v_cvt_pk_bf16_f32 v114, v100, v101
    v_cvt_pk_bf16_f32 v115, v102, v103
    v_exp_f32 v105, v105
    v_exp_f32 v106, v106
    v_exp_f32 v107, v107
    s_waitcnt lgkmcnt(3)
    v_mfma_f32_32x32x16_bf16 v[16:31], v[36:39], v[112:115], v[16:31]
    s_mov_b64 exec, s[4:5]
    ds_read_b128 v[36:39], v138 offset:7680
    s_mov_b64 exec, -1
    s_cmp_eq_u32 s22, 2
    s_cbranch_scc0 L_sk_3
    s_waitcnt vmcnt(8)
    v_perm_b32 v88, v210, v208, s6
    v_perm_b32 v89, v214, v212, s6
    v_perm_b32 v90, v218, v216, s6
    v_perm_b32 v91, v222, v220, s6
    buffer_store_dwordx4 v[88:91], v3, s[64:67], s20 offen offset:0 sc1
L_sk_3:
    .p2align 3
    v_exp_f32 v108, v108
    v_exp_f32 v109, v109
    v_exp_f32 v110, v110
    v_exp_f32 v111, v111
    v_cvt_pk_bf16_f32 v116, v104, v105
    v_cvt_pk_bf16_f32 v117, v106, v107
    v_cvt_pk_bf16_f32 v118, v108, v109
    v_cvt_pk_bf16_f32 v119, v110, v111
    .p2align 3
    v_exp_f32 v120, v120
    s_waitcnt lgkmcnt(3)
    v_mfma_f32_32x32x16_bf16 v[96:111], v[32:35], v[44:47], 0
    ds_read_b128 v[32:35], v136 offset:12800
    buffer_load_dwordx4 v3, s[64:67], s8 offen sc1 lds
    s_add_u32 m0, m0, 8192
    s_add_u32 s8, s8, 8192
    .p2align 3
    v_exp_f32 v121, v121
    v_exp_f32 v122, v122
    v_exp_f32 v123, v123
    s_waitcnt lgkmcnt(3)
    v_mfma_f32_32x32x16_bf16 v[16:31], v[40:43], v[116:119], v[16:31]
    s_mov_b64 exec, s[4:5]
    ds_read_b128 v[40:43], v138 offset:8320
    s_mov_b64 exec, -1
    v_exp_f32 v124, v124
    v_exp_f32 v125, v125
    v_exp_f32 v126, v126
    v_exp_f32 v127, v127
    v_cvt_pk_bf16_f32 v112, v120, v121
    v_cvt_pk_bf16_f32 v113, v122, v123
    v_exp_f32 v128, v128
    s_waitcnt lgkmcnt(3)
    v_mfma_f32_32x32x8_bf16 v[96:111], v[48:49], v[50:51], v[96:111]
    ds_read_b64 v[48:49], v137 offset:12800
    s_cmp_eq_u32 s22, 2
    s_cbranch_scc0 L_sk_4
    v_perm_b32 v92, v210, v208, s7
    v_perm_b32 v93, v214, v212, s7
    v_perm_b32 v94, v218, v216, s7
    v_perm_b32 v95, v222, v220, s7
    buffer_store_dwordx4 v[92:95], v3, s[64:67], s20 offen offset:1024 sc1
L_sk_4:
    .p2align 3
    v_cvt_pk_bf16_f32 v114, v124, v125
    v_cvt_pk_bf16_f32 v115, v126, v127
    v_exp_f32 v129, v129
    v_exp_f32 v130, v130
    v_exp_f32 v131, v131
    s_waitcnt lgkmcnt(3)
    v_mfma_f32_32x32x16_bf16 v[16:31], v[36:39], v[112:115], v[16:31]
    s_mov_b64 exec, s[4:5]
    ds_read_b128 v[36:39], v138 offset:10240
    s_mov_b64 exec, -1
    v_exp_f32 v132, v132
    v_exp_f32 v133, v133
    v_exp_f32 v134, v134
    v_exp_f32 v135, v135
    v_cvt_pk_bf16_f32 v116, v128, v129
    v_cvt_pk_bf16_f32 v117, v130, v131
    v_cvt_pk_bf16_f32 v118, v132, v133
    v_cvt_pk_bf16_f32 v119, v134, v135
    s_setprio 1
    .p2align 3
    v_exp_f32 v96, v96
    s_waitcnt lgkmcnt(3)
    v_mfma_f32_32x32x16_bf16 v[120:135], v[32:35], v[44:47], 0
    ds_read_b128 v[32:35], v136 offset:15360
    buffer_load_dwordx4 v3, s[64:67], s8 offen sc1 lds
    s_add_u32 m0, m0, 8192
    s_add_u32 s8, s8, 8192
    .p2align 3
    v_exp_f32 v97, v97
    v_exp_f32 v98, v98
    v_exp_f32 v99, v99
    s_waitcnt lgkmcnt(3)
    v_mfma_f32_32x32x16_bf16 v[16:31], v[40:43], v[116:119], v[16:31]
    s_mov_b64 exec, s[4:5]
    ds_read_b128 v[40:43], v138 offset:10880
    s_mov_b64 exec, -1
    v_exp_f32 v100, v100
    v_exp_f32 v101, v101
    v_exp_f32 v102, v102
    v_exp_f32 v103, v103
    v_cvt_pk_bf16_f32 v112, v96, v97
    v_cvt_pk_bf16_f32 v113, v98, v99
    v_exp_f32 v104, v104
    s_waitcnt lgkmcnt(3)
    v_mfma_f32_32x32x8_bf16 v[120:135], v[48:49], v[50:51], v[120:135]
    ds_read_b64 v[48:49], v137 offset:15360
    s_cmp_eq_u32 s22, 2
    s_cbranch_scc0 L_sk_5
    v_perm_b32 v88, v211, v209, s6
    v_perm_b32 v89, v215, v213, s6
    v_perm_b32 v90, v219, v217, s6
    v_perm_b32 v91, v223, v221, s6
    buffer_store_dwordx4 v[88:91], v3, s[64:67], s20 offen offset:2048 sc1
L_sk_5:
    .p2align 3
    v_cvt_pk_bf16_f32 v114, v100, v101
    v_cvt_pk_bf16_f32 v115, v102, v103
    v_exp_f32 v105, v105
    v_exp_f32 v106, v106
    v_exp_f32 v107, v107
    s_waitcnt lgkmcnt(3)
    v_mfma_f32_32x32x16_bf16 v[16:31], v[36:39], v[112:115], v[16:31]
    s_mov_b64 exec, s[4:5]
    ds_read_b128 v[36:39], v138 offset:12800
    s_mov_b64 exec, -1
    v_exp_f32 v108, v108
    v_exp_f32 v109, v109
    v_exp_f32 v110, v110
    v_exp_f32 v111, v111
    v_cvt_pk_bf16_f32 v116, v104, v105
    v_cvt_pk_bf16_f32 v117, v106, v107
    v_cvt_pk_bf16_f32 v118, v108, v109
    v_cvt_pk_bf16_f32 v119, v110, v111
    .p2align 3
    v_exp_f32 v120, v120
    s_waitcnt lgkmcnt(3)
    v_mfma_f32_32x32x16_bf16 v[96:111], v[32:35], v[44:47], 0
    ds_read_b128 v[32:35], v136 offset:17920
    buffer_load_dwordx4 v3, s[64:67], s8 offen sc1 lds
    s_add_u32 m0, m0, 8192
    s_add_u32 s8, s8, 8192
    .p2align 3
    v_exp_f32 v121, v121
    v_exp_f32 v122, v122
    v_exp_f32 v123, v123
    s_waitcnt lgkmcnt(3)
    v_mfma_f32_32x32x16_bf16 v[16:31], v[40:43], v[116:119], v[16:31]
    s_mov_b64 exec, s[4:5]
    ds_read_b128 v[40:43], v138 offset:13440
    s_mov_b64 exec, -1
    v_exp_f32 v124, v124
    v_exp_f32 v125, v125
    v_exp_f32 v126, v126
    v_exp_f32 v127, v127
    v_cvt_pk_bf16_f32 v112, v120, v121
    v_cvt_pk_bf16_f32 v113, v122, v123
    v_exp_f32 v128, v128
    s_waitcnt lgkmcnt(3)
    v_mfma_f32_32x32x8_bf16 v[96:111], v[48:49], v[50:51], v[96:111]
    ds_read_b64 v[48:49], v137 offset:17920
    s_cmp_eq_u32 s22, 2
    s_cbranch_scc0 L_sk_6
    v_perm_b32 v92, v211, v209, s7
    v_perm_b32 v93, v215, v213, s7
    v_perm_b32 v94, v219, v217, s7
    v_perm_b32 v95, v223, v221, s7
    buffer_store_dwordx4 v[92:95], v3, s[64:67], s20 offen offset:3072 sc1
L_sk_6:
    .p2align 3
    v_cvt_pk_bf16_f32 v114, v124, v125
    v_cvt_pk_bf16_f32 v115, v126, v127
    v_exp_f32 v129, v129
    v_exp_f32 v130, v130
    v_exp_f32 v131, v131
    s_waitcnt lgkmcnt(3)
    v_mfma_f32_32x32x16_bf16 v[16:31], v[36:39], v[112:115], v[16:31]
    s_mov_b64 exec, s[4:5]
    ds_read_b128 v[36:39], v138 offset:15360
    s_mov_b64 exec, -1
    v_exp_f32 v132, v132
    v_exp_f32 v133, v133
    v_exp_f32 v134, v134
    v_exp_f32 v135, v135
    v_cvt_pk_bf16_f32 v116, v128, v129
    v_cvt_pk_bf16_f32 v117, v130, v131
    v_cvt_pk_bf16_f32 v118, v132, v133
    v_cvt_pk_bf16_f32 v119, v134, v135
    s_setprio 0
    .p2align 3
    v_exp_f32 v96, v96
    s_waitcnt lgkmcnt(3)
    v_mfma_f32_32x32x16_bf16 v[120:135], v[32:35], v[44:47], 0
    ds_read_b128 v[32:35], v136 offset:20480
    buffer_load_dwordx4 v3, s[64:67], s8 offen sc1 lds
    s_add_u32 m0, m0, 8192
    s_add_u32 s8, s8, 8192
    .p2align 3
    v_exp_f32 v97, v97
    v_exp_f32 v98, v98
    v_exp_f32 v99, v99
    s_waitcnt lgkmcnt(3)
    v_mfma_f32_32x32x16_bf16 v[16:31], v[40:43], v[116:119], v[16:31]
    s_mov_b64 exec, s[4:5]
    ds_read_b128 v[40:43], v138 offset:16000
    s_mov_b64 exec, -1
    v_exp_f32 v100, v100
    v_exp_f32 v101, v101
    v_exp_f32 v102, v102
    v_exp_f32 v103, v103
    v_cvt_pk_bf16_f32 v112, v96, v97
    v_cvt_pk_bf16_f32 v113, v98, v99
    v_exp_f32 v104, v104
    s_waitcnt lgkmcnt(3)
    v_mfma_f32_32x32x8_bf16 v[120:135], v[48:49], v[50:51], v[120:135]
    ds_read_b64 v[48:49], v137 offset:20480
    s_cmp_eq_u32 s22, 2
    s_cbranch_scc0 L_sk_7
    v_perm_b32 v88, v225, v224, s6
    v_perm_b32 v89, v227, v226, s6
    v_perm_b32 v90, v229, v228, s6
    v_perm_b32 v91, v231, v230, s6
    s_add_u32 s20, s20, 4096
    buffer_store_dwordx4 v[88:91], v3, s[64:67], s20 offen offset:0 sc1
L_sk_7:
    .p2align 3
    v_cvt_pk_bf16_f32 v114, v100, v101
    v_cvt_pk_bf16_f32 v115, v102, v103
    v_exp_f32 v105, v105
    v_exp_f32 v106, v106
    v_exp_f32 v107, v107
    s_waitcnt lgkmcnt(3)
    v_mfma_f32_32x32x16_bf16 v[16:31], v[36:39], v[112:115], v[16:31]
    s_mov_b64 exec, s[4:5]
    ds_read_b128 v[36:39], v138 offset:17920
    s_mov_b64 exec, -1
    v_exp_f32 v108, v108
    v_exp_f32 v109, v109
    v_exp_f32 v110, v110
    v_exp_f32 v111, v111
    v_cvt_pk_bf16_f32 v116, v104, v105
    v_cvt_pk_bf16_f32 v117, v106, v107
    v_cvt_pk_bf16_f32 v118, v108, v109
    v_cvt_pk_bf16_f32 v119, v110, v111
    s_cmp_eq_u32 s22, 2
    s_cbranch_scc1 L_vw_8
    s_waitcnt vmcnt(7)
L_vw_8:
    s_waitcnt vmcnt(12)
    s_barrier
    s_setprio 3
    .p2align 3
    v_exp_f32 v120, v120
    s_waitcnt lgkmcnt(3)
    v_mfma_f32_32x32x16_bf16 v[96:111], v[32:35], v[44:47], 0
    ds_read_b128 v[32:35], v136 offset:23040
    buffer_load_dwordx4 v3, s[64:67], s8 offen sc1 lds
    s_add_u32 m0, m0, 8192
    s_add_u32 s8, s8, 8192
    .p2align 3
    v_exp_f32 v121, v121
    v_exp_f32 v122, v122
    v_exp_f32 v123, v123
    s_waitcnt lgkmcnt(3)
    v_mfma_f32_32x32x16_bf16 v[16:31], v[40:43], v[116:119], v[16:31]
    s_mov_b64 exec, s[4:5]
    ds_read_b128 v[40:43], v138 offset:18560
    s_mov_b64 exec, -1
    v_exp_f32 v124, v124
    v_exp_f32 v125, v125
    v_exp_f32 v126, v126
    v_exp_f32 v127, v127
    v_cvt_pk_bf16_f32 v112, v120, v121
    v_cvt_pk_bf16_f32 v113, v122, v123
    v_exp_f32 v128, v128
    s_waitcnt lgkmcnt(3)
    v_mfma_f32_32x32x8_bf16 v[96:111], v[48:49], v[50:51], v[96:111]
    ds_read_b64 v[48:49], v137 offset:23040
    buffer_load_dwordx4 v3, s[64:67], s8 offen sc1 lds
    s_add_u32 m0, m0, 8192
    s_add_u32 s8, s8, 8192
    .p2align 3
    v_cvt_pk_bf16_f32 v114, v124, v125
    v_cvt_pk_bf16_f32 v115, v126, v127
    v_exp_f32 v129, v129
    v_exp_f32 v130, v130
    v_exp_f32 v131, v131
    s_waitcnt lgkmcnt(3)
    v_mfma_f32_32x32x16_bf16 v[16:31], v[36:39], v[112:115], v[16:31]
    s_mov_b64 exec, s[4:5]
    ds_read_b128 v[36:39], v138 offset:20480
    s_mov_b64 exec, -1
    v_exp_f32 v132, v132
    v_exp_f32 v133, v133
    v_exp_f32 v134, v134
    v_exp_f32 v135, v135
    v_cvt_pk_bf16_f32 v116, v128, v129
    v_cvt_pk_bf16_f32 v117, v130, v131
    v_cvt_pk_bf16_f32 v118, v132, v133
    v_cvt_pk_bf16_f32 v119, v134, v135
    .p2align 3
    v_exp_f32 v96, v96
    s_waitcnt lgkmcnt(3)
    v_mfma_f32_32x32x16_bf16 v[120:135], v[32:35], v[44:47], 0
    ds_read_b128 v[32:35], v136 offset:25600
    buffer_load_dwordx4 v3, s[64:67], s8 offen sc1 lds
    s_add_u32 m0, m0, 8192
    s_add_u32 s8, s8, 8192
    .p2align 3
    v_exp_f32 v97, v97
    v_exp_f32 v98, v98
    v_exp_f32 v99, v99
    s_waitcnt lgkmcnt(3)
    v_mfma_f32_32x32x16_bf16 v[16:31], v[40:43], v[116:119], v[16:31]
    s_mov_b64 exec, s[4:5]
    ds_read_b128 v[40:43], v138 offset:21120
    s_mov_b64 exec, -1
    v_exp_f32 v100, v100
    v_exp_f32 v101, v101
    v_exp_f32 v102, v102
    v_exp_f32 v103, v103
    v_cvt_pk_bf16_f32 v112, v96, v97
    v_cvt_pk_bf16_f32 v113, v98, v99
    v_exp_f32 v104, v104
    s_waitcnt lgkmcnt(3)
    v_mfma_f32_32x32x8_bf16 v[120:135], v[48:49], v[50:51], v[120:135]
    ds_read_b64 v[48:49], v137 offset:25600
    buffer_load_dwordx4 v3, s[64:67], s8 offen sc1 lds
    s_add_u32 m0, m0, 8192
    s_add_u32 s8, s8, 8192
    .p2align 3
    v_cvt_pk_bf16_f32 v114, v100, v101
    v_cvt_pk_bf16_f32 v115, v102, v103
    v_exp_f32 v105, v105
    v_exp_f32 v106, v106
    v_exp_f32 v107, v107
    s_waitcnt lgkmcnt(3)
    v_mfma_f32_32x32x16_bf16 v[16:31], v[36:39], v[112:115], v[16:31]
    s_mov_b64 exec, s[4:5]
    ds_read_b128 v[36:39], v138 offset:23040
    s_mov_b64 exec, -1
    v_exp_f32 v108, v108
    v_exp_f32 v109, v109
    v_exp_f32 v110, v110
    v_exp_f32 v111, v111
    v_cvt_pk_bf16_f32 v116, v104, v105
    v_cvt_pk_bf16_f32 v117, v106, v107
    v_cvt_pk_bf16_f32 v118, v108, v109
    v_cvt_pk_bf16_f32 v119, v110, v111
    .p2align 3
    v_exp_f32 v120, v120
    s_waitcnt lgkmcnt(3)
    v_mfma_f32_32x32x16_bf16 v[96:111], v[32:35], v[44:47], 0
    ds_read_b128 v[32:35], v136 offset:28160
    buffer_load_dwordx4 v3, s[64:67], s8 offen sc1 lds
    .p2align 3
    v_exp_f32 v121, v121
    v_exp_f32 v122, v122
    v_exp_f32 v123, v123
    s_waitcnt lgkmcnt(3)
    v_mfma_f32_32x32x16_bf16 v[16:31], v[40:43], v[116:119], v[16:31]
    s_mov_b64 exec, s[4:5]
    ds_read_b128 v[40:43], v138 offset:23680
    s_mov_b64 exec, -1
    v_exp_f32 v124, v124
    v_exp_f32 v125, v125
    v_exp_f32 v126, v126
    v_exp_f32 v127, v127
    v_cvt_pk_bf16_f32 v112, v120, v121
    v_cvt_pk_bf16_f32 v113, v122, v123
    v_exp_f32 v128, v128
    s_waitcnt lgkmcnt(3)
    v_mfma_f32_32x32x8_bf16 v[96:111], v[48:49], v[50:51], v[96:111]
    ds_read_b64 v[48:49], v137 offset:28160
    buffer_load_dwordx4 v[64:67], v143, s[48:51], s12 offen
    .p2align 3
    v_cvt_pk_bf16_f32 v114, v124, v125
    v_cvt_pk_bf16_f32 v115, v126, v127
    v_exp_f32 v129, v129
    v_exp_f32 v130, v130
    v_exp_f32 v131, v131
    s_waitcnt lgkmcnt(3)
    v_mfma_f32_32x32x16_bf16 v[16:31], v[36:39], v[112:115], v[16:31]
    s_mov_b64 exec, s[4:5]
    ds_read_b128 v[36:39], v138 offset:25600
    s_mov_b64 exec, -1
    v_exp_f32 v132, v132
    v_exp_f32 v133, v133
    v_exp_f32 v134, v134
    v_exp_f32 v135, v135
    v_cvt_pk_bf16_f32 v116, v128, v129
    v_cvt_pk_bf16_f32 v117, v130, v131
    v_cvt_pk_bf16_f32 v118, v132, v133
    v_cvt_pk_bf16_f32 v119, v134, v135
    s_setprio 2
    .p2align 3
    v_exp_f32 v96, v96
    s_waitcnt lgkmcnt(3)
    v_mfma_f32_32x32x16_bf16 v[120:135], v[32:35], v[44:47], 0
    ds_read_b128 v[32:35], v136 offset:30720
    s_cmp_eq_u32 s22, 2
    s_cbranch_scc0 L_sk_9
    s_waitcnt vmcnt(6)
    s_mov_b64 exec, 1
    buffer_store_dword v61, v60, s[64:67], s25 offen sc1
    s_mov_b64 exec, -1
L_sk_9:
    .p2align 3
    v_exp_f32 v97, v97
    v_exp_f32 v98, v98
    v_exp_f32 v99, v99
    s_waitcnt lgkmcnt(3)
    v_mfma_f32_32x32x16_bf16 v[16:31], v[40:43], v[116:119], v[16:31]
    s_mov_b64 exec, s[4:5]
    ds_read_b128 v[40:43], v138 offset:26240
    s_mov_b64 exec, -1
    v_exp_f32 v100, v100
    v_exp_f32 v101, v101
    v_exp_f32 v102, v102
    v_exp_f32 v103, v103
    v_cvt_pk_bf16_f32 v112, v96, v97
    v_cvt_pk_bf16_f32 v113, v98, v99
    v_exp_f32 v104, v104
    s_waitcnt lgkmcnt(3)
    v_mfma_f32_32x32x8_bf16 v[120:135], v[48:49], v[50:51], v[120:135]
    ds_read_b64 v[48:49], v137 offset:30720
    buffer_load_dwordx4 v[68:71], v144, s[48:51], s12 offen
    .p2align 3
    v_cvt_pk_bf16_f32 v114, v100, v101
    v_cvt_pk_bf16_f32 v115, v102, v103
    v_exp_f32 v105, v105
    v_exp_f32 v106, v106
    v_exp_f32 v107, v107
    s_waitcnt lgkmcnt(3)
    v_mfma_f32_32x32x16_bf16 v[16:31], v[36:39], v[112:115], v[16:31]
    s_mov_b64 exec, s[4:5]
    ds_read_b128 v[36:39], v138 offset:28160
    s_mov_b64 exec, -1
    v_exp_f32 v108, v108
    v_exp_f32 v109, v109
    v_exp_f32 v110, v110
    v_exp_f32 v111, v111
    v_cvt_pk_bf16_f32 v116, v104, v105
    v_cvt_pk_bf16_f32 v117, v106, v107
    v_cvt_pk_bf16_f32 v118, v108, v109
    v_cvt_pk_bf16_f32 v119, v110, v111
    .p2align 3
    v_exp_f32 v120, v120
    s_waitcnt lgkmcnt(3)
    v_mfma_f32_32x32x16_bf16 v[96:111], v[32:35], v[44:47], 0
    ds_read_b128 v[32:35], v136 offset:33280
    v_exp_f32 v121, v121
    v_exp_f32 v122, v122
    v_exp_f32 v123, v123
    s_waitcnt lgkmcnt(3)
    v_mfma_f32_32x32x16_bf16 v[16:31], v[40:43], v[116:119], v[16:31]
    s_mov_b64 exec, s[4:5]
    ds_read_b128 v[40:43], v138 offset:28800
    s_mov_b64 exec, -1
    v_exp_f32 v124, v124
    v_exp_f32 v125, v125
    v_exp_f32 v126, v126
    v_exp_f32 v127, v127
    v_cvt_pk_bf16_f32 v112, v120, v121
    v_cvt_pk_bf16_f32 v113, v122, v123
    v_exp_f32 v128, v128
    s_waitcnt lgkmcnt(3)
    v_mfma_f32_32x32x8_bf16 v[96:111], v[48:49], v[50:51], v[96:111]
    ds_read_b64 v[48:49], v137 offset:33280
    v_cvt_pk_bf16_f32 v114, v124, v125
    v_cvt_pk_bf16_f32 v115, v126, v127
    v_exp_f32 v129, v129
    v_exp_f32 v130, v130
    v_exp_f32 v131, v131
    s_waitcnt lgkmcnt(3)
    v_mfma_f32_32x32x16_bf16 v[16:31], v[36:39], v[112:115], v[16:31]
    s_mov_b64 exec, s[4:5]
    ds_read_b128 v[36:39], v138 offset:30720
    s_mov_b64 exec, -1
    v_exp_f32 v132, v132
    v_exp_f32 v133, v133
    v_exp_f32 v134, v134
    v_exp_f32 v135, v135
    v_cvt_pk_bf16_f32 v116, v128, v129
    v_cvt_pk_bf16_f32 v117, v130, v131
    v_cvt_pk_bf16_f32 v118, v132, v133
    v_cvt_pk_bf16_f32 v119, v134, v135
    .p2align 3
    v_exp_f32 v96, v96
    s_waitcnt lgkmcnt(3)
    v_mfma_f32_32x32x16_bf16 v[120:135], v[32:35], v[44:47], 0
    ds_read_b128 v[32:35], v136 offset:35840
    buffer_load_dwordx4 v[72:75], v145, s[48:51], s12 offen
    .p2align 3
    v_exp_f32 v97, v97
    v_exp_f32 v98, v98
    v_exp_f32 v99, v99
    s_waitcnt lgkmcnt(3)
    v_mfma_f32_32x32x16_bf16 v[16:31], v[40:43], v[116:119], v[16:31]
    s_mov_b64 exec, s[4:5]
    ds_read_b128 v[40:43], v138 offset:31360
    s_mov_b64 exec, -1
    v_exp_f32 v100, v100
    v_exp_f32 v101, v101
    v_exp_f32 v102, v102
    v_exp_f32 v103, v103
    v_cvt_pk_bf16_f32 v112, v96, v97
    v_cvt_pk_bf16_f32 v113, v98, v99
    v_exp_f32 v104, v104
    s_waitcnt lgkmcnt(3)
    v_mfma_f32_32x32x8_bf16 v[120:135], v[48:49], v[50:51], v[120:135]
    ds_read_b64 v[48:49], v137 offset:35840
    v_cvt_pk_bf16_f32 v114, v100, v101
    v_cvt_pk_bf16_f32 v115, v102, v103
    v_exp_f32 v105, v105
    v_exp_f32 v106, v106
    v_exp_f32 v107, v107
    s_waitcnt lgkmcnt(3)
    v_mfma_f32_32x32x16_bf16 v[16:31], v[36:39], v[112:115], v[16:31]
    s_mov_b64 exec, s[4:5]
    ds_read_b128 v[36:39], v138 offset:33280
    s_mov_b64 exec, -1
    v_exp_f32 v108, v108
    v_exp_f32 v109, v109
    v_exp_f32 v110, v110
    v_exp_f32 v111, v111
    v_cvt_pk_bf16_f32 v116, v104, v105
    v_cvt_pk_bf16_f32 v117, v106, v107
    v_cvt_pk_bf16_f32 v118, v108, v109
    v_cvt_pk_bf16_f32 v119, v110, v111
    .p2align 3
    v_exp_f32 v120, v120
    s_waitcnt lgkmcnt(3)
    v_mfma_f32_32x32x16_bf16 v[96:111], v[32:35], v[44:47], 0
    ds_read_b128 v[32:35], v136 offset:38400
    s_add_u32 s12, s12, 393216
    buffer_load_dwordx4 v[76:79], v143, s[48:51], s12 offen
    .p2align 3
    v_exp_f32 v121, v121
    v_exp_f32 v122, v122
    v_exp_f32 v123, v123
    s_waitcnt lgkmcnt(3)
    v_mfma_f32_32x32x16_bf16 v[16:31], v[40:43], v[116:119], v[16:31]
    s_mov_b64 exec, s[4:5]
    ds_read_b128 v[40:43], v138 offset:33920
    s_mov_b64 exec, -1
    v_exp_f32 v124, v124
    v_exp_f32 v125, v125
    v_exp_f32 v126, v126
    v_exp_f32 v127, v127
    v_cvt_pk_bf16_f32 v112, v120, v121
    v_cvt_pk_bf16_f32 v113, v122, v123
    v_exp_f32 v128, v128
    s_waitcnt lgkmcnt(3)
    v_mfma_f32_32x32x8_bf16 v[96:111], v[48:49], v[50:51], v[96:111]
    ds_read_b64 v[48:49], v137 offset:38400
    v_cvt_pk_bf16_f32 v114, v124, v125
    v_cvt_pk_bf16_f32 v115, v126, v127
    v_exp_f32 v129, v129
    v_exp_f32 v130, v130
    v_exp_f32 v131, v131
    s_waitcnt lgkmcnt(3)
    v_mfma_f32_32x32x16_bf16 v[16:31], v[36:39], v[112:115], v[16:31]
    s_mov_b64 exec, s[4:5]
    ds_read_b128 v[36:39], v138 offset:35840
    s_mov_b64 exec, -1
    v_exp_f32 v132, v132
    v_exp_f32 v133, v133
    v_exp_f32 v134, v134
    v_exp_f32 v135, v135
    v_cvt_pk_bf16_f32 v116, v128, v129
    v_cvt_pk_bf16_f32 v117, v130, v131
    v_cvt_pk_bf16_f32 v118, v132, v133
    v_cvt_pk_bf16_f32 v119, v134, v135
    s_setprio 1
    .p2align 3
    v_exp_f32 v96, v96
    s_waitcnt lgkmcnt(3)
    v_mfma_f32_32x32x16_bf16 v[120:135], v[32:35], v[44:47], 0
    ds_read_b128 v[32:35], v136 offset:40960
    buffer_load_dwordx4 v[80:83], v144, s[48:51], s12 offen
    .p2align 3
    v_exp_f32 v97, v97
    v_exp_f32 v98, v98
    v_exp_f32 v99, v99
    s_waitcnt lgkmcnt(3)
    v_mfma_f32_32x32x16_bf16 v[16:31], v[40:43], v[116:119], v[16:31]
    s_mov_b64 exec, s[4:5]
    ds_read_b128 v[40:43], v138 offset:36480
    s_mov_b64 exec, -1
    v_exp_f32 v100, v100
    v_exp_f32 v101, v101
    v_exp_f32 v102, v102
    v_exp_f32 v103, v103
    v_cvt_pk_bf16_f32 v112, v96, v97
    v_cvt_pk_bf16_f32 v113, v98, v99
    v_exp_f32 v104, v104
    s_waitcnt lgkmcnt(3)
    v_mfma_f32_32x32x8_bf16 v[120:135], v[48:49], v[50:51], v[120:135]
    ds_read_b64 v[48:49], v137 offset:40960
    v_cvt_pk_bf16_f32 v114, v100, v101
    v_cvt_pk_bf16_f32 v115, v102, v103
    v_exp_f32 v105, v105
    v_exp_f32 v106, v106
    v_exp_f32 v107, v107
    s_waitcnt lgkmcnt(3)
    v_mfma_f32_32x32x16_bf16 v[16:31], v[36:39], v[112:115], v[16:31]
    s_mov_b64 exec, s[4:5]
    ds_read_b128 v[36:39], v138 offset:38400
    s_mov_b64 exec, -1
    v_exp_f32 v108, v108
    v_exp_f32 v109, v109
    v_exp_f32 v110, v110
    v_exp_f32 v111, v111
    v_cvt_pk_bf16_f32 v116, v104, v105
    v_cvt_pk_bf16_f32 v117, v106, v107
    v_cvt_pk_bf16_f32 v118, v108, v109
    v_cvt_pk_bf16_f32 v119, v110, v111
    .p2align 3
    v_exp_f32 v120, v120
    s_waitcnt lgkmcnt(3)
    v_mfma_f32_32x32x16_bf16 v[96:111], v[32:35], v[44:47], 0
    ds_read_b128 v[32:35], v136 offset:43520
    buffer_load_dwordx4 v[84:87], v145, s[48:51], s12 offen
    .p2align 3
    v_exp_f32 v121, v121
    v_exp_f32 v122, v122
    v_exp_f32 v123, v123
    s_waitcnt lgkmcnt(3)
    v_mfma_f32_32x32x16_bf16 v[16:31], v[40:43], v[116:119], v[16:31]
    s_mov_b64 exec, s[4:5]
    ds_read_b128 v[40:43], v138 offset:39040
    s_mov_b64 exec, -1
    v_exp_f32 v124, v124
    v_exp_f32 v125, v125
    v_exp_f32 v126, v126
    v_exp_f32 v127, v127
    v_cvt_pk_bf16_f32 v112, v120, v121
    v_cvt_pk_bf16_f32 v113, v122, v123
    v_exp_f32 v128, v128
    s_waitcnt lgkmcnt(3)
    v_mfma_f32_32x32x8_bf16 v[96:111], v[48:49], v[50:51], v[96:111]
    ds_read_b64 v[48:49], v137 offset:43520
    v_cvt_pk_bf16_f32 v114, v124, v125
    v_cvt_pk_bf16_f32 v115, v126, v127
    v_exp_f32 v129, v129
    v_exp_f32 v130, v130
    v_exp_f32 v131, v131
    s_waitcnt lgkmcnt(3)
    v_mfma_f32_32x32x16_bf16 v[16:31], v[36:39], v[112:115], v[16:31]
    s_mov_b64 exec, s[4:5]
    ds_read_b128 v[36:39], v138 offset:40960
    s_mov_b64 exec, -1
    v_exp_f32 v132, v132
    v_exp_f32 v133, v133
    v_exp_f32 v134, v134
    v_exp_f32 v135, v135
    v_cvt_pk_bf16_f32 v116, v128, v129
    v_cvt_pk_bf16_f32 v117, v130, v131
    v_cvt_pk_bf16_f32 v118, v132, v133
    v_cvt_pk_bf16_f32 v119, v134, v135
    s_setprio 0
    .p2align 3
    v_exp_f32 v96, v96
    s_waitcnt lgkmcnt(3)
    v_mfma_f32_32x32x16_bf16 v[120:135], v[32:35], v[44:47], 0
    ds_read_b128 v[32:35], v136 offset:46080
    buffer_load_dwordx2 v[62:63], v154, s[64:67], 0 offen sc1
    .p2align 3
    v_exp_f32 v97, v97
    v_exp_f32 v98, v98
    v_exp_f32 v99, v99
    s_waitcnt lgkmcnt(3)
    v_mfma_f32_32x32x16_bf16 v[16:31], v[40:43], v[116:119], v[16:31]
    s_mov_b64 exec, s[4:5]
    ds_read_b128 v[40:43], v138 offset:41600
    s_mov_b64 exec, -1
    v_exp_f32 v100, v100
    v_exp_f32 v101, v101
    v_exp_f32 v102, v102
    v_exp_f32 v103, v103
    v_cvt_pk_bf16_f32 v112, v96, v97
    v_cvt_pk_bf16_f32 v113, v98, v99
    v_exp_f32 v104, v104
    s_waitcnt lgkmcnt(3)
    v_mfma_f32_32x32x8_bf16 v[120:135], v[48:49], v[50:51], v[120:135]
    ds_read_b64 v[48:49], v137 offset:46080
    v_cvt_pk_bf16_f32 v114, v100, v101
    v_cvt_pk_bf16_f32 v115, v102, v103
    v_exp_f32 v105, v105
    v_exp_f32 v106, v106
    v_exp_f32 v107, v107
    s_waitcnt lgkmcnt(3)
    v_mfma_f32_32x32x16_bf16 v[16:31], v[36:39], v[112:115], v[16:31]
    s_mov_b64 exec, s[4:5]
    ds_read_b128 v[36:39], v138 offset:43520
    s_mov_b64 exec, -1
    v_exp_f32 v108, v108
    v_exp_f32 v109, v109
    v_exp_f32 v110, v110
    v_exp_f32 v111, v111
    v_cvt_pk_bf16_f32 v116, v104, v105
    v_cvt_pk_bf16_f32 v117, v106, v107
    v_cvt_pk_bf16_f32 v118, v108, v109
    v_cvt_pk_bf16_f32 v119, v110, v111
    s_cmp_eq_u32 s22, 2
    s_cbranch_scc1 L_vw_10
    s_waitcnt vmcnt(7)
L_vw_10:
    s_waitcnt vmcnt(8)
    s_barrier
    s_setprio 3
    .p2align 3
    v_exp_f32 v120, v120
    s_waitcnt lgkmcnt(3)
    v_mfma_f32_32x32x16_bf16 v[96:111], v[32:35], v[44:47], 0
    ds_read_b128 v[32:35], v136 offset:48640
    s_add_u32 m0, s17, 0
    s_nop 0
    buffer_load_dwordx4 v143, s[48:51], s16 offen lds
    .p2align 3
    v_exp_f32 v121, v121
    v_exp_f32 v122, v122
    v_exp_f32 v123, v123
    s_waitcnt lgkmcnt(3)
    v_mfma_f32_32x32x16_bf16 v[16:31], v[40:43], v[116:119], v[16:31]
    s_mov_b64 exec, s[4:5]
    ds_read_b128 v[40:43], v138 offset:44160
    s_mov_b64 exec, -1
    v_exp_f32 v124, v124
    v_exp_f32 v125, v125
    v_exp_f32 v126, v126
    v_exp_f32 v127, v127
    v_cvt_pk_bf16_f32 v112, v120, v121
    v_cvt_pk_bf16_f32 v113, v122, v123
    v_exp_f32 v128, v128
    s_waitcnt lgkmcnt(3)
    v_mfma_f32_32x32x8_bf16 v[96:111], v[48:49], v[50:51], v[96:111]
    ds_read_b64 v[48:49], v137 offset:48640
    v_cvt_pk_bf16_f32 v114, v124, v125
    v_cvt_pk_bf16_f32 v115, v126, v127
    v_exp_f32 v129, v129
    v_exp_f32 v130, v130
    v_exp_f32 v131, v131
    s_waitcnt lgkmcnt(3)
    v_mfma_f32_32x32x16_bf16 v[16:31], v[36:39], v[112:115], v[16:31]
    s_mov_b64 exec, s[4:5]
    ds_read_b128 v[36:39], v138 offset:46080
    s_mov_b64 exec, -1
    v_exp_f32 v132, v132
    v_exp_f32 v133, v133
    v_exp_f32 v134, v134
    v_exp_f32 v135, v135
    v_cvt_pk_bf16_f32 v116, v128, v129
    v_cvt_pk_bf16_f32 v117, v130, v131
    v_cvt_pk_bf16_f32 v118, v132, v133
    v_cvt_pk_bf16_f32 v119, v134, v135
    .p2align 3
    v_exp_f32 v96, v96
    s_waitcnt lgkmcnt(3)
    v_mfma_f32_32x32x16_bf16 v[120:135], v[32:35], v[44:47], 0
    ds_read_b128 v[32:35], v136 offset:51200
    s_waitcnt vmcnt(1)
    s_movk_i32 s85, 0x7fff
L_plp:
    v_min_u32 v62, v62, v63
    v_cmp_le_u32 vcc, 1, v62
    s_nop 0
    s_cmp_eq_u64 vcc, exec
    s_cbranch_scc1 L_pld
    buffer_load_dwordx2 v[62:63], v154, s[64:67], 0 offen sc1
    s_sub_u32 s85, s85, 1
    s_waitcnt vmcnt(0)
    s_cbranch_scc0 L_plp
L_pld:
    .p2align 3
    v_exp_f32 v97, v97
    v_exp_f32 v98, v98
    v_exp_f32 v99, v99
    s_waitcnt lgkmcnt(3)
    v_mfma_f32_32x32x16_bf16 v[16:31], v[40:43], v[116:119], v[16:31]
    s_mov_b64 exec, s[4:5]
    ds_read_b128 v[40:43], v138 offset:46720
    s_mov_b64 exec, -1
    v_exp_f32 v100, v100
    v_exp_f32 v101, v101
    v_exp_f32 v102, v102
    v_exp_f32 v103, v103
    v_cvt_pk_bf16_f32 v112, v96, v97
    v_cvt_pk_bf16_f32 v113, v98, v99
    v_exp_f32 v104, v104
    s_waitcnt lgkmcnt(3)
    v_mfma_f32_32x32x8_bf16 v[120:135], v[48:49], v[50:51], v[120:135]
    ds_read_b64 v[48:49], v137 offset:51200
    s_mov_b32 exec_lo, 0xfff
    s_mov_b32 exec_hi, 0x0
    buffer_load_dword v63, v141, s[64:67], s26 offen sc1
    s_mov_b64 exec, -1
    .p2align 3
    v_cvt_pk_bf16_f32 v114, v100, v101
    v_cvt_pk_bf16_f32 v115, v102, v103
    v_exp_f32 v105, v105
    v_exp_f32 v106, v106
    v_exp_f32 v107, v107
    s_waitcnt lgkmcnt(3)
    v_mfma_f32_32x32x16_bf16 v[16:31], v[36:39], v[112:115], v[16:31]
    s_mov_b64 exec, s[4:5]
    ds_read_b128 v[36:39], v138 offset:48640
    s_mov_b64 exec, -1
    v_exp_f32 v108, v108
    v_exp_f32 v109, v109
    v_exp_f32 v110, v110
    v_exp_f32 v111, v111
    v_cvt_pk_bf16_f32 v116, v104, v105
    v_cvt_pk_bf16_f32 v117, v106, v107
    v_cvt_pk_bf16_f32 v118, v108, v109
    v_cvt_pk_bf16_f32 v119, v110, v111
    .p2align 3
    v_exp_f32 v120, v120
    s_waitcnt lgkmcnt(3)
    v_mfma_f32_32x32x16_bf16 v[96:111], v[32:35], v[44:47], 0
    ds_read_b128 v[32:35], v136 offset:53760
    s_mov_b32 exec_lo, 0x1fff000
    s_mov_b32 exec_hi, 0x0
    buffer_load_dword v63, v141, s[64:67], s26 offen sc1
    s_mov_b64 exec, -1
    .p2align 3
    v_exp_f32 v121, v121
    v_exp_f32 v122, v122
    v_exp_f32 v123, v123
    s_waitcnt lgkmcnt(3)
    v_mfma_f32_32x32x16_bf16 v[16:31], v[40:43], v[116:119], v[16:31]
    s_mov_b64 exec, s[4:5]
    ds_read_b128 v[40:43], v138 offset:49280
    s_mov_b64 exec, -1
    v_exp_f32 v124, v124
    v_exp_f32 v125, v125
    v_exp_f32 v126, v126
    v_exp_f32 v127, v127
    v_cvt_pk_bf16_f32 v112, v120, v121
    v_cvt_pk_bf16_f32 v113, v122, v123
    v_exp_f32 v128, v128
    s_waitcnt lgkmcnt(3)
    v_mfma_f32_32x32x8_bf16 v[96:111], v[48:49], v[50:51], v[96:111]
    ds_read_b64 v[48:49], v137 offset:53760
    v_cvt_pk_bf16_f32 v114, v124, v125
    v_cvt_pk_bf16_f32 v115, v126, v127
    v_exp_f32 v129, v129
    v_exp_f32 v130, v130
    v_exp_f32 v131, v131
    s_waitcnt lgkmcnt(3)
    v_mfma_f32_32x32x16_bf16 v[16:31], v[36:39], v[112:115], v[16:31]
    s_mov_b64 exec, s[4:5]
    ds_read_b128 v[36:39], v138 offset:51200
    s_mov_b64 exec, -1
    v_exp_f32 v132, v132
    v_exp_f32 v133, v133
    v_exp_f32 v134, v134
    v_exp_f32 v135, v135
    v_cvt_pk_bf16_f32 v116, v128, v129
    v_cvt_pk_bf16_f32 v117, v130, v131
    v_cvt_pk_bf16_f32 v118, v132, v133
    v_cvt_pk_bf16_f32 v119, v134, v135
    .p2align 3
    v_exp_f32 v96, v96
    s_waitcnt lgkmcnt(3)
    v_mfma_f32_32x32x16_bf16 v[120:135], v[32:35], v[44:47], 0
    ds_read_b128 v[32:35], v136 offset:56320
    s_add_u32 m0, s17, 1024
    s_nop 0
    buffer_load_dwordx4 v144, s[48:51], s16 offen lds
    .p2align 3
    v_exp_f32 v97, v97
    v_exp_f32 v98, v98
    v_exp_f32 v99, v99
    s_waitcnt lgkmcnt(3)
    v_mfma_f32_32x32x16_bf16 v[16:31], v[40:43], v[116:119], v[16:31]
    s_mov_b64 exec, s[4:5]
    ds_read_b128 v[40:43], v138 offset:51840
    s_mov_b64 exec, -1
    v_exp_f32 v100, v100
    v_exp_f32 v101, v101
    v_exp_f32 v102, v102
    v_exp_f32 v103, v103
    v_cvt_pk_bf16_f32 v112, v96, v97
    v_cvt_pk_bf16_f32 v113, v98, v99
    v_exp_f32 v104, v104
    s_waitcnt lgkmcnt(3)
    v_mfma_f32_32x32x8_bf16 v[120:135], v[48:49], v[50:51], v[120:135]
    ds_read_b64 v[48:49], v137 offset:56320
    v_cvt_pk_bf16_f32 v114, v100, v101
    v_cvt_pk_bf16_f32 v115, v102, v103
    v_exp_f32 v105, v105
    v_exp_f32 v106, v106
    v_exp_f32 v107, v107
    s_waitcnt lgkmcnt(3)
    v_mfma_f32_32x32x16_bf16 v[16:31], v[36:39], v[112:115], v[16:31]
    s_mov_b64 exec, s[4:5]
    ds_read_b128 v[36:39], v138 offset:53760
    s_mov_b64 exec, -1
    v_exp_f32 v108, v108
    v_exp_f32 v109, v109
    v_exp_f32 v110, v110
    v_exp_f32 v111, v111
    v_cvt_pk_bf16_f32 v116, v104, v105
    v_cvt_pk_bf16_f32 v117, v106, v107
    v_cvt_pk_bf16_f32 v118, v108, v109
    v_cvt_pk_bf16_f32 v119, v110, v111
    .p2align 3
    v_exp_f32 v120, v120
    s_waitcnt lgkmcnt(3)
    v_mfma_f32_32x32x16_bf16 v[96:111], v[32:35], v[44:47], 0
    ds_read_b128 v[32:35], v136 offset:58880
    s_add_u32 m0, s17, 2048
    s_nop 0
    buffer_load_dwordx4 v145, s[48:51], s16 offen lds
    .p2align 3
    v_exp_f32 v121, v121
    v_exp_f32 v122, v122
    v_exp_f32 v123, v123
    s_waitcnt lgkmcnt(3)
    v_mfma_f32_32x32x16_bf16 v[16:31], v[40:43], v[116:119], v[16:31]
    s_mov_b64 exec, s[4:5]
    ds_read_b128 v[40:43], v138 offset:54400
    s_mov_b64 exec, -1
    v_exp_f32 v124, v124
    v_exp_f32 v125, v125
    v_exp_f32 v126, v126
    v_exp_f32 v127, v127
    v_cvt_pk_bf16_f32 v112, v120, v121
    v_cvt_pk_bf16_f32 v113, v122, v123
    v_exp_f32 v128, v128
    s_waitcnt lgkmcnt(3)
    v_mfma_f32_32x32x8_bf16 v[96:111], v[48:49], v[50:51], v[96:111]
    ds_read_b64 v[48:49], v137 offset:58880
    v_cvt_pk_bf16_f32 v114, v124, v125
    v_cvt_pk_bf16_f32 v115, v126, v127
    v_exp_f32 v129, v129
    v_exp_f32 v130, v130
    v_exp_f32 v131, v131
    s_waitcnt lgkmcnt(3)
    v_mfma_f32_32x32x16_bf16 v[16:31], v[36:39], v[112:115], v[16:31]
    s_mov_b64 exec, s[4:5]
    ds_read_b128 v[36:39], v138 offset:56320
    s_mov_b64 exec, -1
    v_exp_f32 v132, v132
    v_exp_f32 v133, v133
    v_exp_f32 v134, v134
    v_exp_f32 v135, v135
    v_cvt_pk_bf16_f32 v116, v128, v129
    v_cvt_pk_bf16_f32 v117, v130, v131
    v_cvt_pk_bf16_f32 v118, v132, v133
    v_cvt_pk_bf16_f32 v119, v134, v135
    .p2align 3
    v_exp_f32 v96, v96
    s_waitcnt lgkmcnt(3)
    v_mfma_f32_32x32x16_bf16 v[120:135], v[32:35], v[44:47], 0
    ds_read_b128 v[32:35], v136 offset:61440
    v_exp_f32 v97, v97
    v_exp_f32 v98, v98
    v_exp_f32 v99, v99
    s_waitcnt lgkmcnt(3)
    v_mfma_f32_32x32x16_bf16 v[16:31], v[40:43], v[116:119], v[16:31]
    s_mov_b64 exec, s[4:5]
    ds_read_b128 v[40:43], v138 offset:56960
    s_mov_b64 exec, -1
    v_exp_f32 v100, v100
    v_exp_f32 v101, v101
    v_exp_f32 v102, v102
    v_exp_f32 v103, v103
    v_cvt_pk_bf16_f32 v112, v96, v97
    v_cvt_pk_bf16_f32 v113, v98, v99
    v_exp_f32 v104, v104
    s_waitcnt lgkmcnt(3)
    v_mfma_f32_32x32x8_bf16 v[120:135], v[48:49], v[50:51], v[120:135]
    ds_read_b64 v[48:49], v137 offset:61440
    v_cvt_pk_bf16_f32 v114, v100, v101
    v_cvt_pk_bf16_f32 v115, v102, v103
    v_exp_f32 v105, v105
    v_exp_f32 v106, v106
    v_exp_f32 v107, v107
    s_waitcnt lgkmcnt(3)
    v_mfma_f32_32x32x16_bf16 v[16:31], v[36:39], v[112:115], v[16:31]
    s_mov_b64 exec, s[4:5]
    ds_read_b128 v[36:39], v138 offset:58880
    s_mov_b64 exec, -1
    v_exp_f32 v108, v108
    v_exp_f32 v109, v109
    v_exp_f32 v110, v110
    v_exp_f32 v111, v111
    v_cvt_pk_bf16_f32 v116, v104, v105
    v_cvt_pk_bf16_f32 v117, v106, v107
    v_cvt_pk_bf16_f32 v118, v108, v109
    v_cvt_pk_bf16_f32 v119, v110, v111
    s_setprio 2
    .p2align 3
    v_exp_f32 v120, v120
    s_waitcnt lgkmcnt(3)
    v_mfma_f32_32x32x16_bf16 v[96:111], v[32:35], v[44:47], 0
    ds_read_b128 v[32:35], v136 offset:64000
    v_exp_f32 v121, v121
    v_exp_f32 v122, v122
    v_exp_f32 v123, v123
    s_waitcnt lgkmcnt(3)
    v_mfma_f32_32x32x16_bf16 v[16:31], v[40:43], v[116:119], v[16:31]
    s_mov_b64 exec, s[4:5]
    ds_read_b128 v[40:43], v138 offset:59520
    s_mov_b64 exec, -1
    v_exp_f32 v124, v124
    v_exp_f32 v125, v125
    v_exp_f32 v126, v126
    v_exp_f32 v127, v127
    v_cvt_pk_bf16_f32 v112, v120, v121
    v_cvt_pk_bf16_f32 v113, v122, v123
    v_exp_f32 v128, v128
    s_waitcnt lgkmcnt(3)
    v_mfma_f32_32x32x8_bf16 v[96:111], v[48:49], v[50:51], v[96:111]
    ds_read_b64 v[48:49], v137 offset:64000
    v_cvt_pk_bf16_f32 v114, v124, v125
    v_cvt_pk_bf16_f32 v115, v126, v127
    v_exp_f32 v129, v129
    v_exp_f32 v130, v130
    v_exp_f32 v131, v131
    s_waitcnt lgkmcnt(3)
    v_mfma_f32_32x32x16_bf16 v[16:31], v[36:39], v[112:115], v[16:31]
    s_mov_b64 exec, s[4:5]
    ds_read_b128 v[36:39], v138 offset:61440
    s_mov_b64 exec, -1
    v_exp_f32 v132, v132
    v_exp_f32 v133, v133
    v_exp_f32 v134, v134
    v_exp_f32 v135, v135
    v_cvt_pk_bf16_f32 v116, v128, v129
    v_cvt_pk_bf16_f32 v117, v130, v131
    v_cvt_pk_bf16_f32 v118, v132, v133
    v_cvt_pk_bf16_f32 v119, v134, v135
    .p2align 3
    v_exp_f32 v96, v96
    s_waitcnt lgkmcnt(3)
    v_mfma_f32_32x32x16_bf16 v[120:135], v[32:35], v[44:47], 0
    v_add_u32 v136, 61440, v136
    ds_read_b128 v[32:35], v136 offset:5120
    buffer_load_dwordx4 v[156:159], v14, s[64:67], s21 offen offset:0 sc1
    .p2align 3
    v_exp_f32 v97, v97
    v_exp_f32 v98, v98
    v_exp_f32 v99, v99
    s_waitcnt lgkmcnt(3)
    v_mfma_f32_32x32x16_bf16 v[16:31], v[40:43], v[116:119], v[16:31]
    s_mov_b64 exec, s[4:5]
    ds_read_b128 v[40:43], v138 offset:62080
    s_mov_b64 exec, -1
    v_exp_f32 v100, v100
    v_exp_f32 v101, v101
    v_exp_f32 v102, v102
    v_exp_f32 v103, v103
    v_cvt_pk_bf16_f32 v112, v96, v97
    v_cvt_pk_bf16_f32 v113, v98, v99
    v_exp_f32 v104, v104
    s_waitcnt lgkmcnt(3)
    v_mfma_f32_32x32x8_bf16 v[120:135], v[48:49], v[50:51], v[120:135]
    v_add_u32 v137, 61440, v137
    ds_read_b64 v[48:49], v137 offset:5120
    buffer_load_dwordx4 v[160:163], v14, s[64:67], s21 offen offset:1024 sc1
    .p2align 3
    v_cvt_pk_bf16_f32 v114, v100, v101
    v_cvt_pk_bf16_f32 v115, v102, v103
    v_exp_f32 v105, v105
    v_exp_f32 v106, v106
    v_exp_f32 v107, v107
    s_waitcnt lgkmcnt(3)
    v_mfma_f32_32x32x16_bf16 v[16:31], v[36:39], v[112:115], v[16:31]
    s_mov_b64 exec, s[4:5]
    ds_read_b128 v[36:39], v138 offset:64000
    s_mov_b64 exec, -1
    v_exp_f32 v108, v108
    v_exp_f32 v109, v109
    v_exp_f32 v110, v110
    v_exp_f32 v111, v111
    v_cvt_pk_bf16_f32 v116, v104, v105
    v_cvt_pk_bf16_f32 v117, v106, v107
    v_cvt_pk_bf16_f32 v118, v108, v109
    v_cvt_pk_bf16_f32 v119, v110, v111
    .p2align 3
    v_exp_f32 v120, v120
    s_waitcnt lgkmcnt(3)
    v_mfma_f32_32x32x16_bf16 v[96:111], v[32:35], v[44:47], 0
    ds_read_b128 v[32:35], v136 offset:7680
    buffer_load_dwordx4 v[164:167], v14, s[64:67], s21 offen offset:2048 sc1
    .p2align 3
    v_exp_f32 v121, v121
    v_exp_f32 v122, v122
    v_exp_f32 v123, v123
    s_waitcnt lgkmcnt(3)
    v_mfma_f32_32x32x16_bf16 v[16:31], v[40:43], v[116:119], v[16:31]
    s_mov_b64 exec, s[4:5]
    ds_read_b128 v[40:43], v138 offset:64640
    s_mov_b64 exec, -1
    v_exp_f32 v124, v124
    v_exp_f32 v125, v125
    v_exp_f32 v126, v126
    v_exp_f32 v127, v127
    v_cvt_pk_bf16_f32 v112, v120, v121
    v_cvt_pk_bf16_f32 v113, v122, v123
    v_exp_f32 v128, v128
    s_waitcnt lgkmcnt(3)
    v_mfma_f32_32x32x8_bf16 v[96:111], v[48:49], v[50:51], v[96:111]
    ds_read_b64 v[48:49], v137 offset:7680
    buffer_load_dwordx4 v[168:171], v14, s[64:67], s21 offen offset:3072 sc1
    .p2align 3
    v_cvt_pk_bf16_f32 v114, v124, v125
    v_cvt_pk_bf16_f32 v115, v126, v127
    v_exp_f32 v129, v129
    v_exp_f32 v130, v130
    v_exp_f32 v131, v131
    s_waitcnt lgkmcnt(3)
    v_mfma_f32_32x32x16_bf16 v[16:31], v[36:39], v[112:115], v[16:31]
    v_add_u32 v138, 61440, v138
    s_mov_b64 exec, s[4:5]
    ds_read_b128 v[36:39], v138 offset:5120
    s_mov_b64 exec, -1
    v_exp_f32 v132, v132
    v_exp_f32 v133, v133
    v_exp_f32 v134, v134
    v_exp_f32 v135, v135
    v_cvt_pk_bf16_f32 v116, v128, v129
    v_cvt_pk_bf16_f32 v117, v130, v131
    v_cvt_pk_bf16_f32 v118, v132, v133
    v_cvt_pk_bf16_f32 v119, v134, v135
    .p2align 3
    v_exp_f32 v96, v96
    s_waitcnt lgkmcnt(3)
    v_mfma_f32_32x32x16_bf16 v[120:135], v[32:35], v[44:47], 0
    ds_read_b128 v[32:35], v136 offset:10240
    s_add_u32 s21, s21, 4096
    buffer_load_dwordx4 v[172:175], v14, s[64:67], s21 offen offset:0 sc1
    .p2align 3
    v_exp_f32 v97, v97
    v_exp_f32 v98, v98
    v_exp_f32 v99, v99
    s_waitcnt lgkmcnt(3)
    v_mfma_f32_32x32x16_bf16 v[16:31], v[40:43], v[116:119], v[16:31]
    s_mov_b64 exec, s[4:5]
    ds_read_b128 v[40:43], v138 offset:5760
    s_mov_b64 exec, -1
    v_exp_f32 v100, v100
    v_exp_f32 v101, v101
    v_exp_f32 v102, v102
    v_exp_f32 v103, v103
    v_cvt_pk_bf16_f32 v112, v96, v97
    v_cvt_pk_bf16_f32 v113, v98, v99
    v_exp_f32 v104, v104
    s_waitcnt lgkmcnt(3)
    v_mfma_f32_32x32x8_bf16 v[120:135], v[48:49], v[50:51], v[120:135]
    ds_read_b64 v[48:49], v137 offset:10240
    buffer_load_dwordx4 v[176:179], v14, s[64:67], s21 offen offset:1024 sc1
    .p2align 3
    v_cvt_pk_bf16_f32 v114, v100, v101
    v_cvt_pk_bf16_f32 v115, v102, v103
    v_exp_f32 v105, v105
    v_exp_f32 v106, v106
    v_exp_f32 v107, v107
    s_waitcnt lgkmcnt(3)
    v_mfma_f32_32x32x16_bf16 v[16:31], v[36:39], v[112:115], v[16:31]
    s_mov_b64 exec, s[4:5]
    ds_read_b128 v[36:39], v138 offset:7680
    s_mov_b64 exec, -1
    v_exp_f32 v108, v108
    v_exp_f32 v109, v109
    v_exp_f32 v110, v110
    v_exp_f32 v111, v111
    v_cvt_pk_bf16_f32 v116, v104, v105
    v_cvt_pk_bf16_f32 v117, v106, v107
    v_cvt_pk_bf16_f32 v118, v108, v109
    v_cvt_pk_bf16_f32 v119, v110, v111
    s_setprio 1
    .p2align 3
    v_exp_f32 v120, v120
    s_waitcnt lgkmcnt(3)
    v_mfma_f32_32x32x16_bf16 v[96:111], v[32:35], v[44:47], 0
    ds_read_b128 v[32:35], v136 offset:12800
    buffer_load_dwordx4 v[180:183], v14, s[64:67], s21 offen offset:2048 sc1
    .p2align 3
    v_exp_f32 v121, v121
    v_exp_f32 v122, v122
    v_exp_f32 v123, v123
    s_waitcnt lgkmcnt(3)
    v_mfma_f32_32x32x16_bf16 v[16:31], v[40:43], v[116:119], v[16:31]
    s_mov_b64 exec, s[4:5]
    ds_read_b128 v[40:43], v138 offset:8320
    s_mov_b64 exec, -1
    v_exp_f32 v124, v124
    v_exp_f32 v125, v125
    v_exp_f32 v126, v126
    v_exp_f32 v127, v127
    v_cvt_pk_bf16_f32 v112, v120, v121
    v_cvt_pk_bf16_f32 v113, v122, v123
    v_exp_f32 v128, v128
    s_waitcnt lgkmcnt(3)
    v_mfma_f32_32x32x8_bf16 v[96:111], v[48:49], v[50:51], v[96:111]
    ds_read_b64 v[48:49], v137 offset:12800
    buffer_load_dwordx4 v[184:187], v14, s[64:67], s21 offen offset:3072 sc1
    .p2align 3
    v_cvt_pk_bf16_f32 v114, v124, v125
    v_cvt_pk_bf16_f32 v115, v126, v127
    v_exp_f32 v129, v129
    v_exp_f32 v130, v130
    v_exp_f32 v131, v131
    s_waitcnt lgkmcnt(3)
    v_mfma_f32_32x32x16_bf16 v[16:31], v[36:39], v[112:115], v[16:31]
    s_mov_b64 exec, s[4:5]
    ds_read_b128 v[36:39], v138 offset:10240
    s_mov_b64 exec, -1
    v_exp_f32 v132, v132
    v_exp_f32 v133, v133
    v_exp_f32 v134, v134
    v_exp_f32 v135, v135
    v_cvt_pk_bf16_f32 v116, v128, v129
    v_cvt_pk_bf16_f32 v117, v130, v131
    v_cvt_pk_bf16_f32 v118, v132, v133
    v_cvt_pk_bf16_f32 v119, v134, v135
    .p2align 3
    v_exp_f32 v96, v96
    s_waitcnt lgkmcnt(3)
    v_mfma_f32_32x32x16_bf16 v[120:135], v[32:35], v[44:47], 0
    ds_read_b128 v[32:35], v136 offset:15360
    s_add_u32 s21, s21, 4096
    buffer_load_dwordx4 v[188:191], v14, s[64:67], s21 offen offset:0 sc1
    .p2align 3
    v_exp_f32 v97, v97
    v_exp_f32 v98, v98
    v_exp_f32 v99, v99
    s_waitcnt lgkmcnt(3)
    v_mfma_f32_32x32x16_bf16 v[16:31], v[40:43], v[116:119], v[16:31]
    s_mov_b64 exec, s[4:5]
    ds_read_b128 v[40:43], v138 offset:10880
    s_mov_b64 exec, -1
    v_exp_f32 v100, v100
    v_exp_f32 v101, v101
    v_exp_f32 v102, v102
    v_exp_f32 v103, v103
    v_cvt_pk_bf16_f32 v112, v96, v97
    v_cvt_pk_bf16_f32 v113, v98, v99
    v_exp_f32 v104, v104
    s_waitcnt lgkmcnt(3)
    v_mfma_f32_32x32x8_bf16 v[120:135], v[48:49], v[50:51], v[120:135]
    ds_read_b64 v[48:49], v137 offset:15360
    buffer_load_dwordx4 v[192:195], v14, s[64:67], s21 offen offset:1024 sc1
    .p2align 3
    v_cvt_pk_bf16_f32 v114, v100, v101
    v_cvt_pk_bf16_f32 v115, v102, v103
    v_exp_f32 v105, v105
    v_exp_f32 v106, v106
    v_exp_f32 v107, v107
    s_waitcnt lgkmcnt(3)
    v_mfma_f32_32x32x16_bf16 v[16:31], v[36:39], v[112:115], v[16:31]
    s_mov_b64 exec, s[4:5]
    ds_read_b128 v[36:39], v138 offset:12800
    s_mov_b64 exec, -1
    v_exp_f32 v108, v108
    v_exp_f32 v109, v109
    v_exp_f32 v110, v110
    v_exp_f32 v111, v111
    v_cvt_pk_bf16_f32 v116, v104, v105
    v_cvt_pk_bf16_f32 v117, v106, v107
    v_cvt_pk_bf16_f32 v118, v108, v109
    v_cvt_pk_bf16_f32 v119, v110, v111
    s_setprio 0
    .p2align 3
    v_exp_f32 v120, v120
    s_waitcnt lgkmcnt(3)
    v_mfma_f32_32x32x16_bf16 v[96:111], v[32:35], v[44:47], 0
    ds_read_b128 v[32:35], v136 offset:17920
    buffer_load_dwordx4 v[196:199], v14, s[64:67], s21 offen offset:2048 sc1
    .p2align 3
    v_exp_f32 v121, v121
    v_exp_f32 v122, v122
    v_exp_f32 v123, v123
    s_waitcnt lgkmcnt(3)
    v_mfma_f32_32x32x16_bf16 v[16:31], v[40:43], v[116:119], v[16:31]
    s_mov_b64 exec, s[4:5]
    ds_read_b128 v[40:43], v138 offset:13440
    s_mov_b64 exec, -1
    v_exp_f32 v124, v124
    v_exp_f32 v125, v125
    v_exp_f32 v126, v126
    v_exp_f32 v127, v127
    v_cvt_pk_bf16_f32 v112, v120, v121
    v_cvt_pk_bf16_f32 v113, v122, v123
    v_exp_f32 v128, v128
    s_waitcnt lgkmcnt(3)
    v_mfma_f32_32x32x8_bf16 v[96:111], v[48:49], v[50:51], v[96:111]
    ds_read_b64 v[48:49], v137 offset:17920
    buffer_load_dwordx4 v[200:203], v14, s[64:67], s21 offen offset:3072 sc1
    .p2align 3
    v_cvt_pk_bf16_f32 v114, v124, v125
    v_cvt_pk_bf16_f32 v115, v126, v127
    v_exp_f32 v129, v129
    v_exp_f32 v130, v130
    v_exp_f32 v131, v131
    s_waitcnt lgkmcnt(3)
    v_mfma_f32_32x32x16_bf16 v[16:31], v[36:39], v[112:115], v[16:31]
    s_mov_b64 exec, s[4:5]
    ds_read_b128 v[36:39], v138 offset:15360
    s_mov_b64 exec, -1
    v_exp_f32 v132, v132
    v_exp_f32 v133, v133
    v_exp_f32 v134, v134
    v_exp_f32 v135, v135
    v_cvt_pk_bf16_f32 v116, v128, v129
    v_cvt_pk_bf16_f32 v117, v130, v131
    v_cvt_pk_bf16_f32 v118, v132, v133
    v_cvt_pk_bf16_f32 v119, v134, v135
    s_barrier
    s_setprio 3
    .p2align 3
    v_exp_f32 v96, v96
    s_waitcnt lgkmcnt(3)
    v_mfma_f32_32x32x16_bf16 v[120:135], v[32:35], v[44:47], 0
    ds_read_b128 v[32:35], v136 offset:20480
    s_add_u32 m0, s17, 24576
    s_add_u32 s16, s16, 393216
    buffer_load_dwordx4 v143, s[48:51], s16 offen lds
    .p2align 3
    v_exp_f32 v97, v97
    v_exp_f32 v98, v98
    v_exp_f32 v99, v99
    s_waitcnt lgkmcnt(3)
    v_mfma_f32_32x32x16_bf16 v[16:31], v[40:43], v[116:119], v[16:31]
    s_mov_b64 exec, s[4:5]
    ds_read_b128 v[40:43], v138 offset:16000
    s_mov_b64 exec, -1
    v_exp_f32 v100, v100
    v_exp_f32 v101, v101
    v_exp_f32 v102, v102
    v_exp_f32 v103, v103
    v_cvt_pk_bf16_f32 v112, v96, v97
    v_cvt_pk_bf16_f32 v113, v98, v99
    v_exp_f32 v104, v104
    s_waitcnt lgkmcnt(3)
    v_mfma_f32_32x32x8_bf16 v[120:135], v[48:49], v[50:51], v[120:135]
    ds_read_b64 v[48:49], v137 offset:20480
    v_cvt_pk_bf16_f32 v114, v100, v101
    v_cvt_pk_bf16_f32 v115, v102, v103
    v_exp_f32 v105, v105
    v_exp_f32 v106, v106
    v_exp_f32 v107, v107
    s_waitcnt lgkmcnt(3)
    v_mfma_f32_32x32x16_bf16 v[16:31], v[36:39], v[112:115], v[16:31]
    s_mov_b64 exec, s[4:5]
    ds_read_b128 v[36:39], v138 offset:17920
    s_mov_b64 exec, -1
    v_exp_f32 v108, v108
    v_exp_f32 v109, v109
    v_exp_f32 v110, v110
    v_exp_f32 v111, v111
    v_cvt_pk_bf16_f32 v116, v104, v105
    v_cvt_pk_bf16_f32 v117, v106, v107
    v_cvt_pk_bf16_f32 v118, v108, v109
    v_cvt_pk_bf16_f32 v119, v110, v111
    .p2align 3
    v_exp_f32 v120, v120
    s_waitcnt lgkmcnt(3)
    v_mfma_f32_32x32x16_bf16 v[96:111], v[32:35], v[44:47], 0
    ds_read_b128 v[32:35], v136 offset:23040
    s_add_u32 m0, s17, 25600
    s_nop 0
    buffer_load_dwordx4 v144, s[48:51], s16 offen lds
    .p2align 3
    v_exp_f32 v121, v121
    v_exp_f32 v122, v122
    v_exp_f32 v123, v123
    s_waitcnt lgkmcnt(3)
    v_mfma_f32_32x32x16_bf16 v[16:31], v[40:43], v[116:119], v[16:31]
    s_mov_b64 exec, s[4:5]
    ds_read_b128 v[40:43], v138 offset:18560
    s_mov_b64 exec, -1
    v_exp_f32 v124, v124
    v_exp_f32 v125, v125
    v_exp_f32 v126, v126
    v_exp_f32 v127, v127
    v_cvt_pk_bf16_f32 v112, v120, v121
    v_cvt_pk_bf16_f32 v113, v122, v123
    v_exp_f32 v128, v128
    s_waitcnt lgkmcnt(3)
    v_mfma_f32_32x32x8_bf16 v[96:111], v[48:49], v[50:51], v[96:111]
    ds_read_b64 v[48:49], v137 offset:23040
    v_cvt_pk_bf16_f32 v114, v124, v125
    v_cvt_pk_bf16_f32 v115, v126, v127
    v_exp_f32 v129, v129
    v_exp_f32 v130, v130
    v_exp_f32 v131, v131
    s_waitcnt lgkmcnt(3)
    v_mfma_f32_32x32x16_bf16 v[16:31], v[36:39], v[112:115], v[16:31]
    s_mov_b64 exec, s[4:5]
    ds_read_b128 v[36:39], v138 offset:20480
    s_mov_b64 exec, -1
    v_exp_f32 v132, v132
    v_exp_f32 v133, v133
    v_exp_f32 v134, v134
    v_exp_f32 v135, v135
    v_cvt_pk_bf16_f32 v116, v128, v129
    v_cvt_pk_bf16_f32 v117, v130, v131
    v_cvt_pk_bf16_f32 v118, v132, v133
    v_cvt_pk_bf16_f32 v119, v134, v135
    .p2align 3
    v_exp_f32 v96, v96
    s_waitcnt lgkmcnt(3)
    v_mfma_f32_32x32x16_bf16 v[120:135], v[32:35], v[44:47], 0
    ds_read_b128 v[32:35], v136 offset:25600
    v_exp_f32 v97, v97
    v_exp_f32 v98, v98
    v_exp_f32 v99, v99
    s_waitcnt lgkmcnt(3)
    v_mfma_f32_32x32x16_bf16 v[16:31], v[40:43], v[116:119], v[16:31]
    s_mov_b64 exec, s[4:5]
    ds_read_b128 v[40:43], v138 offset:21120
    s_mov_b64 exec, -1
    v_exp_f32 v100, v100
    v_exp_f32 v101, v101
    v_exp_f32 v102, v102
    v_exp_f32 v103, v103
    v_cvt_pk_bf16_f32 v112, v96, v97
    v_cvt_pk_bf16_f32 v113, v98, v99
    v_exp_f32 v104, v104
    s_waitcnt lgkmcnt(3)
    v_mfma_f32_32x32x8_bf16 v[120:135], v[48:49], v[50:51], v[120:135]
    ds_read_b64 v[48:49], v137 offset:25600
    v_cvt_pk_bf16_f32 v114, v100, v101
    v_cvt_pk_bf16_f32 v115, v102, v103
    v_exp_f32 v105, v105
    v_exp_f32 v106, v106
    v_exp_f32 v107, v107
    s_waitcnt lgkmcnt(3)
    v_mfma_f32_32x32x16_bf16 v[16:31], v[36:39], v[112:115], v[16:31]
    s_mov_b64 exec, s[4:5]
    ds_read_b128 v[36:39], v138 offset:23040
    s_mov_b64 exec, -1
    v_exp_f32 v108, v108
    v_exp_f32 v109, v109
    v_exp_f32 v110, v110
    v_exp_f32 v111, v111
    v_cvt_pk_bf16_f32 v116, v104, v105
    v_cvt_pk_bf16_f32 v117, v106, v107
    v_cvt_pk_bf16_f32 v118, v108, v109
    v_cvt_pk_bf16_f32 v119, v110, v111
    .p2align 3
    v_exp_f32 v120, v120
    s_waitcnt lgkmcnt(3)
    v_mfma_f32_32x32x16_bf16 v[96:111], v[32:35], v[44:47], 0
    ds_read_b128 v[32:35], v136 offset:28160
    s_add_u32 m0, s17, 26624
    s_nop 0
    buffer_load_dwordx4 v145, s[48:51], s16 offen lds
    .p2align 3
    v_exp_f32 v121, v121
    v_exp_f32 v122, v122
    v_exp_f32 v123, v123
    s_waitcnt lgkmcnt(3)
    v_mfma_f32_32x32x16_bf16 v[16:31], v[40:43], v[116:119], v[16:31]
    s_mov_b64 exec, s[4:5]
    ds_read_b128 v[40:43], v138 offset:23680
    s_mov_b64 exec, -1
    v_exp_f32 v124, v124
    v_exp_f32 v125, v125
    v_exp_f32 v126, v126
    v_exp_f32 v127, v127
    v_cvt_pk_bf16_f32 v112, v120, v121
    v_cvt_pk_bf16_f32 v113, v122, v123
    v_exp_f32 v128, v128
    s_waitcnt lgkmcnt(3)
    v_mfma_f32_32x32x8_bf16 v[96:111], v[48:49], v[50:51], v[96:111]
    ds_read_b64 v[48:49], v137 offset:28160
    v_cvt_pk_bf16_f32 v114, v124, v125
    v_cvt_pk_bf16_f32 v115, v126, v127
    v_exp_f32 v129, v129
    v_exp_f32 v130, v130
    v_exp_f32 v131, v131
    s_waitcnt lgkmcnt(3)
    v_mfma_f32_32x32x16_bf16 v[16:31], v[36:39], v[112:115], v[16:31]
    s_mov_b64 exec, s[4:5]
    ds_read_b128 v[36:39], v138 offset:25600
    s_mov_b64 exec, -1
    v_exp_f32 v132, v132
    v_exp_f32 v133, v133
    v_exp_f32 v134, v134
    v_exp_f32 v135, v135
    v_cvt_pk_bf16_f32 v116, v128, v129
    v_cvt_pk_bf16_f32 v117, v130, v131
    v_cvt_pk_bf16_f32 v118, v132, v133
    v_cvt_pk_bf16_f32 v119, v134, v135
    .p2align 3
    v_exp_f32 v96, v96
    s_waitcnt lgkmcnt(3)
    v_mfma_f32_32x32x16_bf16 v[120:135], v[32:35], v[44:47], 0
    ds_read_b128 v[32:35], v136 offset:30720
    v_exp_f32 v97, v97
    v_exp_f32 v98, v98
    v_exp_f32 v99, v99
    s_waitcnt lgkmcnt(3)
    v_mfma_f32_32x32x16_bf16 v[16:31], v[40:43], v[116:119], v[16:31]
    s_mov_b64 exec, s[4:5]
    ds_read_b128 v[40:43], v138 offset:26240
    s_mov_b64 exec, -1
    v_exp_f32 v100, v100
    v_exp_f32 v101, v101
    v_exp_f32 v102, v102
    v_exp_f32 v103, v103
    v_cvt_pk_bf16_f32 v112, v96, v97
    v_cvt_pk_bf16_f32 v113, v98, v99
    v_exp_f32 v104, v104
    s_waitcnt lgkmcnt(3)
    v_mfma_f32_32x32x8_bf16 v[120:135], v[48:49], v[50:51], v[120:135]
    ds_read_b64 v[48:49], v137 offset:30720
    v_cvt_pk_bf16_f32 v114, v100, v101
    v_cvt_pk_bf16_f32 v115, v102, v103
    v_exp_f32 v105, v105
    v_exp_f32 v106, v106
    v_exp_f32 v107, v107
    s_waitcnt lgkmcnt(3)
    v_mfma_f32_32x32x16_bf16 v[16:31], v[36:39], v[112:115], v[16:31]
    s_mov_b64 exec, s[4:5]
    ds_read_b128 v[36:39], v138 offset:28160
    s_mov_b64 exec, -1
    v_exp_f32 v108, v108
    v_exp_f32 v109, v109
    v_exp_f32 v110, v110
    v_exp_f32 v111, v111
    v_cvt_pk_bf16_f32 v116, v104, v105
    v_cvt_pk_bf16_f32 v117, v106, v107
    v_cvt_pk_bf16_f32 v118, v108, v109
    v_cvt_pk_bf16_f32 v119, v110, v111
    .p2align 3
    v_exp_f32 v120, v120
    s_waitcnt lgkmcnt(3)
    v_mfma_f32_32x32x16_bf16 v[96:111], v[32:35], v[44:47], 0
    ds_read_b128 v[32:35], v136 offset:33280
    s_add_u32 m0, s17, 49152
    s_add_u32 s16, s16, 393216
    buffer_load_dwordx4 v143, s[48:51], s16 offen lds
    .p2align 3
    v_exp_f32 v121, v121
    v_exp_f32 v122, v122
    v_exp_f32 v123, v123
    s_waitcnt lgkmcnt(3)
    v_mfma_f32_32x32x16_bf16 v[16:31], v[40:43], v[116:119], v[16:31]
    s_mov_b64 exec, s[4:5]
    ds_read_b128 v[40:43], v138 offset:28800
    s_mov_b64 exec, -1
    v_exp_f32 v124, v124
    v_exp_f32 v125, v125
    v_exp_f32 v126, v126
    v_exp_f32 v127, v127
    v_cvt_pk_bf16_f32 v112, v120, v121
    v_cvt_pk_bf16_f32 v113, v122, v123
    v_exp_f32 v128, v128
    s_waitcnt lgkmcnt(3)
    v_mfma_f32_32x32x8_bf16 v[96:111], v[48:49], v[50:51], v[96:111]
    ds_read_b64 v[48:49], v137 offset:33280
    v_cvt_pk_bf16_f32 v114, v124, v125
    v_cvt_pk_bf16_f32 v115, v126, v127
    v_exp_f32 v129, v129
    v_exp_f32 v130, v130
    v_exp_f32 v131, v131
    s_waitcnt lgkmcnt(3)
    v_mfma_f32_32x32x16_bf16 v[16:31], v[36:39], v[112:115], v[16:31]
    s_mov_b64 exec, s[4:5]
    ds_read_b128 v[36:39], v138 offset:30720
    s_mov_b64 exec, -1
    v_exp_f32 v132, v132
    v_exp_f32 v133, v133
    v_exp_f32 v134, v134
    v_exp_f32 v135, v135
    v_cvt_pk_bf16_f32 v116, v128, v129
    v_cvt_pk_bf16_f32 v117, v130, v131
    v_cvt_pk_bf16_f32 v118, v132, v133
    v_cvt_pk_bf16_f32 v119, v134, v135
    .p2align 3
    v_exp_f32 v96, v96
    s_waitcnt lgkmcnt(3)
    v_mfma_f32_32x32x16_bf16 v[120:135], v[32:35], v[44:47], 0
    ds_read_b128 v[32:35], v136 offset:35840
    s_add_u32 m0, s17, 50176
    s_nop 0
    buffer_load_dwordx4 v144, s[48:51], s16 offen lds
    .p2align 3
    v_exp_f32 v97, v97
    v_exp_f32 v98, v98
    v_exp_f32 v99, v99
    s_waitcnt lgkmcnt(3)
    v_mfma_f32_32x32x16_bf16 v[16:31], v[40:43], v[116:119], v[16:31]
    s_mov_b64 exec, s[4:5]
    ds_read_b128 v[40:43], v138 offset:31360
    s_mov_b64 exec, -1
    v_exp_f32 v100, v100
    v_exp_f32 v101, v101
    v_exp_f32 v102, v102
    v_exp_f32 v103, v103
    v_cvt_pk_bf16_f32 v112, v96, v97
    v_cvt_pk_bf16_f32 v113, v98, v99
    v_exp_f32 v104, v104
    s_waitcnt lgkmcnt(3)
    v_mfma_f32_32x32x8_bf16 v[120:135], v[48:49], v[50:51], v[120:135]
    ds_read_b64 v[48:49], v137 offset:35840
    v_cvt_pk_bf16_f32 v114, v100, v101
    v_cvt_pk_bf16_f32 v115, v102, v103
    v_exp_f32 v105, v105
    v_exp_f32 v106, v106
    v_exp_f32 v107, v107
    s_waitcnt lgkmcnt(3)
    v_mfma_f32_32x32x16_bf16 v[16:31], v[36:39], v[112:115], v[16:31]
    s_mov_b64 exec, s[4:5]
    ds_read_b128 v[36:39], v138 offset:33280
    s_mov_b64 exec, -1
    v_exp_f32 v108, v108
    v_exp_f32 v109, v109
    v_exp_f32 v110, v110
    v_exp_f32 v111, v111
    v_cvt_pk_bf16_f32 v116, v104, v105
    v_cvt_pk_bf16_f32 v117, v106, v107
    v_cvt_pk_bf16_f32 v118, v108, v109
    v_cvt_pk_bf16_f32 v119, v110, v111
    .p2align 3
    v_exp_f32 v120, v120
    s_waitcnt lgkmcnt(3)
    v_mfma_f32_32x32x16_bf16 v[96:111], v[32:35], v[44:47], 0
    ds_read_b128 v[32:35], v136 offset:38400
    v_exp_f32 v121, v121
    v_exp_f32 v122, v122
    v_exp_f32 v123, v123
    s_waitcnt lgkmcnt(3)
    v_mfma_f32_32x32x16_bf16 v[16:31], v[40:43], v[116:119], v[16:31]
    s_mov_b64 exec, s[4:5]
    ds_read_b128 v[40:43], v138 offset:33920
    s_mov_b64 exec, -1
    v_exp_f32 v124, v124
    v_exp_f32 v125, v125
    v_exp_f32 v126, v126
    v_exp_f32 v127, v127
    v_cvt_pk_bf16_f32 v112, v120, v121
    v_cvt_pk_bf16_f32 v113, v122, v123
    v_exp_f32 v128, v128
    s_waitcnt lgkmcnt(3)
    v_mfma_f32_32x32x8_bf16 v[96:111], v[48:49], v[50:51], v[96:111]
    ds_read_b64 v[48:49], v137 offset:38400
    v_cvt_pk_bf16_f32 v114, v124, v125
    v_cvt_pk_bf16_f32 v115, v126, v127
    v_exp_f32 v129, v129
    v_exp_f32 v130, v130
    v_exp_f32 v131, v131
    s_waitcnt lgkmcnt(3)
    v_mfma_f32_32x32x16_bf16 v[16:31], v[36:39], v[112:115], v[16:31]
    s_mov_b64 exec, s[4:5]
    ds_read_b128 v[36:39], v138 offset:35840
    s_mov_b64 exec, -1
    v_exp_f32 v132, v132
    v_exp_f32 v133, v133
    v_exp_f32 v134, v134
    v_exp_f32 v135, v135
    v_cvt_pk_bf16_f32 v116, v128, v129
    v_cvt_pk_bf16_f32 v117, v130, v131
    v_cvt_pk_bf16_f32 v118, v132, v133
    v_cvt_pk_bf16_f32 v119, v134, v135
    .p2align 3
    v_exp_f32 v96, v96
    s_waitcnt lgkmcnt(3)
    v_mfma_f32_32x32x16_bf16 v[120:135], v[32:35], v[44:47], 0
    ds_read_b128 v[32:35], v136 offset:40960
    s_add_u32 m0, s17, 51200
    s_nop 0
    buffer_load_dwordx4 v145, s[48:51], s16 offen lds
    .p2align 3
    v_exp_f32 v97, v97
    v_exp_f32 v98, v98
    v_exp_f32 v99, v99
    s_waitcnt lgkmcnt(3)
    v_mfma_f32_32x32x16_bf16 v[16:31], v[40:43], v[116:119], v[16:31]
    s_mov_b64 exec, s[4:5]
    ds_read_b128 v[40:43], v138 offset:36480
    s_mov_b64 exec, -1
    v_exp_f32 v100, v100
    v_exp_f32 v101, v101
    v_exp_f32 v102, v102
    v_exp_f32 v103, v103
    v_cvt_pk_bf16_f32 v112, v96, v97
    v_cvt_pk_bf16_f32 v113, v98, v99
    v_exp_f32 v104, v104
    s_waitcnt lgkmcnt(3)
    v_mfma_f32_32x32x8_bf16 v[120:135], v[48:49], v[50:51], v[120:135]
    ds_read_b64 v[48:49], v137 offset:40960
    v_cvt_pk_bf16_f32 v114, v100, v101
    v_cvt_pk_bf16_f32 v115, v102, v103
    v_exp_f32 v105, v105
    v_exp_f32 v106, v106
    v_exp_f32 v107, v107
    s_waitcnt lgkmcnt(3)
    v_mfma_f32_32x32x16_bf16 v[16:31], v[36:39], v[112:115], v[16:31]
    s_mov_b64 exec, s[4:5]
    ds_read_b128 v[36:39], v138 offset:38400
    s_mov_b64 exec, -1
    v_exp_f32 v108, v108
    v_exp_f32 v109, v109
    v_exp_f32 v110, v110
    v_exp_f32 v111, v111
    v_cvt_pk_bf16_f32 v116, v104, v105
    v_cvt_pk_bf16_f32 v117, v106, v107
    v_cvt_pk_bf16_f32 v118, v108, v109
    v_cvt_pk_bf16_f32 v119, v110, v111
    .p2align 3
    v_exp_f32 v120, v120
    s_waitcnt lgkmcnt(3)
    v_mfma_f32_32x32x16_bf16 v[96:111], v[32:35], v[44:47], 0
    ds_read_b128 v[32:35], v136 offset:43520
    v_exp_f32 v121, v121
    v_exp_f32 v122, v122
    v_exp_f32 v123, v123
    s_waitcnt lgkmcnt(3)
    v_mfma_f32_32x32x16_bf16 v[16:31], v[40:43], v[116:119], v[16:31]
    s_mov_b64 exec, s[4:5]
    ds_read_b128 v[40:43], v138 offset:39040
    s_mov_b64 exec, -1
    v_exp_f32 v124, v124
    v_exp_f32 v125, v125
    v_exp_f32 v126, v126
    v_exp_f32 v127, v127
    v_cvt_pk_bf16_f32 v112, v120, v121
    v_cvt_pk_bf16_f32 v113, v122, v123
    v_exp_f32 v128, v128
    s_waitcnt lgkmcnt(3)
    v_mfma_f32_32x32x8_bf16 v[96:111], v[48:49], v[50:51], v[96:111]
    ds_read_b64 v[48:49], v137 offset:43520
    v_cvt_pk_bf16_f32 v114, v124, v125
    v_cvt_pk_bf16_f32 v115, v126, v127
    v_exp_f32 v129, v129
    v_exp_f32 v130, v130
    v_exp_f32 v131, v131
    s_waitcnt lgkmcnt(3)
    v_mfma_f32_32x32x16_bf16 v[16:31], v[36:39], v[112:115], v[16:31]
    s_mov_b64 exec, s[4:5]
    ds_read_b128 v[36:39], v138 offset:40960
    s_mov_b64 exec, -1
    v_exp_f32 v132, v132
    v_exp_f32 v133, v133
    v_exp_f32 v134, v134
    v_exp_f32 v135, v135
    v_cvt_pk_bf16_f32 v116, v128, v129
    v_cvt_pk_bf16_f32 v117, v130, v131
    v_cvt_pk_bf16_f32 v118, v132, v133
    v_cvt_pk_bf16_f32 v119, v134, v135
    .p2align 3
    v_exp_f32 v96, v96
    s_waitcnt lgkmcnt(3)
    v_mfma_f32_32x32x16_bf16 v[120:135], v[32:35], v[44:47], 0
    ds_read_b128 v[32:35], v136 offset:46080
    v_exp_f32 v97, v97
    v_exp_f32 v98, v98
    v_exp_f32 v99, v99
    s_waitcnt lgkmcnt(3)
    v_mfma_f32_32x32x16_bf16 v[16:31], v[40:43], v[116:119], v[16:31]
    s_mov_b64 exec, s[4:5]
    ds_read_b128 v[40:43], v138 offset:41600
    s_mov_b64 exec, -1
    v_exp_f32 v100, v100
    v_exp_f32 v101, v101
    v_exp_f32 v102, v102
    v_exp_f32 v103, v103
    v_cvt_pk_bf16_f32 v112, v96, v97
    v_cvt_pk_bf16_f32 v113, v98, v99
    v_exp_f32 v104, v104
    s_waitcnt lgkmcnt(3)
    v_mfma_f32_32x32x8_bf16 v[120:135], v[48:49], v[50:51], v[120:135]
    ds_read_b64 v[48:49], v137 offset:46080
    v_cvt_pk_bf16_f32 v114, v100, v101
    v_cvt_pk_bf16_f32 v115, v102, v103
    v_exp_f32 v105, v105
    v_exp_f32 v106, v106
    v_exp_f32 v107, v107
    s_waitcnt lgkmcnt(3)
    v_mfma_f32_32x32x16_bf16 v[16:31], v[36:39], v[112:115], v[16:31]
    s_mov_b64 exec, s[4:5]
    ds_read_b128 v[36:39], v138 offset:43520
    s_mov_b64 exec, -1
    v_exp_f32 v108, v108
    v_exp_f32 v109, v109
    v_exp_f32 v110, v110
    v_exp_f32 v111, v111
    v_cvt_pk_bf16_f32 v116, v104, v105
    v_cvt_pk_bf16_f32 v117, v106, v107
    v_cvt_pk_bf16_f32 v118, v108, v109
    v_cvt_pk_bf16_f32 v119, v110, v111
    .p2align 3
    v_exp_f32 v120, v120
    s_waitcnt lgkmcnt(3)
    v_mfma_f32_32x32x16_bf16 v[96:111], v[32:35], v[44:47], 0
    ds_read_b128 v[32:35], v136 offset:48640
    s_add_u32 s21, s21, 4096
    buffer_load_dwordx4 v[204:207], v14, s[64:67], s21 offen offset:0 sc1
    .p2align 3
    v_exp_f32 v121, v121
    v_exp_f32 v122, v122
    v_exp_f32 v123, v123
    s_waitcnt lgkmcnt(3)
    v_mfma_f32_32x32x16_bf16 v[16:31], v[40:43], v[116:119], v[16:31]
    s_mov_b64 exec, s[4:5]
    ds_read_b128 v[40:43], v138 offset:44160
    s_mov_b64 exec, -1
    v_exp_f32 v124, v124
    v_exp_f32 v125, v125
    v_exp_f32 v126, v126
    v_exp_f32 v127, v127
    v_cvt_pk_bf16_f32 v112, v120, v121
    v_cvt_pk_bf16_f32 v113, v122, v123
    v_exp_f32 v128, v128
    s_waitcnt lgkmcnt(3)
    v_mfma_f32_32x32x8_bf16 v[96:111], v[48:49], v[50:51], v[96:111]
    ds_read_b64 v[48:49], v137 offset:48640
    buffer_load_dwordx4 v[208:211], v14, s[64:67], s21 offen offset:1024 sc1
    .p2align 3
    v_cvt_pk_bf16_f32 v114, v124, v125
    v_cvt_pk_bf16_f32 v115, v126, v127
    v_exp_f32 v129, v129
    v_exp_f32 v130, v130
    v_exp_f32 v131, v131
    s_waitcnt lgkmcnt(3)
    v_mfma_f32_32x32x16_bf16 v[16:31], v[36:39], v[112:115], v[16:31]
    s_mov_b64 exec, s[4:5]
    ds_read_b128 v[36:39], v138 offset:46080
    s_mov_b64 exec, -1
    v_exp_f32 v132, v132
    v_exp_f32 v133, v133
    v_exp_f32 v134, v134
    v_exp_f32 v135, v135
    v_cvt_pk_bf16_f32 v116, v128, v129
    v_cvt_pk_bf16_f32 v117, v130, v131
    v_cvt_pk_bf16_f32 v118, v132, v133
    v_cvt_pk_bf16_f32 v119, v134, v135
    s_setprio 2
    .p2align 3
    v_exp_f32 v96, v96
    s_waitcnt lgkmcnt(3)
    v_mfma_f32_32x32x16_bf16 v[120:135], v[32:35], v[44:47], 0
    ds_read_b128 v[32:35], v136 offset:51200
    buffer_load_dwordx4 v[212:215], v14, s[64:67], s21 offen offset:2048 sc1
    .p2align 3
    v_exp_f32 v97, v97
    v_exp_f32 v98, v98
    v_exp_f32 v99, v99
    s_waitcnt lgkmcnt(3)
    v_mfma_f32_32x32x16_bf16 v[16:31], v[40:43], v[116:119], v[16:31]
    s_mov_b64 exec, s[4:5]
    ds_read_b128 v[40:43], v138 offset:46720
    s_mov_b64 exec, -1
    v_exp_f32 v100, v100
    v_exp_f32 v101, v101
    v_exp_f32 v102, v102
    v_exp_f32 v103, v103
    v_cvt_pk_bf16_f32 v112, v96, v97
    v_cvt_pk_bf16_f32 v113, v98, v99
    v_exp_f32 v104, v104
    s_waitcnt lgkmcnt(3)
    v_mfma_f32_32x32x8_bf16 v[120:135], v[48:49], v[50:51], v[120:135]
    ds_read_b64 v[48:49], v137 offset:51200
    buffer_load_dwordx4 v[216:219], v14, s[64:67], s21 offen offset:3072 sc1
    .p2align 3
    v_cvt_pk_bf16_f32 v114, v100, v101
    v_cvt_pk_bf16_f32 v115, v102, v103
    v_exp_f32 v105, v105
    v_exp_f32 v106, v106
    v_exp_f32 v107, v107
    s_waitcnt lgkmcnt(3)
    v_mfma_f32_32x32x16_bf16 v[16:31], v[36:39], v[112:115], v[16:31]
    s_mov_b64 exec, s[4:5]
    ds_read_b128 v[36:39], v138 offset:48640
    s_mov_b64 exec, -1
    v_exp_f32 v108, v108
    v_exp_f32 v109, v109
    v_exp_f32 v110, v110
    v_exp_f32 v111, v111
    v_cvt_pk_bf16_f32 v116, v104, v105
    v_cvt_pk_bf16_f32 v117, v106, v107
    v_cvt_pk_bf16_f32 v118, v108, v109
    v_cvt_pk_bf16_f32 v119, v110, v111
    .p2align 3
    v_exp_f32 v120, v120
    s_waitcnt lgkmcnt(3)
    v_mfma_f32_32x32x16_bf16 v[96:111], v[32:35], v[44:47], 0
    ds_read_b128 v[32:35], v136 offset:53760
    s_add_u32 s21, s21, 4096
    buffer_load_dwordx4 v[220:223], v14, s[64:67], s21 offen offset:0 sc1
    .p2align 3
    v_exp_f32 v121, v121
    v_exp_f32 v122, v122
    v_exp_f32 v123, v123
    s_waitcnt lgkmcnt(3)
    v_mfma_f32_32x32x16_bf16 v[16:31], v[40:43], v[116:119], v[16:31]
    s_mov_b64 exec, s[4:5]
    ds_read_b128 v[40:43], v138 offset:49280
    s_mov_b64 exec, -1
    v_exp_f32 v124, v124
    v_exp_f32 v125, v125
    v_exp_f32 v126, v126
    v_exp_f32 v127, v127
    v_cvt_pk_bf16_f32 v112, v120, v121
    v_cvt_pk_bf16_f32 v113, v122, v123
    v_exp_f32 v128, v128
    s_waitcnt lgkmcnt(3)
    v_mfma_f32_32x32x8_bf16 v[96:111], v[48:49], v[50:51], v[96:111]
    ds_read_b64 v[48:49], v137 offset:53760
    buffer_load_dwordx4 v[224:227], v14, s[64:67], s21 offen offset:1024 sc1
    .p2align 3
    v_cvt_pk_bf16_f32 v114, v124, v125
    v_cvt_pk_bf16_f32 v115, v126, v127
    v_exp_f32 v129, v129
    v_exp_f32 v130, v130
    v_exp_f32 v131, v131
    s_waitcnt lgkmcnt(3)
    v_mfma_f32_32x32x16_bf16 v[16:31], v[36:39], v[112:115], v[16:31]
    s_mov_b64 exec, s[4:5]
    ds_read_b128 v[36:39], v138 offset:51200
    s_mov_b64 exec, -1
    v_exp_f32 v132, v132
    v_exp_f32 v133, v133
    v_exp_f32 v134, v134
    v_exp_f32 v135, v135
    v_cvt_pk_bf16_f32 v116, v128, v129
    v_cvt_pk_bf16_f32 v117, v130, v131
    v_cvt_pk_bf16_f32 v118, v132, v133
    v_cvt_pk_bf16_f32 v119, v134, v135
    .p2align 3
    v_exp_f32 v96, v96
    s_waitcnt lgkmcnt(3)
    v_mfma_f32_32x32x16_bf16 v[120:135], v[32:35], v[44:47], 0
    ds_read_b128 v[32:35], v136 offset:56320
    buffer_load_dwordx4 v[228:231], v14, s[64:67], s21 offen offset:2048 sc1
    .p2align 3
    v_exp_f32 v97, v97
    v_exp_f32 v98, v98
    v_exp_f32 v99, v99
    s_waitcnt lgkmcnt(3)
    v_mfma_f32_32x32x16_bf16 v[16:31], v[40:43], v[116:119], v[16:31]
    s_mov_b64 exec, s[4:5]
    ds_read_b128 v[40:43], v138 offset:51840
    s_mov_b64 exec, -1
    v_exp_f32 v100, v100
    v_exp_f32 v101, v101
    v_exp_f32 v102, v102
    v_exp_f32 v103, v103
    v_cvt_pk_bf16_f32 v112, v96, v97
    v_cvt_pk_bf16_f32 v113, v98, v99
    v_exp_f32 v104, v104
    s_waitcnt lgkmcnt(3)
    v_mfma_f32_32x32x8_bf16 v[120:135], v[48:49], v[50:51], v[120:135]
    ds_read_b64 v[48:49], v137 offset:56320
    buffer_load_dwordx4 v[232:235], v14, s[64:67], s21 offen offset:3072 sc1
    .p2align 3
    v_cvt_pk_bf16_f32 v114, v100, v101
    v_cvt_pk_bf16_f32 v115, v102, v103
    v_exp_f32 v105, v105
    v_exp_f32 v106, v106
    v_exp_f32 v107, v107
    s_waitcnt lgkmcnt(3)
    v_mfma_f32_32x32x16_bf16 v[16:31], v[36:39], v[112:115], v[16:31]
    s_mov_b64 exec, s[4:5]
    ds_read_b128 v[36:39], v138 offset:53760
    s_mov_b64 exec, -1
    v_exp_f32 v108, v108
    v_exp_f32 v109, v109
    v_exp_f32 v110, v110
    v_exp_f32 v111, v111
    v_cvt_pk_bf16_f32 v116, v104, v105
    v_cvt_pk_bf16_f32 v117, v106, v107
    v_cvt_pk_bf16_f32 v118, v108, v109
    v_cvt_pk_bf16_f32 v119, v110, v111
    .p2align 3
    v_exp_f32 v120, v120
    s_waitcnt lgkmcnt(3)
    v_mfma_f32_32x32x16_bf16 v[96:111], v[32:35], v[44:47], 0
    ds_read_b128 v[32:35], v136 offset:58880
    s_add_u32 s21, s21, 4096
    buffer_load_dwordx4 v[236:239], v14, s[64:67], s21 offen offset:0 sc1
    .p2align 3
    v_exp_f32 v121, v121
    v_exp_f32 v122, v122
    v_exp_f32 v123, v123
    s_waitcnt lgkmcnt(3)
    v_mfma_f32_32x32x16_bf16 v[16:31], v[40:43], v[116:119], v[16:31]
    s_mov_b64 exec, s[4:5]
    ds_read_b128 v[40:43], v138 offset:54400
    s_mov_b64 exec, -1
    v_exp_f32 v124, v124
    v_exp_f32 v125, v125
    v_exp_f32 v126, v126
    v_exp_f32 v127, v127
    v_cvt_pk_bf16_f32 v112, v120, v121
    v_cvt_pk_bf16_f32 v113, v122, v123
    v_exp_f32 v128, v128
    s_waitcnt lgkmcnt(3)
    v_mfma_f32_32x32x8_bf16 v[96:111], v[48:49], v[50:51], v[96:111]
    ds_read_b64 v[48:49], v137 offset:58880
    buffer_load_dwordx4 v[240:243], v14, s[64:67], s21 offen offset:1024 sc1
    .p2align 3
    v_cvt_pk_bf16_f32 v114, v124, v125
    v_cvt_pk_bf16_f32 v115, v126, v127
    v_exp_f32 v129, v129
    v_exp_f32 v130, v130
    v_exp_f32 v131, v131
    s_waitcnt lgkmcnt(3)
    v_mfma_f32_32x32x16_bf16 v[16:31], v[36:39], v[112:115], v[16:31]
    s_mov_b64 exec, s[4:5]
    ds_read_b128 v[36:39], v138 offset:56320
    s_mov_b64 exec, -1
    v_exp_f32 v132, v132
    v_exp_f32 v133, v133
    v_exp_f32 v134, v134
    v_exp_f32 v135, v135
    v_cvt_pk_bf16_f32 v116, v128, v129
    v_cvt_pk_bf16_f32 v117, v130, v131
    v_cvt_pk_bf16_f32 v118, v132, v133
    v_cvt_pk_bf16_f32 v119, v134, v135
    s_setprio 1
    .p2align 3
    v_exp_f32 v96, v96
    s_waitcnt lgkmcnt(3)
    v_mfma_f32_32x32x16_bf16 v[120:135], v[32:35], v[44:47], 0
    ds_read_b128 v[32:35], v136 offset:61440
    buffer_load_dwordx4 v[244:247], v14, s[64:67], s21 offen offset:2048 sc1
    .p2align 3
    v_exp_f32 v97, v97
    v_exp_f32 v98, v98
    v_exp_f32 v99, v99
    s_waitcnt lgkmcnt(3)
    v_mfma_f32_32x32x16_bf16 v[16:31], v[40:43], v[116:119], v[16:31]
    s_mov_b64 exec, s[4:5]
    ds_read_b128 v[40:43], v138 offset:56960
    s_mov_b64 exec, -1
    v_exp_f32 v100, v100
    v_exp_f32 v101, v101
    v_exp_f32 v102, v102
    v_exp_f32 v103, v103
    v_cvt_pk_bf16_f32 v112, v96, v97
    v_cvt_pk_bf16_f32 v113, v98, v99
    v_exp_f32 v104, v104
    s_waitcnt lgkmcnt(3)
    v_mfma_f32_32x32x8_bf16 v[120:135], v[48:49], v[50:51], v[120:135]
    ds_read_b64 v[48:49], v137 offset:61440
    buffer_load_dwordx4 v[248:251], v14, s[64:67], s21 offen offset:3072 sc1
    .p2align 3
    v_cvt_pk_bf16_f32 v114, v100, v101
    v_cvt_pk_bf16_f32 v115, v102, v103
    v_exp_f32 v105, v105
    v_exp_f32 v106, v106
    v_exp_f32 v107, v107
    s_waitcnt lgkmcnt(3)
    v_mfma_f32_32x32x16_bf16 v[16:31], v[36:39], v[112:115], v[16:31]
    s_mov_b64 exec, s[4:5]
    ds_read_b128 v[36:39], v138 offset:58880
    s_mov_b64 exec, -1
    v_exp_f32 v108, v108
    v_exp_f32 v109, v109
    v_exp_f32 v110, v110
    v_exp_f32 v111, v111
    v_cvt_pk_bf16_f32 v116, v104, v105
    v_cvt_pk_bf16_f32 v117, v106, v107
    v_cvt_pk_bf16_f32 v118, v108, v109
    v_cvt_pk_bf16_f32 v119, v110, v111
    .p2align 3
    v_exp_f32 v120, v120
    s_waitcnt lgkmcnt(3)
    v_mfma_f32_32x32x16_bf16 v[96:111], v[32:35], v[44:47], 0
    ds_read_b128 v[32:35], v136 offset:64000
    s_add_u32 s21, s21, 4096
    buffer_load_dwordx4 v[252:255], v14, s[64:67], s21 offen offset:0 sc1
    .p2align 3
    v_exp_f32 v121, v121
    v_exp_f32 v122, v122
    v_exp_f32 v123, v123
    s_waitcnt lgkmcnt(3)
    v_mfma_f32_32x32x16_bf16 v[16:31], v[40:43], v[116:119], v[16:31]
    s_mov_b64 exec, s[4:5]
    ds_read_b128 v[40:43], v138 offset:59520
    s_mov_b64 exec, -1
    v_exp_f32 v124, v124
    v_exp_f32 v125, v125
    v_exp_f32 v126, v126
    v_exp_f32 v127, v127
    v_cvt_pk_bf16_f32 v112, v120, v121
    v_cvt_pk_bf16_f32 v113, v122, v123
    v_exp_f32 v128, v128
    s_waitcnt lgkmcnt(3)
    v_mfma_f32_32x32x8_bf16 v[96:111], v[48:49], v[50:51], v[96:111]
    ds_read_b64 v[48:49], v137 offset:64000
    buffer_load_dwordx4 v[8:11], v6, s[32:35], 0 offen
    buffer_load_dword v12, v7, s[32:35], 0 offen
    .p2align 3
    v_cvt_pk_bf16_f32 v114, v124, v125
    v_cvt_pk_bf16_f32 v115, v126, v127
    v_exp_f32 v129, v129
    v_exp_f32 v130, v130
    v_exp_f32 v131, v131
    s_waitcnt lgkmcnt(3)
    v_mfma_f32_32x32x16_bf16 v[16:31], v[36:39], v[112:115], v[16:31]
    s_mov_b64 exec, s[4:5]
    ds_read_b128 v[36:39], v138 offset:61440
    s_mov_b64 exec, -1
    v_exp_f32 v132, v132
    v_exp_f32 v133, v133
    v_exp_f32 v134, v134
    v_exp_f32 v135, v135
    v_cvt_pk_bf16_f32 v116, v128, v129
    v_cvt_pk_bf16_f32 v117, v130, v131
    v_cvt_pk_bf16_f32 v118, v132, v133
    v_cvt_pk_bf16_f32 v119, v134, v135
    s_setprio 0
    .p2align 3
    v_exp_f32 v96, v96
    s_waitcnt lgkmcnt(3)
    v_mfma_f32_32x32x16_bf16 v[120:135], v[32:35], v[44:47], 0
    v_add_u32 v136, 61440, v136
    ds_read_b128 v[32:35], v136 offset:5120
    v_exp_f32 v97, v97
    v_exp_f32 v98, v98
    v_exp_f32 v99, v99
    s_waitcnt lgkmcnt(3)
    v_mfma_f32_32x32x16_bf16 v[16:31], v[40:43], v[116:119], v[16:31]
    s_mov_b64 exec, s[4:5]
    ds_read_b128 v[40:43], v138 offset:62080
    s_mov_b64 exec, -1
    v_exp_f32 v100, v100
    v_exp_f32 v101, v101
    v_exp_f32 v102, v102
    v_exp_f32 v103, v103
    v_cvt_pk_bf16_f32 v112, v96, v97
    v_cvt_pk_bf16_f32 v113, v98, v99
    v_exp_f32 v104, v104
    s_waitcnt lgkmcnt(3)
    v_mfma_f32_32x32x8_bf16 v[120:135], v[48:49], v[50:51], v[120:135]
    v_add_u32 v137, 61440, v137
    ds_read_b64 v[48:49], v137 offset:5120
    v_cvt_pk_bf16_f32 v114, v100, v101
    v_cvt_pk_bf16_f32 v115, v102, v103
    v_exp_f32 v105, v105
    v_exp_f32 v106, v106
    v_exp_f32 v107, v107
    s_waitcnt lgkmcnt(3)
    v_mfma_f32_32x32x16_bf16 v[16:31], v[36:39], v[112:115], v[16:31]
    s_mov_b64 exec, s[4:5]
    ds_read_b128 v[36:39], v138 offset:64000
    s_mov_b64 exec, -1
    v_exp_f32 v108, v108
    v_exp_f32 v109, v109
    v_exp_f32 v110, v110
    v_exp_f32 v111, v111
    v_cvt_pk_bf16_f32 v116, v104, v105
    v_cvt_pk_bf16_f32 v117, v106, v107
    v_cvt_pk_bf16_f32 v118, v108, v109
    v_cvt_pk_bf16_f32 v119, v110, v111
    s_barrier
    s_setprio 3
    .p2align 3
    v_exp_f32 v120, v120
    s_waitcnt lgkmcnt(3)
    v_mfma_f32_32x32x16_bf16 v[96:111], v[32:35], v[44:47], 0
    ds_read_b128 v[32:35], v136 offset:7680
    s_waitcnt vmcnt(39)
    ds_write_b128 v142, v[64:67] offset:0
    .p2align 3
    v_exp_f32 v121, v121
    v_exp_f32 v122, v122
    v_exp_f32 v123, v123
    s_waitcnt lgkmcnt(4)
    v_mfma_f32_32x32x16_bf16 v[16:31], v[40:43], v[116:119], v[16:31]
    s_mov_b64 exec, s[4:5]
    ds_read_b128 v[40:43], v138 offset:64640
    s_mov_b64 exec, -1
    v_exp_f32 v124, v124
    v_exp_f32 v125, v125
    v_exp_f32 v126, v126
    v_exp_f32 v127, v127
    v_cvt_pk_bf16_f32 v112, v120, v121
    v_cvt_pk_bf16_f32 v113, v122, v123
    v_exp_f32 v128, v128
    s_waitcnt lgkmcnt(4)
    v_mfma_f32_32x32x8_bf16 v[96:111], v[48:49], v[50:51], v[96:111]
    ds_read_b64 v[48:49], v137 offset:7680
    v_cvt_pk_bf16_f32 v114, v124, v125
    v_cvt_pk_bf16_f32 v115, v126, v127
    v_exp_f32 v129, v129
    v_exp_f32 v130, v130
    v_exp_f32 v131, v131
    s_waitcnt lgkmcnt(4)
    v_mfma_f32_32x32x16_bf16 v[16:31], v[36:39], v[112:115], v[16:31]
    v_add_u32 v138, 61440, v138
    s_mov_b64 exec, s[4:5]
    ds_read_b128 v[36:39], v138 offset:5120
    s_mov_b64 exec, -1
    v_exp_f32 v132, v132
    v_exp_f32 v133, v133
    v_exp_f32 v134, v134
    v_exp_f32 v135, v135
    v_cvt_pk_bf16_f32 v116, v128, v129
    v_cvt_pk_bf16_f32 v117, v130, v131
    v_cvt_pk_bf16_f32 v118, v132, v133
    v_cvt_pk_bf16_f32 v119, v134, v135
    .p2align 3
    v_exp_f32 v96, v96
    s_waitcnt lgkmcnt(4)
    v_mfma_f32_32x32x16_bf16 v[120:135], v[32:35], v[44:47], 0
    ds_read_b128 v[32:35], v136 offset:10240
    ds_write_b128 v142, v[68:71] offset:1024
    .p2align 3
    v_exp_f32 v97, v97
    v_exp_f32 v98, v98
    v_exp_f32 v99, v99
    s_waitcnt lgkmcnt(4)
    v_mfma_f32_32x32x16_bf16 v[16:31], v[40:43], v[116:119], v[16:31]
    s_mov_b64 exec, s[4:5]
    ds_read_b128 v[40:43], v138 offset:5760
    s_mov_b64 exec, -1
    v_exp_f32 v100, v100
    v_exp_f32 v101, v101
    v_exp_f32 v102, v102
    v_exp_f32 v103, v103
    v_cvt_pk_bf16_f32 v112, v96, v97
    v_cvt_pk_bf16_f32 v113, v98, v99
    v_exp_f32 v104, v104
    s_waitcnt lgkmcnt(4)
    v_mfma_f32_32x32x8_bf16 v[120:135], v[48:49], v[50:51], v[120:135]
    ds_read_b64 v[48:49], v137 offset:10240
    s_mov_b32 exec_lo, 0x3ff
    s_mov_b32 exec_hi, 0x0
    buffer_load_dword v63, v155, s[56:59], 0 offen sc1
    s_mov_b64 exec, -1
    .p2align 3
    v_cvt_pk_bf16_f32 v114, v100, v101
    v_cvt_pk_bf16_f32 v115, v102, v103
    v_exp_f32 v105, v105
    v_exp_f32 v106, v106
    v_exp_f32 v107, v107
    s_waitcnt lgkmcnt(4)
    v_mfma_f32_32x32x16_bf16 v[16:31], v[36:39], v[112:115], v[16:31]
    s_mov_b64 exec, s[4:5]
    ds_read_b128 v[36:39], v138 offset:7680
    s_mov_b64 exec, -1
    v_exp_f32 v108, v108
    v_exp_f32 v109, v109
    v_exp_f32 v110, v110
    v_exp_f32 v111, v111
    v_cvt_pk_bf16_f32 v116, v104, v105
    v_cvt_pk_bf16_f32 v117, v106, v107
    v_cvt_pk_bf16_f32 v118, v108, v109
    v_cvt_pk_bf16_f32 v119, v110, v111
    .p2align 3
    v_exp_f32 v120, v120
    s_waitcnt lgkmcnt(4)
    v_mfma_f32_32x32x16_bf16 v[96:111], v[32:35], v[44:47], 0
    ds_read_b128 v[32:35], v136 offset:12800
    ds_write_b128 v142, v[72:75] offset:2048
    .p2align 3
    v_exp_f32 v121, v121
    v_exp_f32 v122, v122
    v_exp_f32 v123, v123
    s_waitcnt lgkmcnt(4)
    v_mfma_f32_32x32x16_bf16 v[16:31], v[40:43], v[116:119], v[16:31]
    s_mov_b64 exec, s[4:5]
    ds_read_b128 v[40:43], v138 offset:8320
    s_mov_b64 exec, -1
    v_exp_f32 v124, v124
    v_exp_f32 v125, v125
    v_exp_f32 v126, v126
    v_exp_f32 v127, v127
    v_cvt_pk_bf16_f32 v112, v120, v121
    v_cvt_pk_bf16_f32 v113, v122, v123
    v_exp_f32 v128, v128
    s_waitcnt lgkmcnt(4)
    v_mfma_f32_32x32x8_bf16 v[96:111], v[48:49], v[50:51], v[96:111]
    ds_read_b64 v[48:49], v137 offset:12800
    s_mov_b32 exec_lo, 0x3ff
    s_mov_b32 exec_hi, 0x0
    buffer_load_dword v63, v141, s[64:67], s23 offen sc1
    s_mov_b64 exec, -1
    .p2align 3
    v_cvt_pk_bf16_f32 v114, v124, v125
    v_cvt_pk_bf16_f32 v115, v126, v127
    v_exp_f32 v129, v129
    v_exp_f32 v130, v130
    v_exp_f32 v131, v131
    s_waitcnt lgkmcnt(4)
    v_mfma_f32_32x32x16_bf16 v[16:31], v[36:39], v[112:115], v[16:31]
    s_mov_b64 exec, s[4:5]
    ds_read_b128 v[36:39], v138 offset:10240
    s_mov_b64 exec, -1
    v_exp_f32 v132, v132
    v_exp_f32 v133, v133
    v_exp_f32 v134, v134
    v_exp_f32 v135, v135
    v_cvt_pk_bf16_f32 v116, v128, v129
    v_cvt_pk_bf16_f32 v117, v130, v131
    v_cvt_pk_bf16_f32 v118, v132, v133
    v_cvt_pk_bf16_f32 v119, v134, v135
    .p2align 3
    v_exp_f32 v96, v96
    s_waitcnt lgkmcnt(4)
    v_mfma_f32_32x32x16_bf16 v[120:135], v[32:35], v[44:47], 0
    ds_read_b128 v[32:35], v136 offset:15360
    ds_write_b128 v142, v[76:79] offset:24576
    .p2align 3
    v_exp_f32 v97, v97
    v_exp_f32 v98, v98
    v_exp_f32 v99, v99
    s_waitcnt lgkmcnt(4)
    v_mfma_f32_32x32x16_bf16 v[16:31], v[40:43], v[116:119], v[16:31]
    s_mov_b64 exec, s[4:5]
    ds_read_b128 v[40:43], v138 offset:10880
    s_mov_b64 exec, -1
    v_exp_f32 v100, v100
    v_exp_f32 v101, v101
    v_exp_f32 v102, v102
    v_exp_f32 v103, v103
    v_cvt_pk_bf16_f32 v112, v96, v97
    v_cvt_pk_bf16_f32 v113, v98, v99
    v_exp_f32 v104, v104
    s_waitcnt lgkmcnt(4)
    v_mfma_f32_32x32x8_bf16 v[120:135], v[48:49], v[50:51], v[120:135]
    ds_read_b64 v[48:49], v137 offset:15360
    s_mov_b32 exec_lo, 0x3fc00
    s_mov_b32 exec_hi, 0x0
    buffer_load_dword v63, v155, s[64:67], 0 offen sc1
    s_mov_b64 exec, -1
    .p2align 3
    v_cvt_pk_bf16_f32 v114, v100, v101
    v_cvt_pk_bf16_f32 v115, v102, v103
    v_exp_f32 v105, v105
    v_exp_f32 v106, v106
    v_exp_f32 v107, v107
    s_waitcnt lgkmcnt(4)
    v_mfma_f32_32x32x16_bf16 v[16:31], v[36:39], v[112:115], v[16:31]
    s_mov_b64 exec, s[4:5]
    ds_read_b128 v[36:39], v138 offset:12800
    s_mov_b64 exec, -1
    v_exp_f32 v108, v108
    v_exp_f32 v109, v109
    v_exp_f32 v110, v110
    v_exp_f32 v111, v111
    v_cvt_pk_bf16_f32 v116, v104, v105
    v_cvt_pk_bf16_f32 v117, v106, v107
    v_cvt_pk_bf16_f32 v118, v108, v109
    v_cvt_pk_bf16_f32 v119, v110, v111
    .p2align 3
    v_exp_f32 v120, v120
    s_waitcnt lgkmcnt(4)
    v_mfma_f32_32x32x16_bf16 v[96:111], v[32:35], v[44:47], 0
    ds_read_b128 v[32:35], v136 offset:17920
    ds_write_b128 v142, v[80:83] offset:25600
    .p2align 3
    v_exp_f32 v121, v121
    v_exp_f32 v122, v122
    v_exp_f32 v123, v123
    s_waitcnt lgkmcnt(4)
    v_mfma_f32_32x32x16_bf16 v[16:31], v[40:43], v[116:119], v[16:31]
    s_mov_b64 exec, s[4:5]
    ds_read_b128 v[40:43], v138 offset:13440
    s_mov_b64 exec, -1
    v_exp_f32 v124, v124
    v_exp_f32 v125, v125
    v_exp_f32 v126, v126
    v_exp_f32 v127, v127
    v_cvt_pk_bf16_f32 v112, v120, v121
    v_cvt_pk_bf16_f32 v113, v122, v123
    v_exp_f32 v128, v128
    s_waitcnt lgkmcnt(4)
    v_mfma_f32_32x32x8_bf16 v[96:111], v[48:49], v[50:51], v[96:111]
    ds_read_b64 v[48:49], v137 offset:17920
    s_mov_b32 exec_lo, 0xffc00
    s_mov_b32 exec_hi, 0x0
    buffer_load_dword v63, v141, s[64:67], s23 offen sc1
    s_mov_b64 exec, -1
    .p2align 3
    v_cvt_pk_bf16_f32 v114, v124, v125
    v_cvt_pk_bf16_f32 v115, v126, v127
    v_exp_f32 v129, v129
    v_exp_f32 v130, v130
    v_exp_f32 v131, v131
    s_waitcnt lgkmcnt(4)
    v_mfma_f32_32x32x16_bf16 v[16:31], v[36:39], v[112:115], v[16:31]
    s_mov_b64 exec, s[4:5]
    ds_read_b128 v[36:39], v138 offset:15360
    s_mov_b64 exec, -1
    v_exp_f32 v132, v132
    v_exp_f32 v133, v133
    v_exp_f32 v134, v134
    v_exp_f32 v135, v135
    v_cvt_pk_bf16_f32 v116, v128, v129
    v_cvt_pk_bf16_f32 v117, v130, v131
    v_cvt_pk_bf16_f32 v118, v132, v133
    v_cvt_pk_bf16_f32 v119, v134, v135
    .p2align 3
    v_exp_f32 v96, v96
    s_waitcnt lgkmcnt(4)
    v_mfma_f32_32x32x16_bf16 v[120:135], v[32:35], v[44:47], 0
    ds_read_b128 v[32:35], v136 offset:20480
    ds_write_b128 v142, v[84:87] offset:26624
    .p2align 3
    v_exp_f32 v97, v97
    v_exp_f32 v98, v98
    v_exp_f32 v99, v99
    s_waitcnt lgkmcnt(4)
    v_mfma_f32_32x32x16_bf16 v[16:31], v[40:43], v[116:119], v[16:31]
    s_mov_b64 exec, s[4:5]
    ds_read_b128 v[40:43], v138 offset:16000
    s_mov_b64 exec, -1
    v_exp_f32 v100, v100
    v_exp_f32 v101, v101
    v_exp_f32 v102, v102
    v_exp_f32 v103, v103
    v_cvt_pk_bf16_f32 v112, v96, v97
    v_cvt_pk_bf16_f32 v113, v98, v99
    v_exp_f32 v104, v104
    s_waitcnt lgkmcnt(4)
    v_mfma_f32_32x32x8_bf16 v[120:135], v[48:49], v[50:51], v[120:135]
    ds_read_b64 v[48:49], v137 offset:20480
    s_mov_b32 exec_lo, 0x7fc0000
    s_mov_b32 exec_hi, 0x0
    buffer_load_dword v63, v155, s[64:67], 0 offen sc1
    s_mov_b64 exec, -1
    .p2align 3
    v_cvt_pk_bf16_f32 v114, v100, v101
    v_cvt_pk_bf16_f32 v115, v102, v103
    v_exp_f32 v105, v105
    v_exp_f32 v106, v106
    v_exp_f32 v107, v107
    s_waitcnt lgkmcnt(4)
    v_mfma_f32_32x32x16_bf16 v[16:31], v[36:39], v[112:115], v[16:31]
    s_mov_b64 exec, s[4:5]
    ds_read_b128 v[36:39], v138 offset:17920
    s_mov_b64 exec, -1
    v_exp_f32 v108, v108
    v_exp_f32 v109, v109
    v_exp_f32 v110, v110
    v_exp_f32 v111, v111
    v_cvt_pk_bf16_f32 v116, v104, v105
    v_cvt_pk_bf16_f32 v117, v106, v107
    v_cvt_pk_bf16_f32 v118, v108, v109
    v_cvt_pk_bf16_f32 v119, v110, v111
    .p2align 3
    v_exp_f32 v120, v120
    s_waitcnt lgkmcnt(4)
    v_mfma_f32_32x32x16_bf16 v[96:111], v[32:35], v[44:47], 0
    ds_read_b128 v[32:35], v136 offset:23040
    s_mov_b32 exec_lo, 0x3ff00000
    s_mov_b32 exec_hi, 0x0
    buffer_load_dword v63, v141, s[64:67], s23 offen sc1
    s_mov_b64 exec, -1
    .p2align 3
    v_exp_f32 v121, v121
    v_exp_f32 v122, v122
    v_exp_f32 v123, v123
    s_waitcnt lgkmcnt(3)
    v_mfma_f32_32x32x16_bf16 v[16:31], v[40:43], v[116:119], v[16:31]
    s_mov_b64 exec, s[4:5]
    ds_read_b128 v[40:43], v138 offset:18560
    s_mov_b64 exec, -1
    v_exp_f32 v124, v124
    v_exp_f32 v125, v125
    v_exp_f32 v126, v126
    v_exp_f32 v127, v127
    v_cvt_pk_bf16_f32 v112, v120, v121
    v_cvt_pk_bf16_f32 v113, v122, v123
    v_exp_f32 v128, v128
    s_waitcnt lgkmcnt(3)
    v_mfma_f32_32x32x8_bf16 v[96:111], v[48:49], v[50:51], v[96:111]
    ds_read_b64 v[48:49], v137 offset:23040
    v_cvt_pk_bf16_f32 v114, v124, v125
    v_cvt_pk_bf16_f32 v115, v126, v127
    v_exp_f32 v129, v129
    v_exp_f32 v130, v130
    v_exp_f32 v131, v131
    s_waitcnt lgkmcnt(3)
    v_mfma_f32_32x32x16_bf16 v[16:31], v[36:39], v[112:115], v[16:31]
    s_mov_b64 exec, s[4:5]
    ds_read_b128 v[36:39], v138 offset:20480
    s_mov_b64 exec, -1
    v_exp_f32 v132, v132
    v_exp_f32 v133, v133
    v_exp_f32 v134, v134
    v_exp_f32 v135, v135
    v_cvt_pk_bf16_f32 v116, v128, v129
    v_cvt_pk_bf16_f32 v117, v130, v131
    v_cvt_pk_bf16_f32 v118, v132, v133
    v_cvt_pk_bf16_f32 v119, v134, v135
    .p2align 3
    v_exp_f32 v96, v96
    s_waitcnt lgkmcnt(3)
    v_mfma_f32_32x32x16_bf16 v[120:135], v[32:35], v[44:47], 0
    ds_read_b128 v[32:35], v136 offset:25600
    s_mov_b32 exec_lo, 0xf8000000
    s_mov_b32 exec_hi, 0xf
    buffer_load_dword v63, v155, s[64:67], 0 offen sc1
    s_mov_b64 exec, -1
    .p2align 3
    v_exp_f32 v97, v97
    v_exp_f32 v98, v98
    v_exp_f32 v99, v99
    s_waitcnt lgkmcnt(3)
    v_mfma_f32_32x32x16_bf16 v[16:31], v[40:43], v[116:119], v[16:31]
    s_mov_b64 exec, s[4:5]
    ds_read_b128 v[40:43], v138 offset:21120
    s_mov_b64 exec, -1
    v_exp_f32 v100, v100
    v_exp_f32 v101, v101
    v_exp_f32 v102, v102
    v_exp_f32 v103, v103
    v_cvt_pk_bf16_f32 v112, v96, v97
    v_cvt_pk_bf16_f32 v113, v98, v99
    v_exp_f32 v104, v104
    s_waitcnt lgkmcnt(3)
    v_mfma_f32_32x32x8_bf16 v[120:135], v[48:49], v[50:51], v[120:135]
    ds_read_b64 v[48:49], v137 offset:25600
    v_cvt_pk_bf16_f32 v114, v100, v101
    v_cvt_pk_bf16_f32 v115, v102, v103
    v_exp_f32 v105, v105
    v_exp_f32 v106, v106
    v_exp_f32 v107, v107
    s_waitcnt lgkmcnt(3)
    v_mfma_f32_32x32x16_bf16 v[16:31], v[36:39], v[112:115], v[16:31]
    s_mov_b64 exec, s[4:5]
    ds_read_b128 v[36:39], v138 offset:23040
    s_mov_b64 exec, -1
    v_exp_f32 v108, v108
    v_exp_f32 v109, v109
    v_exp_f32 v110, v110
    v_exp_f32 v111, v111
    v_cvt_pk_bf16_f32 v116, v104, v105
    v_cvt_pk_bf16_f32 v117, v106, v107
    v_cvt_pk_bf16_f32 v118, v108, v109
    v_cvt_pk_bf16_f32 v119, v110, v111
    s_setprio 2
    .p2align 3
    v_exp_f32 v120, v120
    s_waitcnt lgkmcnt(3)
    v_mfma_f32_32x32x16_bf16 v[96:111], v[32:35], v[44:47], 0
    ds_read_b128 v[32:35], v136 offset:28160
    s_mov_b32 exec_lo, 0xc0000000
    s_mov_b32 exec_hi, 0xff
    buffer_load_dword v63, v141, s[64:67], s23 offen sc1
    s_mov_b64 exec, -1
    .p2align 3
    v_exp_f32 v121, v121
    v_exp_f32 v122, v122
    v_exp_f32 v123, v123
    s_waitcnt lgkmcnt(3)
    v_mfma_f32_32x32x16_bf16 v[16:31], v[40:43], v[116:119], v[16:31]
    s_mov_b64 exec, s[4:5]
    ds_read_b128 v[40:43], v138 offset:23680
    s_mov_b64 exec, -1
    v_exp_f32 v124, v124
    v_exp_f32 v125, v125
    v_exp_f32 v126, v126
    v_exp_f32 v127, v127
    v_cvt_pk_bf16_f32 v112, v120, v121
    v_cvt_pk_bf16_f32 v113, v122, v123
    v_exp_f32 v128, v128
    s_waitcnt lgkmcnt(3)
    v_mfma_f32_32x32x8_bf16 v[96:111], v[48:49], v[50:51], v[96:111]
    ds_read_b64 v[48:49], v137 offset:28160
    v_cvt_pk_bf16_f32 v114, v124, v125
    v_cvt_pk_bf16_f32 v115, v126, v127
    v_exp_f32 v129, v129
    v_exp_f32 v130, v130
    v_exp_f32 v131, v131
    s_waitcnt lgkmcnt(3)
    v_mfma_f32_32x32x16_bf16 v[16:31], v[36:39], v[112:115], v[16:31]
    s_mov_b64 exec, s[4:5]
    ds_read_b128 v[36:39], v138 offset:25600
    s_mov_b64 exec, -1
    v_exp_f32 v132, v132
    v_exp_f32 v133, v133
    v_exp_f32 v134, v134
    v_exp_f32 v135, v135
    v_cvt_pk_bf16_f32 v116, v128, v129
    v_cvt_pk_bf16_f32 v117, v130, v131
    v_cvt_pk_bf16_f32 v118, v132, v133
    v_cvt_pk_bf16_f32 v119, v134, v135
    .p2align 3
    v_exp_f32 v96, v96
    s_waitcnt lgkmcnt(3)
    v_mfma_f32_32x32x16_bf16 v[120:135], v[32:35], v[44:47], 0
    ds_read_b128 v[32:35], v136 offset:30720
    s_mov_b32 exec_lo, 0x0
    s_mov_b32 exec_hi, 0x3ff00
    buffer_load_dword v63, v141, s[64:67], s23 offen sc1
    s_mov_b64 exec, -1
    .p2align 3
    v_exp_f32 v97, v97
    v_exp_f32 v98, v98
    v_exp_f32 v99, v99
    s_waitcnt lgkmcnt(3)
    v_mfma_f32_32x32x16_bf16 v[16:31], v[40:43], v[116:119], v[16:31]
    s_mov_b64 exec, s[4:5]
    ds_read_b128 v[40:43], v138 offset:26240
    s_mov_b64 exec, -1
    v_exp_f32 v100, v100
    v_exp_f32 v101, v101
    v_exp_f32 v102, v102
    v_exp_f32 v103, v103
    v_cvt_pk_bf16_f32 v112, v96, v97
    v_cvt_pk_bf16_f32 v113, v98, v99
    v_exp_f32 v104, v104
    s_waitcnt lgkmcnt(3)
    v_mfma_f32_32x32x8_bf16 v[120:135], v[48:49], v[50:51], v[120:135]
    ds_read_b64 v[48:49], v137 offset:30720
    v_cvt_pk_bf16_f32 v114, v100, v101
    v_cvt_pk_bf16_f32 v115, v102, v103
    v_exp_f32 v105, v105
    v_exp_f32 v106, v106
    v_exp_f32 v107, v107
    s_waitcnt lgkmcnt(3)
    v_mfma_f32_32x32x16_bf16 v[16:31], v[36:39], v[112:115], v[16:31]
    s_mov_b64 exec, s[4:5]
    ds_read_b128 v[36:39], v138 offset:28160
    s_mov_b64 exec, -1
    v_exp_f32 v108, v108
    v_exp_f32 v109, v109
    v_exp_f32 v110, v110
    v_exp_f32 v111, v111
    v_cvt_pk_bf16_f32 v116, v104, v105
    v_cvt_pk_bf16_f32 v117, v106, v107
    v_cvt_pk_bf16_f32 v118, v108, v109
    v_cvt_pk_bf16_f32 v119, v110, v111
    .p2align 3
    v_exp_f32 v120, v120
    s_waitcnt lgkmcnt(3)
    v_mfma_f32_32x32x16_bf16 v[96:111], v[32:35], v[44:47], 0
    ds_read_b128 v[32:35], v136 offset:33280
    s_mov_b32 exec_lo, 0x0
    s_mov_b32 exec_hi, 0xffc0000
    buffer_load_dword v63, v141, s[64:67], s23 offen sc1
    s_mov_b64 exec, -1
    .p2align 3
    v_exp_f32 v121, v121
    v_exp_f32 v122, v122
    v_exp_f32 v123, v123
    s_waitcnt lgkmcnt(3)
    v_mfma_f32_32x32x16_bf16 v[16:31], v[40:43], v[116:119], v[16:31]
    s_mov_b64 exec, s[4:5]
    ds_read_b128 v[40:43], v138 offset:28800
    s_mov_b64 exec, -1
    v_exp_f32 v124, v124
    v_exp_f32 v125, v125
    v_exp_f32 v126, v126
    v_exp_f32 v127, v127
    v_cvt_pk_bf16_f32 v112, v120, v121
    v_cvt_pk_bf16_f32 v113, v122, v123
    v_exp_f32 v128, v128
    s_waitcnt lgkmcnt(3)
    v_mfma_f32_32x32x8_bf16 v[96:111], v[48:49], v[50:51], v[96:111]
    ds_read_b64 v[48:49], v137 offset:33280
    v_cvt_pk_bf16_f32 v114, v124, v125
    v_cvt_pk_bf16_f32 v115, v126, v127
    v_exp_f32 v129, v129
    v_exp_f32 v130, v130
    v_exp_f32 v131, v131
    s_waitcnt lgkmcnt(3)
    v_mfma_f32_32x32x16_bf16 v[16:31], v[36:39], v[112:115], v[16:31]
    s_mov_b64 exec, s[4:5]
    ds_read_b128 v[36:39], v138 offset:30720
    s_mov_b64 exec, -1
    v_exp_f32 v132, v132
    v_exp_f32 v133, v133
    v_exp_f32 v134, v134
    v_exp_f32 v135, v135
    v_cvt_pk_bf16_f32 v116, v128, v129
    v_cvt_pk_bf16_f32 v117, v130, v131
    v_cvt_pk_bf16_f32 v118, v132, v133
    v_cvt_pk_bf16_f32 v119, v134, v135
    .p2align 3
    v_exp_f32 v96, v96
    s_waitcnt lgkmcnt(3)
    v_mfma_f32_32x32x16_bf16 v[120:135], v[32:35], v[44:47], 0
    ds_read_b128 v[32:35], v136 offset:35840
    v_exp_f32 v97, v97
    v_exp_f32 v98, v98
    v_exp_f32 v99, v99
    s_waitcnt lgkmcnt(3)
    v_mfma_f32_32x32x16_bf16 v[16:31], v[40:43], v[116:119], v[16:31]
    s_mov_b64 exec, s[4:5]
    ds_read_b128 v[40:43], v138 offset:31360
    s_mov_b64 exec, -1
    v_exp_f32 v100, v100
    v_exp_f32 v101, v101
    v_exp_f32 v102, v102
    v_exp_f32 v103, v103
    v_cvt_pk_bf16_f32 v112, v96, v97
    v_cvt_pk_bf16_f32 v113, v98, v99
    v_exp_f32 v104, v104
    s_waitcnt lgkmcnt(3)
    v_mfma_f32_32x32x8_bf16 v[120:135], v[48:49], v[50:51], v[120:135]
    ds_read_b64 v[48:49], v137 offset:35840
    v_cvt_pk_bf16_f32 v114, v100, v101
    v_cvt_pk_bf16_f32 v115, v102, v103
    v_exp_f32 v105, v105
    v_exp_f32 v106, v106
    v_exp_f32 v107, v107
    s_waitcnt lgkmcnt(3)
    v_mfma_f32_32x32x16_bf16 v[16:31], v[36:39], v[112:115], v[16:31]
    s_mov_b64 exec, s[4:5]
    ds_read_b128 v[36:39], v138 offset:33280
    s_mov_b64 exec, -1
    v_exp_f32 v108, v108
    v_exp_f32 v109, v109
    v_exp_f32 v110, v110
    v_exp_f32 v111, v111
    v_cvt_pk_bf16_f32 v116, v104, v105
    v_cvt_pk_bf16_f32 v117, v106, v107
    v_cvt_pk_bf16_f32 v118, v108, v109
    v_cvt_pk_bf16_f32 v119, v110, v111
    s_setprio 1
    .p2align 3
    v_exp_f32 v120, v120
    s_waitcnt lgkmcnt(3)
    v_mfma_f32_32x32x16_bf16 v[96:111], v[32:35], v[44:47], 0
    ds_read_b128 v[32:35], v136 offset:38400
    v_exp_f32 v121, v121
    v_exp_f32 v122, v122
    v_exp_f32 v123, v123
    s_waitcnt lgkmcnt(3)
    v_mfma_f32_32x32x16_bf16 v[16:31], v[40:43], v[116:119], v[16:31]
    s_mov_b64 exec, s[4:5]
    ds_read_b128 v[40:43], v138 offset:33920
    s_mov_b64 exec, -1
    v_exp_f32 v124, v124
    v_exp_f32 v125, v125
    v_exp_f32 v126, v126
    v_exp_f32 v127, v127
    v_cvt_pk_bf16_f32 v112, v120, v121
    v_cvt_pk_bf16_f32 v113, v122, v123
    v_exp_f32 v128, v128
    s_waitcnt lgkmcnt(3)
    v_mfma_f32_32x32x8_bf16 v[96:111], v[48:49], v[50:51], v[96:111]
    ds_read_b64 v[48:49], v137 offset:38400
    v_cvt_pk_bf16_f32 v114, v124, v125
    v_cvt_pk_bf16_f32 v115, v126, v127
    v_exp_f32 v129, v129
    v_exp_f32 v130, v130
    v_exp_f32 v131, v131
    s_waitcnt lgkmcnt(3)
    v_mfma_f32_32x32x16_bf16 v[16:31], v[36:39], v[112:115], v[16:31]
    s_mov_b64 exec, s[4:5]
    ds_read_b128 v[36:39], v138 offset:35840
    s_mov_b64 exec, -1
    v_exp_f32 v132, v132
    v_exp_f32 v133, v133
    v_exp_f32 v134, v134
    v_exp_f32 v135, v135
    v_cvt_pk_bf16_f32 v116, v128, v129
    v_cvt_pk_bf16_f32 v117, v130, v131
    v_cvt_pk_bf16_f32 v118, v132, v133
    v_cvt_pk_bf16_f32 v119, v134, v135
    .p2align 3
    v_exp_f32 v96, v96
    s_waitcnt lgkmcnt(3)
    v_mfma_f32_32x32x16_bf16 v[120:135], v[32:35], v[44:47], 0
    v_exp_f32 v97, v97
    v_exp_f32 v98, v98
    v_exp_f32 v99, v99
    s_waitcnt lgkmcnt(2)
    v_mfma_f32_32x32x16_bf16 v[16:31], v[40:43], v[116:119], v[16:31]
    s_mov_b64 exec, s[4:5]
    ds_read_b128 v[40:43], v138 offset:36480
    s_mov_b64 exec, -1
    v_exp_f32 v100, v100
    v_exp_f32 v101, v101
    v_exp_f32 v102, v102
    v_exp_f32 v103, v103
    v_cvt_pk_bf16_f32 v112, v96, v97
    v_cvt_pk_bf16_f32 v113, v98, v99
    v_exp_f32 v104, v104
    s_waitcnt lgkmcnt(2)
    v_mfma_f32_32x32x8_bf16 v[120:135], v[48:49], v[50:51], v[120:135]
    v_cvt_pk_bf16_f32 v114, v100, v101
    v_cvt_pk_bf16_f32 v115, v102, v103
    v_exp_f32 v105, v105
    v_exp_f32 v106, v106
    v_exp_f32 v107, v107
    s_waitcnt lgkmcnt(1)
    v_mfma_f32_32x32x16_bf16 v[16:31], v[36:39], v[112:115], v[16:31]
    s_mov_b64 exec, s[4:5]
    ds_read_b128 v[36:39], v138 offset:38400
    s_mov_b64 exec, -1
    v_exp_f32 v108, v108
    v_exp_f32 v109, v109
    v_exp_f32 v110, v110
    v_exp_f32 v111, v111
    v_cvt_pk_bf16_f32 v116, v104, v105
    v_cvt_pk_bf16_f32 v117, v106, v107
    v_cvt_pk_bf16_f32 v118, v108, v109
    v_cvt_pk_bf16_f32 v119, v110, v111
    s_setprio 0
    .p2align 3
    v_exp_f32 v120, v120
    v_exp_f32 v121, v121
    v_exp_f32 v122, v122
    v_exp_f32 v123, v123
    s_waitcnt lgkmcnt(1)
    v_mfma_f32_32x32x16_bf16 v[16:31], v[40:43], v[116:119], v[16:31]
    s_mov_b64 exec, s[4:5]
    ds_read_b128 v[40:43], v138 offset:39040
    s_mov_b64 exec, -1
    v_exp_f32 v124, v124
    v_exp_f32 v125, v125
    v_exp_f32 v126, v126
    v_exp_f32 v127, v127
    v_cvt_pk_bf16_f32 v112, v120, v121
    v_cvt_pk_bf16_f32 v113, v122, v123
    v_exp_f32 v128, v128
    v_cvt_pk_bf16_f32 v114, v124, v125
    v_cvt_pk_bf16_f32 v115, v126, v127
    v_exp_f32 v129, v129
    v_exp_f32 v130, v130
    v_exp_f32 v131, v131
    s_waitcnt lgkmcnt(1)
    v_mfma_f32_32x32x16_bf16 v[16:31], v[36:39], v[112:115], v[16:31]
    v_exp_f32 v132, v132
    v_exp_f32 v133, v133
    v_exp_f32 v134, v134
    v_exp_f32 v135, v135
    v_cvt_pk_bf16_f32 v116, v128, v129
    v_cvt_pk_bf16_f32 v117, v130, v131
    v_cvt_pk_bf16_f32 v118, v132, v133
    v_cvt_pk_bf16_f32 v119, v134, v135
    s_waitcnt lgkmcnt(0)
    s_nop 0
    v_mfma_f32_32x32x16_bf16 v[16:31], v[40:43], v[116:119], v[16:31]
    v_and_b32 v68, 1, v2
    v_mul_u32_u24 v68, 49152, v68
    v_lshl_add_u32 v68, v1, 4, v68
    v_lshl_add_u32 v68, v5, 8, v68
    v_mov_b32 v61, 2
    s_nop 6
    v_mov_b32 v28, v24
    v_mov_b32 v29, v24
    s_nop 1
    v_permlane32_swap_b32 v29, v28
    s_mov_b32 s80, 0x2b800000
    s_mov_b32 s81, 0x53800000
    v_cmp_le_f32 vcc, s80, v28
    v_cmp_ge_f32 s[82:83], s81, v28
    s_nop 0
    s_and_b64 vcc, vcc, s[82:83]
    s_cmp_eq_u64 vcc, exec
    s_cbranch_scc1 L_onorm
    v_subrev_u32 v137, 122880, v137
    v_subrev_u32 v138, 122880, v138
    v_mov_b32 v64, 0xff800000
    s_mov_b32 s80, 16384
    v_mov_b32 v16, 0
    v_mov_b32 v17, 0
    v_mov_b32 v18, 0
    v_mov_b32 v19, 0
    v_mov_b32 v20, 0
    v_mov_b32 v21, 0
    v_mov_b32 v22, 0
    v_mov_b32 v23, 0
    v_mov_b32 v24, 0
    v_mov_b32 v25, 0
    v_mov_b32 v26, 0
    v_mov_b32 v27, 0
    v_mov_b32 v28, 0
    v_mov_b32 v29, 0
    v_mov_b32 v30, 0
    v_mov_b32 v31, 0
L_slow:
    buffer_load_dwordx4 v[32:35], v3, s[64:67], s80 offen sc1
    buffer_load_dwordx2 v[48:49], v137, s[64:67], s80 offen sc1
    s_mov_b64 exec, s[4:5]
    buffer_load_dwordx4 v[36:39], v138, s[64:67], s80 offen sc1
    buffer_load_dwordx4 v[40:43], v138, s[64:67], s80 offen offset:640 sc1
    s_mov_b64 exec, -1
    s_waitcnt vmcnt(0)
    v_mfma_f32_32x32x16_bf16 v[96:111], v[32:35], v[44:47], 0
    s_nop 9
    v_mfma_f32_32x32x8_bf16 v[96:111], v[48:49], v[50:51], v[96:111]
    s_nop 11
    v_max3_f32 v65, v96, v97, v64
    v_max3_f32 v65, v98, v99, v65
    v_max3_f32 v65, v100, v101, v65
    v_max3_f32 v65, v102, v103, v65
    v_max3_f32 v65, v104, v105, v65
    v_max3_f32 v65, v106, v107, v65
    v_max3_f32 v65, v108, v109, v65
    v_max3_f32 v65, v110, v111, v65
    v_mov_b32 v66, v65
    s_nop 1
    v_permlane32_swap_b32 v66, v65
    v_max_f32 v65, v65, v66
    v_sub_f32 v66, v64, v65
    v_exp_f32 v66, v66
    v_mov_b32 v64, v65
    v_sub_f32 v96, v96, v65
    v_mul_f32 v16, v66, v16
    v_sub_f32 v97, v97, v65
    v_mul_f32 v17, v66, v17
    v_sub_f32 v98, v98, v65
    v_mul_f32 v18, v66, v18
    v_sub_f32 v99, v99, v65
    v_mul_f32 v19, v66, v19
    v_sub_f32 v100, v100, v65
    v_mul_f32 v20, v66, v20
    v_sub_f32 v101, v101, v65
    v_mul_f32 v21, v66, v21
    v_sub_f32 v102, v102, v65
    v_mul_f32 v22, v66, v22
    v_sub_f32 v103, v103, v65
    v_mul_f32 v23, v66, v23
    v_sub_f32 v104, v104, v65
    v_mul_f32 v24, v66, v24
    v_sub_f32 v105, v105, v65
    v_mul_f32 v25, v66, v25
    v_sub_f32 v106, v106, v65
    v_mul_f32 v26, v66, v26
    v_sub_f32 v107, v107, v65
    v_mul_f32 v27, v66, v27
    v_sub_f32 v108, v108, v65
    v_mul_f32 v28, v66, v28
    v_sub_f32 v109, v109, v65
    v_mul_f32 v29, v66, v29
    v_sub_f32 v110, v110, v65
    v_mul_f32 v30, v66, v30
    v_sub_f32 v111, v111, v65
    v_mul_f32 v31, v66, v31
    v_exp_f32 v96, v96
    v_exp_f32 v97, v97
    v_exp_f32 v98, v98
    v_exp_f32 v99, v99
    v_exp_f32 v100, v100
    v_exp_f32 v101, v101
    v_exp_f32 v102, v102
    v_exp_f32 v103, v103
    v_exp_f32 v104, v104
    v_exp_f32 v105, v105
    v_exp_f32 v106, v106
    v_exp_f32 v107, v107
    v_exp_f32 v108, v108
    v_exp_f32 v109, v109
    v_exp_f32 v110, v110
    v_exp_f32 v111, v111
    v_cvt_pk_bf16_f32 v112, v96, v97
    v_cvt_pk_bf16_f32 v113, v98, v99
    v_cvt_pk_bf16_f32 v114, v100, v101
    v_cvt_pk_bf16_f32 v115, v102, v103
    v_cvt_pk_bf16_f32 v116, v104, v105
    v_cvt_pk_bf16_f32 v117, v106, v107
    v_cvt_pk_bf16_f32 v118, v108, v109
    v_cvt_pk_bf16_f32 v119, v110, v111
    v_mfma_f32_32x32x16_bf16 v[16:31], v[36:39], v[112:115], v[16:31]
    s_nop 0
    v_mfma_f32_32x32x16_bf16 v[16:31], v[40:43], v[116:119], v[16:31]
    s_add_u32 s80, s80, 2560
    s_cmp_lt_u32 s80, 180224
    s_nop 8
    s_cbranch_scc1 L_slow
    v_mov_b32 v28, v24
    v_mov_b32 v29, v24
    s_nop 1
    v_permlane32_swap_b32 v29, v28
L_onorm:
    v_rcp_f32 v64, v28
    s_nop 0
    v_mul_f32 v16, v64, v16
    v_mul_f32 v17, v64, v17
    v_mul_f32 v18, v64, v18
    v_mul_f32 v19, v64, v19
    v_mul_f32 v20, v64, v20
    v_mul_f32 v21, v64, v21
    v_mul_f32 v22, v64, v22
    v_mul_f32 v23, v64, v23
    v_mul_f32 v24, v64, v24
    v_mul_f32 v25, v64, v25
    v_mul_f32 v26, v64, v26
    v_mul_f32 v27, v64, v27
    v_cvt_pk_bf16_f32 v16, v16, v17
    v_cvt_pk_bf16_f32 v17, v18, v19
    v_cvt_pk_bf16_f32 v18, v20, v21
    v_cvt_pk_bf16_f32 v19, v22, v23
    v_cvt_pk_bf16_f32 v20, v24, v25
    v_cvt_pk_bf16_f32 v21, v26, v27
    s_cmp_eq_u32 s75, 0
    s_cbranch_scc1 L_sts_11
    buffer_store_dwordx4 v[16:19], v68, s[64:67], s28 offen
    s_mov_b32 exec_hi, 0
    buffer_store_dwordx2 v[20:21], v68, s[64:67], s29 offen
    s_mov_b64 exec, -1
    s_branch L_ste_12
L_sts_11:
    buffer_store_dwordx4 v[16:19], v68, s[64:67], s28 offen sc1
    s_mov_b32 exec_hi, 0
    buffer_store_dwordx2 v[20:21], v68, s[64:67], s29 offen sc1
    s_mov_b64 exec, -1
L_ste_12:
    s_and_b32 s80, s74, 0xf8
    s_and_b32 s81, s68, 3
    s_lshl_b32 s82, s81, 1
    s_add_u32 s80, s80, s82
    s_lshl_b32 s80, s80, 5
    s_lshl_b32 s82, s77, 4
    s_add_u32 s80, s80, s82
    s_add_u32 s80, s80, 4096
    v_and_b32 v148, 3, v0
    v_lshlrev_b32 v148, 2, v148
    v_and_b32 v149, 4, v0
    v_lshl_add_u32 v148, v149, 3, v148
    v_add_u32 v148, s80, v148
    s_mov_b32 s14, s17
    s_lshr_b32 s82, s68, 1
    s_lshl_b32 s83, s73, 2
    s_add_u32 s83, s83, s82
    s_xor_b32 s84, s83, 1
    s_mul_i32 s16, s83, 49152
    s_mul_i32 s18, s84, 49152
    s_lshl_b32 s82, s81, 10
    s_add_u32 s82, s82, 5783552
    s_add_u32 s17, s16, s82
    s_add_u32 s19, s18, s82
    s_lshl_b32 s82, s81, 12
    s_add_u32 s82, s82, 5767168
    s_add_u32 s16, s16, s82
    s_add_u32 s18, s18, s82
    v_and_b32 v67, 1, v0
    v_lshlrev_b32 v69, 4, v67
    v_and_b32 v67, 2, v0
    v_lshl_add_u32 v69, v67, 2, v69
    v_mov_b32 v67, 96
    v_lshrrev_b32 v65, 2, v0
    v_mad_u32_u24 v92, v65, v67, v69
    v_add_u32 v92, s14, v92
    v_add_u32 v93, 49152, v92
    v_mov_b32 v96, 0x3f803f80
    v_mov_b32 v97, 0x3f803f80
    v_mov_b32 v98, 0x3f803f80
    v_mov_b32 v99, 0x3f803f80
    s_cmp_eq_u32 s75, 0
    s_cbranch_scc1 L_sts_13
    s_mov_b64 exec, 1
    s_waitcnt vmcnt(0)
    buffer_store_dword v61, v60, s[64:67], s27 offen
    s_mov_b64 exec, -1
    s_branch L_ste_14
L_sts_13:
    s_mov_b64 exec, 1
    s_waitcnt vmcnt(0)
    buffer_store_dword v61, v60, s[64:67], s27 offen sc1
    s_mov_b64 exec, -1
L_ste_14:
    ds_read_b64_tr_b16 v[100:101], v92 offset:0
    ds_read_b64_tr_b16 v[102:103], v92 offset:1536
    ds_read_b64_tr_b16 v[104:105], v92 offset:32
    ds_read_b64_tr_b16 v[106:107], v92 offset:1568
    ds_read_b64_tr_b16 v[108:109], v92 offset:64
    ds_read_b64_tr_b16 v[110:111], v92 offset:1600
    ds_read_b64_tr_b16 v[112:113], v92 offset:24576
    ds_read_b64_tr_b16 v[114:115], v92 offset:26112
    ds_read_b64_tr_b16 v[116:117], v92 offset:24608
    ds_read_b64_tr_b16 v[118:119], v92 offset:26144
    ds_read_b64_tr_b16 v[120:121], v92 offset:24640
    ds_read_b64_tr_b16 v[122:123], v92 offset:26176
    s_waitcnt lgkmcnt(10)
    v_mfma_f32_16x16x32_bf16 v[16:19], v[96:99], v[100:103], 0
    ds_read_b64_tr_b16 v[124:125], v93 offset:0
    ds_read_b64_tr_b16 v[126:127], v93 offset:1536
    s_waitcnt lgkmcnt(10)
    v_mfma_f32_16x16x32_bf16 v[20:23], v[96:99], v[104:107], 0
    ds_read_b64_tr_b16 v[128:129], v93 offset:32
    ds_read_b64_tr_b16 v[130:131], v93 offset:1568
    s_waitcnt lgkmcnt(10)
    v_mfma_f32_16x16x32_bf16 v[24:27], v[96:99], v[108:111], 0
    ds_read_b64_tr_b16 v[132:133], v93 offset:64
    ds_read_b64_tr_b16 v[134:135], v93 offset:1600
    buffer_load_dword v149, v148, s[64:67], 0 offen sc1
    s_waitcnt lgkmcnt(10)
    v_mfma_f32_16x16x32_bf16 v[16:19], v[96:99], v[112:115], v[16:19]
    ds_read_b64_tr_b16 v[100:101], v93 offset:24576
    ds_read_b64_tr_b16 v[102:103], v93 offset:26112
    s_waitcnt lgkmcnt(10)
    v_mfma_f32_16x16x32_bf16 v[20:23], v[96:99], v[116:119], v[20:23]
    ds_read_b64_tr_b16 v[104:105], v93 offset:24608
    ds_read_b64_tr_b16 v[106:107], v93 offset:26144
    s_waitcnt lgkmcnt(10)
    v_mfma_f32_16x16x32_bf16 v[24:27], v[96:99], v[120:123], v[24:27]
    ds_read_b64_tr_b16 v[108:109], v93 offset:24640
    ds_read_b64_tr_b16 v[110:111], v93 offset:26176
    s_waitcnt lgkmcnt(10)
    v_mfma_f32_16x16x32_bf16 v[16:19], v[96:99], v[124:127], v[16:19]
    ds_read_b64_tr_b16 v[112:113], v93 offset:49152
    ds_read_b64_tr_b16 v[114:115], v93 offset:50688
    s_waitcnt lgkmcnt(10)
    v_mfma_f32_16x16x32_bf16 v[20:23], v[96:99], v[128:131], v[20:23]
    ds_read_b64_tr_b16 v[116:117], v93 offset:49184
    ds_read_b64_tr_b16 v[118:119], v93 offset:50720
    s_waitcnt lgkmcnt(10)
    v_mfma_f32_16x16x32_bf16 v[24:27], v[96:99], v[132:135], v[24:27]
    ds_read_b64_tr_b16 v[120:121], v93 offset:49216
    ds_read_b64_tr_b16 v[122:123], v93 offset:50752
    s_waitcnt lgkmcnt(10)
    v_mfma_f32_16x16x32_bf16 v[16:19], v[96:99], v[100:103], v[16:19]
    s_waitcnt lgkmcnt(8)
    v_mfma_f32_16x16x32_bf16 v[20:23], v[96:99], v[104:107], v[20:23]
    s_waitcnt lgkmcnt(6)
    v_mfma_f32_16x16x32_bf16 v[24:27], v[96:99], v[108:111], v[24:27]
    s_waitcnt lgkmcnt(4)
    v_mfma_f32_16x16x32_bf16 v[16:19], v[96:99], v[112:115], v[16:19]
    s_waitcnt lgkmcnt(2)
    v_mfma_f32_16x16x32_bf16 v[20:23], v[96:99], v[116:119], v[20:23]
    s_waitcnt lgkmcnt(0)
    v_mfma_f32_16x16x32_bf16 v[24:27], v[96:99], v[120:123], v[24:27]
    v_lshlrev_b32 v76, 16, v8
    v_and_b32 v77, 0xffff0000, v8
    v_lshlrev_b32 v78, 16, v9
    v_and_b32 v79, 0xffff0000, v9
    v_lshlrev_b32 v80, 16, v10
    v_and_b32 v81, 0xffff0000, v10
    v_lshlrev_b32 v82, 16, v11
    v_and_b32 v83, 0xffff0000, v11
    v_lshlrev_b32 v84, 16, v12
    v_and_b32 v85, 0xffff0000, v12
    s_barrier
    s_waitcnt vmcnt(0)
    s_movk_i32 s85, 0x7fff
    v_cmp_le_u32 vcc, 2, v149
    s_nop 0
    s_cmp_eq_u64 vcc, exec
    s_cbranch_scc1 L_pdone_16
L_poll_15:
    buffer_load_dword v149, v148, s[64:67], 0 offen offset:0 sc1
    s_sub_u32 s85, s85, 1
    s_waitcnt vmcnt(0)
    s_cbranch_scc1 L_pdone_16
    v_cmp_le_u32 vcc, 2, v149
    s_nop 0
    s_cmp_eq_u64 vcc, exec
    s_nop 1
    s_cbranch_scc0 L_poll_15
L_pdone_16:
    buffer_load_dwordx4 v[116:119], v3, s[64:67], s18 offen offset:0 sc1
    buffer_load_dwordx4 v[120:123], v3, s[64:67], s18 offen offset:1024 sc1
    buffer_load_dwordx4 v[124:127], v3, s[64:67], s18 offen offset:2048 sc1
    buffer_load_dwordx4 v[128:131], v3, s[64:67], s18 offen offset:3072 sc1
    v_mov_b32 v92, v16
    v_mov_b32 v93, v20
    v_mov_b32 v94, v24
    v_and_b32 v64, 1, v2
    v_lshrrev_b32 v65, 2, v1
    v_lshl_add_u32 v65, v5, 3, v65
    v_lshlrev_b32 v66, 2, v64
    v_xor_b32 v65, v65, v66
    v_xor_b32 v66, 4, v65
    v_mul_u32_u24 v64, 3072, v64
    v_add_u32 v64, v69, v64
    v_mad_u32_u24 v88, v65, v67, v64
    v_mad_u32_u24 v90, v66, v67, v64
    v_add_u32 v89, 61440, v88
    v_add_u32 v91, 61440, v90
    s_mul_i32 s80, s68, 5120
    s_add_u32 s80, s80, 122880
    v_add_u32 v136, s80, v3
    v_lshl_add_u32 v138, v0, 3, s80
    s_xor_b32 s80, s68, 2
    s_mul_i32 s80, s80, 5120
    s_add_u32 s80, s80, 122880
    v_add_u32 v137, s80, v3
    s_xor_b32 s80, s68, 1
    s_mul_i32 s80, s80, 5120
    s_add_u32 s80, s80, 122880
    v_lshl_add_u32 v139, v0, 3, s80
    s_lshl_b32 s80, s73, 1
    s_add_u32 s80, s80, s77
    s_mul_i32 s80, s80, 40960
    s_bfe_u32 s81, s68, 0x10001
    s_lshl_b32 s81, s81, 8
    s_add_u32 s80, s80, s81
    s_and_b32 s81, s68, 1
    s_lshl_b32 s82, s72, 3
    s_add_u32 s82, s82, s81
    s_lshl_b32 s82, s82, 9
    s_add_u32 s20, s80, s82
    s_lshl_b32 s82, s72, 10
    s_add_u32 s21, s80, s82
    s_lshl_b32 s82, s81, 2
    s_add_u32 s21, s21, s82
    s_add_u32 s21, s21, 32768
    s_lshl_b32 s80, s73, 2
    s_lshr_b32 s82, s68, 1
    s_add_u32 s80, s80, s82
    s_lshl_b32 s80, s80, 8
    s_lshl_b32 s82, s72, 15
    s_add_u32 s80, s80, s82
    s_lshl_b32 s82, s81, 3
    s_add_u32 s80, s80, s82
    s_add_u32 s22, s80, 5505024
    v_lshlrev_b32 v140, 4, v1
    v_lshl_add_u32 v141, v2, 10, v140
    v_lshrrev_b32 v142, 1, v2
    v_lshl_add_u32 v142, v142, 9, v140
    v_and_b32 v143, 1, v2
    v_lshl_add_u32 v142, v143, 3, v142
    v_mov_b32 v144, 0
    v_mov_b32 v145, 0
    v_mov_b32 v146, 0x3f803f80
    v_mov_b32 v147, 0
    v_mov_b32 v150, 3
    s_mov_b32 s23, 125440
    s_waitcnt vmcnt(3)
    v_mfma_f32_16x16x32_bf16 v[36:39], v[156:159], v[116:119], 0
    buffer_load_dwordx4 v[132:135], v3, s[64:67], s19 offen offset:0 sc1
    v_mfma_f32_16x16x32_bf16 v[40:43], v[160:163], v[116:119], 0
    v_mfma_f32_16x16x32_bf16 v[44:47], v[164:167], v[116:119], 0
    v_mfma_f32_16x16x32_bf16 v[48:51], v[168:171], v[116:119], 0
    v_mfma_f32_16x16x32_bf16 v[52:55], v[172:175], v[116:119], 0
    s_waitcnt vmcnt(3)
    v_mfma_f32_16x16x32_bf16 v[36:39], v[176:179], v[120:123], v[36:39]
    buffer_load_dwordx4 v[96:99], v3, s[64:67], s16 offen offset:0 sc1
    v_mfma_f32_16x16x32_bf16 v[40:43], v[180:183], v[120:123], v[40:43]
    v_mfma_f32_16x16x32_bf16 v[44:47], v[184:187], v[120:123], v[44:47]
    v_mfma_f32_16x16x32_bf16 v[48:51], v[188:191], v[120:123], v[48:51]
    v_mfma_f32_16x16x32_bf16 v[52:55], v[192:195], v[120:123], v[52:55]
    s_waitcnt vmcnt(3)
    v_mfma_f32_16x16x32_bf16 v[36:39], v[196:199], v[124:127], v[36:39]
    buffer_load_dwordx4 v[100:103], v3, s[64:67], s16 offen offset:1024 sc1
    v_mfma_f32_16x16x32_bf16 v[40:43], v[200:203], v[124:127], v[40:43]
    v_mfma_f32_16x16x32_bf16 v[44:47], v[204:207], v[124:127], v[44:47]
    v_mfma_f32_16x16x32_bf16 v[48:51], v[208:211], v[124:127], v[48:51]
    v_mfma_f32_16x16x32_bf16 v[52:55], v[212:215], v[124:127], v[52:55]
    s_waitcnt vmcnt(3)
    v_mfma_f32_16x16x32_bf16 v[36:39], v[216:219], v[128:131], v[36:39]
    buffer_load_dwordx4 v[104:107], v3, s[64:67], s16 offen offset:2048 sc1
    v_mfma_f32_16x16x32_bf16 v[40:43], v[220:223], v[128:131], v[40:43]
    v_mfma_f32_16x16x32_bf16 v[44:47], v[224:227], v[128:131], v[44:47]
    v_mfma_f32_16x16x32_bf16 v[48:51], v[228:231], v[128:131], v[48:51]
    v_mfma_f32_16x16x32_bf16 v[52:55], v[232:235], v[128:131], v[52:55]
    s_waitcnt vmcnt(3)
    v_mfma_f32_16x16x32_bf16 v[36:39], v[236:239], v[132:135], v[36:39]
    buffer_load_dwordx4 v[108:111], v3, s[64:67], s16 offen offset:3072 sc1
    v_mfma_f32_16x16x32_bf16 v[40:43], v[240:243], v[132:135], v[40:43]
    v_mfma_f32_16x16x32_bf16 v[44:47], v[244:247], v[132:135], v[44:47]
    v_mfma_f32_16x16x32_bf16 v[48:51], v[248:251], v[132:135], v[48:51]
    v_mfma_f32_16x16x32_bf16 v[52:55], v[252:255], v[132:135], v[52:55]
    s_waitcnt vmcnt(3)
    v_mfma_f32_16x16x32_bf16 v[16:19], v[156:159], v[96:99], 0
    buffer_load_dwordx4 v[112:115], v3, s[64:67], s17 offen offset:0 sc1
    v_mfma_f32_16x16x32_bf16 v[20:23], v[160:163], v[96:99], 0
    v_mfma_f32_16x16x32_bf16 v[24:27], v[164:167], v[96:99], 0
    v_mfma_f32_16x16x32_bf16 v[28:31], v[168:171], v[96:99], 0
    ds_write_b128 v137, v[36:39] offset:0
    v_mfma_f32_16x16x32_bf16 v[32:35], v[172:175], v[96:99], 0
    s_waitcnt vmcnt(3)
    v_mfma_f32_16x16x32_bf16 v[16:19], v[176:179], v[100:103], v[16:19]
    v_mfma_f32_16x16x32_bf16 v[20:23], v[180:183], v[100:103], v[20:23]
    ds_write_b128 v137, v[40:43] offset:1024
    v_mfma_f32_16x16x32_bf16 v[24:27], v[184:187], v[100:103], v[24:27]
    v_mfma_f32_16x16x32_bf16 v[28:31], v[188:191], v[100:103], v[28:31]
    v_mfma_f32_16x16x32_bf16 v[32:35], v[192:195], v[100:103], v[32:35]
    ds_write_b128 v137, v[44:47] offset:2048
    s_waitcnt vmcnt(2)
    v_mfma_f32_16x16x32_bf16 v[16:19], v[196:199], v[104:107], v[16:19]
    v_mfma_f32_16x16x32_bf16 v[20:23], v[200:203], v[104:107], v[20:23]
    v_mfma_f32_16x16x32_bf16 v[24:27], v[204:207], v[104:107], v[24:27]
    ds_write_b128 v137, v[48:51] offset:3072
    v_mfma_f32_16x16x32_bf16 v[28:31], v[208:211], v[104:107], v[28:31]
    v_mfma_f32_16x16x32_bf16 v[32:35], v[212:215], v[104:107], v[32:35]
    s_waitcnt vmcnt(1)
    v_mfma_f32_16x16x32_bf16 v[16:19], v[216:219], v[108:111], v[16:19]
    ds_write_b128 v137, v[52:55] offset:4096
    v_mfma_f32_16x16x32_bf16 v[20:23], v[220:223], v[108:111], v[20:23]
    v_mfma_f32_16x16x32_bf16 v[24:27], v[224:227], v[108:111], v[24:27]
    v_mfma_f32_16x16x32_bf16 v[28:31], v[228:231], v[108:111], v[28:31]
    v_mfma_f32_16x16x32_bf16 v[32:35], v[232:235], v[108:111], v[32:35]
    s_waitcnt lgkmcnt(0)
    s_barrier
    ds_read_b128 v[56:59], v136 offset:0
    ds_read_b128 v[60:63], v136 offset:1024
    ds_read_b128 v[64:67], v136 offset:2048
    ds_read_b128 v[68:71], v136 offset:3072
    ds_read_b128 v[72:75], v136 offset:4096
    s_waitcnt vmcnt(0)
    v_mfma_f32_16x16x32_bf16 v[16:19], v[236:239], v[112:115], v[16:19]
    v_mfma_f32_16x16x32_bf16 v[20:23], v[240:243], v[112:115], v[20:23]
    v_mfma_f32_16x16x32_bf16 v[24:27], v[244:247], v[112:115], v[24:27]
    v_mfma_f32_16x16x32_bf16 v[28:31], v[248:251], v[112:115], v[28:31]
    v_mfma_f32_16x16x32_bf16 v[32:35], v[252:255], v[112:115], v[32:35]
    s_waitcnt lgkmcnt(4)
    s_nop 2
    v_pk_add_f32 v[18:19], v[18:19], v[58:59]
    ds_write_b64 v138, v[18:19] offset:0
    s_waitcnt lgkmcnt(4)
    v_pk_add_f32 v[22:23], v[22:23], v[62:63]
    ds_write_b64 v138, v[22:23] offset:512
    s_waitcnt lgkmcnt(4)
    v_pk_add_f32 v[26:27], v[26:27], v[66:67]
    ds_write_b64 v138, v[26:27] offset:1024
    s_waitcnt lgkmcnt(4)
    v_pk_add_f32 v[30:31], v[30:31], v[70:71]
    ds_write_b64 v138, v[30:31] offset:1536
    s_waitcnt lgkmcnt(4)
    v_pk_add_f32 v[34:35], v[34:35], v[74:75]
    ds_write_b64 v138, v[34:35] offset:2048
    s_mov_b64 exec, 0xffff
    ds_write_b128 v136, v[92:95] offset:2560
    s_mov_b64 exec, -1
    v_pk_add_f32 v[16:17], v[16:17], v[56:57]
    v_pk_add_f32 v[20:21], v[20:21], v[60:61]
    v_pk_add_f32 v[24:25], v[24:25], v[64:65]
    v_pk_add_f32 v[28:29], v[28:29], v[68:69]
    v_pk_add_f32 v[32:33], v[32:33], v[72:73]
    v_add_f32 v76, v76, v16
    v_add_f32 v77, v77, v20
    v_add_f32 v78, v78, v24
    v_add_f32 v79, v79, v28
    v_add_f32 v80, v80, v17
    v_add_f32 v81, v81, v21
    v_add_f32 v82, v82, v25
    v_add_f32 v83, v83, v29
    v_add_f32 v84, v84, v32
    v_add_f32 v85, v85, v33
    s_waitcnt lgkmcnt(0)
    s_barrier
    ds_read_b64 v[56:57], v139 offset:0
    ds_read_b64 v[60:61], v139 offset:512
    ds_read_b64 v[64:65], v139 offset:1024
    ds_read_b64 v[68:69], v139 offset:1536
    ds_read_b64 v[72:73], v139 offset:2048
    v_mul_u32_u24 v151, 5120, v143
    v_add3_u32 v151, v151, v140, s23
    ds_read_b128 v[16:19], v151 offset:0
    ds_read_b128 v[20:23], v151 offset:10240
    ds_read_b128 v[24:27], v151 offset:20480
    ds_read_b128 v[28:31], v151 offset:30720
    s_waitcnt lgkmcnt(5)
    v_add_f32 v76, v76, v56
    v_add_f32 v77, v77, v60
    v_add_f32 v78, v78, v64
    v_add_f32 v79, v79, v68
    v_add_f32 v80, v80, v57
    v_add_f32 v81, v81, v61
    v_add_f32 v82, v82, v65
    v_add_f32 v83, v83, v69
    s_waitcnt lgkmcnt(4)
    v_add_f32 v84, v84, v72
    v_add_f32 v85, v85, v73
    v_cvt_pk_bf16_f32 v8, v76, v77
    v_cvt_pk_bf16_f32 v9, v78, v79
    v_cvt_pk_bf16_f32 v10, v80, v81
    v_cvt_pk_bf16_f32 v11, v82, v83
    v_cvt_pk_bf16_f32 v12, v84, v85
    s_cmp_eq_u32 s75, 0
    s_cbranch_scc1 L_sts_17
    buffer_store_dwordx4 v[8:11], v141, s[56:59], s20 offen
    buffer_store_dword v12, v142, s[56:59], s21 offen
    s_branch L_ste_18
L_sts_17:
    buffer_store_dwordx4 v[8:11], v141, s[56:59], s20 offen sc1
    buffer_store_dword v12, v142, s[56:59], s21 offen sc1
L_ste_18:
    v_dot2c_f32_bf16 v144, v8, v146
    v_dot2c_f32_bf16 v145, v8, v8
    v_dot2c_f32_bf16 v144, v9, v146
    v_dot2c_f32_bf16 v145, v9, v9
    v_dot2c_f32_bf16 v144, v10, v146
    v_dot2c_f32_bf16 v145, v10, v10
    v_dot2c_f32_bf16 v144, v11, v146
    v_dot2c_f32_bf16 v145, v11, v11
    v_dot2c_f32_bf16 v144, v12, v146
    v_dot2c_f32_bf16 v145, v12, v12
    v_lshl_add_u32 v140, v143, 2, v140
    s_nop 1
    v_permlane16_swap_b32 v144, v145
    v_add_f32 v144, v144, v145
    v_mov_b32 v145, v144
    s_nop 1
    v_permlane32_swap_b32 v145, v144
    v_add_f32 v144, v144, v145
    s_cmp_eq_u32 s75, 0
    s_cbranch_scc1 L_sts_19
    s_mov_b32 exec_hi, 0
    buffer_store_dword v144, v140, s[64:67], s22 offen
    s_mov_b64 exec, 1
    s_waitcnt vmcnt(0)
    buffer_store_dword v150, v147, s[64:67], s27 offen
    s_mov_b64 exec, -1
    s_branch L_ste_20
L_sts_19:
    s_mov_b32 exec_hi, 0
    buffer_store_dword v144, v140, s[64:67], s22 offen sc1
    s_mov_b64 exec, 1
    s_waitcnt vmcnt(0)
    buffer_store_dword v150, v147, s[64:67], s27 offen sc1
    s_mov_b64 exec, -1
L_ste_20:
    s_and_b32 s80, s68, 3
    s_lshl_b32 s81, s69, 2
    s_add_u32 s80, s80, s81
    s_lshl_b32 s81, s80, 8
    s_lshl_b32 s82, s77, 4
    s_add_u32 s81, s81, s82
    s_add_u32 s81, s81, 4096
    v_and_b32 v100, 3, v0
    v_lshlrev_b32 v100, 2, v100
    v_and_b32 v101, 28, v0
    v_lshl_add_u32 v100, v101, 3, v100
    v_add_u32 v100, s81, v100
    buffer_load_dword v101, v100, s[64:67], 0 offen sc1
    s_lshl_b32 s80, s80, 1
    s_add_u32 s15, s80, s77
    s_mul_i32 s16, s15, 40960
    s_lshl_b32 s17, s15, 9
    s_add_u32 s17, s17, 5505024
    v_lshlrev_b32 v102, 4, v4
    v_lshl_add_u32 v102, v5, 17, v102
    s_waitcnt lgkmcnt(0)
    v_pk_add_f32 v[16:17], v[16:17], v[20:21]
    v_pk_add_f32 v[24:25], v[24:25], v[28:29]
    v_add_f32 v18, v18, v22
    v_add_f32 v26, v26, v30
    v_pk_add_f32 v[94:95], v[16:17], v[24:25]
    v_add_f32 v15, v18, v26
    ds_read_b64_tr_b16 v[64:65], v88 offset:0
    ds_read_b64_tr_b16 v[66:67], v90 offset:0
    ds_read_b64_tr_b16 v[68:69], v88 offset:32
    ds_read_b64_tr_b16 v[70:71], v90 offset:32
    ds_read_b64_tr_b16 v[72:73], v88 offset:64
    ds_read_b64_tr_b16 v[74:75], v90 offset:64
    v_mov_b32 v92, v102
    s_waitcnt vmcnt(0)
    s_movk_i32 s85, 0x7fff
    v_cmp_le_u32 vcc, 3, v101
    s_nop 0
    s_cmp_eq_u64 vcc, exec
    s_cbranch_scc1 L_pdone_22
L_poll_21:
    buffer_load_dword v101, v100, s[64:67], 0 offen offset:0 sc1
    s_sub_u32 s85, s85, 1
    s_waitcnt vmcnt(0)
    s_cbranch_scc1 L_pdone_22
    v_cmp_le_u32 vcc, 3, v101
    s_nop 0
    s_cmp_eq_u64 vcc, exec
    s_nop 1
    s_cbranch_scc0 L_poll_21
L_pdone_22:
    buffer_load_dwordx4 v[96:99], v3, s[56:59], s16 offen offset:0 sc1
    buffer_load_dwordx4 v[100:103], v3, s[56:59], s16 offen offset:1024 sc1
    buffer_load_dwordx4 v[104:107], v3, s[56:59], s16 offen offset:2048 sc1
    buffer_load_dwordx4 v[108:111], v3, s[56:59], s16 offen offset:3072 sc1
    ds_read_b64_tr_b16 v[76:77], v88 offset:1536
    ds_read_b64_tr_b16 v[78:79], v90 offset:1536
    s_waitcnt vmcnt(3) lgkmcnt(6)
    v_mfma_f32_32x32x16_bf16 v[16:31], v[64:67], v[96:99], 0
    s_add_u32 s16, s16, 4096
    buffer_load_dwordx4 v[112:115], v3, s[56:59], s16 offen offset:0 sc1
    ds_read_b64_tr_b16 v[80:81], v88 offset:1568
    ds_read_b64_tr_b16 v[82:83], v90 offset:1568
    s_waitcnt lgkmcnt(6)
    v_mfma_f32_32x32x16_bf16 v[32:47], v[68:71], v[96:99], 0
    ds_read_b64_tr_b16 v[84:85], v88 offset:1600
    ds_read_b64_tr_b16 v[86:87], v90 offset:1600
    s_waitcnt lgkmcnt(6)
    v_mfma_f32_32x32x16_bf16 v[48:63], v[72:75], v[96:99], 0
    ds_read_b64_tr_b16 v[64:65], v88 offset:6144
    ds_read_b64_tr_b16 v[66:67], v90 offset:6144
    s_waitcnt vmcnt(3) lgkmcnt(6)
    v_mfma_f32_32x32x16_bf16 v[16:31], v[76:79], v[100:103], v[16:31]
    buffer_load_dwordx4 v[116:119], v3, s[56:59], s16 offen offset:1024 sc1
    ds_read_b64_tr_b16 v[68:69], v88 offset:6176
    ds_read_b64_tr_b16 v[70:71], v90 offset:6176
    s_waitcnt lgkmcnt(6)
    v_mfma_f32_32x32x16_bf16 v[32:47], v[80:83], v[100:103], v[32:47]
    ds_read_b64_tr_b16 v[72:73], v88 offset:6208
    ds_read_b64_tr_b16 v[74:75], v90 offset:6208
    s_waitcnt lgkmcnt(6)
    v_mfma_f32_32x32x16_bf16 v[48:63], v[84:87], v[100:103], v[48:63]
    ds_read_b64_tr_b16 v[76:77], v88 offset:7680
    ds_read_b64_tr_b16 v[78:79], v90 offset:7680
    s_waitcnt vmcnt(3) lgkmcnt(6)
    v_mfma_f32_32x32x16_bf16 v[16:31], v[64:67], v[104:107], v[16:31]
    buffer_load_dwordx4 v[96:99], v3, s[56:59], s16 offen offset:2048 sc1
    ds_read_b64_tr_b16 v[80:81], v88 offset:7712
    ds_read_b64_tr_b16 v[82:83], v90 offset:7712
    s_waitcnt lgkmcnt(6)
    v_mfma_f32_32x32x16_bf16 v[32:47], v[68:71], v[104:107], v[32:47]
    buffer_load_dwordx4 v[120:123], v92, s[64:67], s17 offen sc1
    ds_read_b64_tr_b16 v[84:85], v88 offset:7744
    ds_read_b64_tr_b16 v[86:87], v90 offset:7744
    s_waitcnt lgkmcnt(6)
    v_mfma_f32_32x32x16_bf16 v[48:63], v[72:75], v[104:107], v[48:63]
    ds_read_b64_tr_b16 v[64:65], v88 offset:12288
    ds_read_b64_tr_b16 v[66:67], v90 offset:12288
    s_waitcnt vmcnt(4) lgkmcnt(6)
    v_mfma_f32_32x32x16_bf16 v[16:31], v[76:79], v[108:111], v[16:31]
    buffer_load_dwordx4 v[100:103], v3, s[56:59], s16 offen offset:3072 sc1
    ds_read_b64_tr_b16 v[68:69], v88 offset:12320
    ds_read_b64_tr_b16 v[70:71], v90 offset:12320
    s_waitcnt lgkmcnt(6)
    v_mfma_f32_32x32x16_bf16 v[32:47], v[80:83], v[108:111], v[32:47]
    ds_read_b64_tr_b16 v[72:73], v88 offset:12352
    ds_read_b64_tr_b16 v[74:75], v90 offset:12352
    s_waitcnt lgkmcnt(6)
    v_mfma_f32_32x32x16_bf16 v[48:63], v[84:87], v[108:111], v[48:63]
    ds_read_b64_tr_b16 v[76:77], v88 offset:13824
    ds_read_b64_tr_b16 v[78:79], v90 offset:13824
    s_waitcnt vmcnt(4) lgkmcnt(6)
    v_mfma_f32_32x32x16_bf16 v[16:31], v[64:67], v[112:115], v[16:31]
    s_add_u32 s16, s16, 4096
    buffer_load_dwordx4 v[104:107], v3, s[56:59], s16 offen offset:0 sc1
    ds_read_b64_tr_b16 v[80:81], v88 offset:13856
    ds_read_b64_tr_b16 v[82:83], v90 offset:13856
    s_waitcnt lgkmcnt(6)
    v_mfma_f32_32x32x16_bf16 v[32:47], v[68:71], v[112:115], v[32:47]
    s_add_u32 s17, s17, 32768
    buffer_load_dwordx4 v[124:127], v92, s[64:67], s17 offen sc1
    ds_read_b64_tr_b16 v[84:85], v88 offset:13888
    ds_read_b64_tr_b16 v[86:87], v90 offset:13888
    s_waitcnt lgkmcnt(6)
    v_mfma_f32_32x32x16_bf16 v[48:63], v[72:75], v[112:115], v[48:63]
    ds_read_b64_tr_b16 v[64:65], v88 offset:18432
    ds_read_b64_tr_b16 v[66:67], v90 offset:18432
    s_waitcnt vmcnt(5) lgkmcnt(6)
    v_mfma_f32_32x32x16_bf16 v[16:31], v[76:79], v[116:119], v[16:31]
    buffer_load_dwordx4 v[108:111], v3, s[56:59], s16 offen offset:1024 sc1
    ds_read_b64_tr_b16 v[68:69], v88 offset:18464
    ds_read_b64_tr_b16 v[70:71], v90 offset:18464
    s_waitcnt lgkmcnt(6)
    v_mfma_f32_32x32x16_bf16 v[32:47], v[80:83], v[116:119], v[32:47]
    ds_read_b64_tr_b16 v[72:73], v88 offset:18496
    ds_read_b64_tr_b16 v[74:75], v90 offset:18496
    s_waitcnt lgkmcnt(6)
    v_mfma_f32_32x32x16_bf16 v[48:63], v[84:87], v[116:119], v[48:63]
    ds_read_b64_tr_b16 v[76:77], v88 offset:19968
    ds_read_b64_tr_b16 v[78:79], v90 offset:19968
    s_waitcnt vmcnt(5) lgkmcnt(6)
    v_mfma_f32_32x32x16_bf16 v[16:31], v[64:67], v[96:99], v[16:31]
    buffer_load_dwordx4 v[112:115], v3, s[56:59], s16 offen offset:2048 sc1
    ds_read_b64_tr_b16 v[80:81], v88 offset:20000
    ds_read_b64_tr_b16 v[82:83], v90 offset:20000
    s_waitcnt lgkmcnt(6)
    v_mfma_f32_32x32x16_bf16 v[32:47], v[68:71], v[96:99], v[32:47]
    s_add_u32 s17, s17, 32768
    buffer_load_dwordx4 v[128:131], v92, s[64:67], s17 offen sc1
    ds_read_b64_tr_b16 v[84:85], v88 offset:20032
    ds_read_b64_tr_b16 v[86:87], v90 offset:20032
    s_waitcnt lgkmcnt(6)
    v_mfma_f32_32x32x16_bf16 v[48:63], v[72:75], v[96:99], v[48:63]
    ds_read_b64_tr_b16 v[64:65], v88 offset:24576
    ds_read_b64_tr_b16 v[66:67], v90 offset:24576
    s_waitcnt vmcnt(5) lgkmcnt(6)
    v_mfma_f32_32x32x16_bf16 v[16:31], v[76:79], v[100:103], v[16:31]
    buffer_load_dwordx4 v[116:119], v3, s[56:59], s16 offen offset:3072 sc1
    ds_read_b64_tr_b16 v[68:69], v88 offset:24608
    ds_read_b64_tr_b16 v[70:71], v90 offset:24608
    s_waitcnt lgkmcnt(6)
    v_mfma_f32_32x32x16_bf16 v[32:47], v[80:83], v[100:103], v[32:47]
    ds_read_b64_tr_b16 v[72:73], v88 offset:24640
    ds_read_b64_tr_b16 v[74:75], v90 offset:24640
    s_waitcnt lgkmcnt(6)
    v_mfma_f32_32x32x16_bf16 v[48:63], v[84:87], v[100:103], v[48:63]
    ds_read_b64_tr_b16 v[76:77], v88 offset:26112
    ds_read_b64_tr_b16 v[78:79], v90 offset:26112
    s_waitcnt vmcnt(5) lgkmcnt(6)
    v_mfma_f32_32x32x16_bf16 v[16:31], v[64:67], v[104:107], v[16:31]
    s_add_u32 s16, s16, 4096
    buffer_load_dwordx4 v[96:99], v3, s[56:59], s16 offen offset:0 sc1
    ds_read_b64_tr_b16 v[80:81], v88 offset:26144
    ds_read_b64_tr_b16 v[82:83], v90 offset:26144
    s_waitcnt lgkmcnt(6)
    v_mfma_f32_32x32x16_bf16 v[32:47], v[68:71], v[104:107], v[32:47]
    s_add_u32 s17, s17, 32768
    buffer_load_dwordx4 v[132:135], v92, s[64:67], s17 offen sc1
    ds_read_b64_tr_b16 v[84:85], v88 offset:26176
    ds_read_b64_tr_b16 v[86:87], v90 offset:26176
    s_waitcnt lgkmcnt(6)
    v_mfma_f32_32x32x16_bf16 v[48:63], v[72:75], v[104:107], v[48:63]
    ds_read_b64_tr_b16 v[64:65], v88 offset:30720
    ds_read_b64_tr_b16 v[66:67], v90 offset:30720
    s_waitcnt vmcnt(5) lgkmcnt(6)
    v_mfma_f32_32x32x16_bf16 v[16:31], v[76:79], v[108:111], v[16:31]
    buffer_load_dwordx4 v[100:103], v3, s[56:59], s16 offen offset:1024 sc1
    ds_read_b64_tr_b16 v[68:69], v88 offset:30752
    ds_read_b64_tr_b16 v[70:71], v90 offset:30752
    s_waitcnt lgkmcnt(6)
    v_mfma_f32_32x32x16_bf16 v[32:47], v[80:83], v[108:111], v[32:47]
    ds_read_b64_tr_b16 v[72:73], v88 offset:30784
    ds_read_b64_tr_b16 v[74:75], v90 offset:30784
    s_waitcnt lgkmcnt(6)
    v_mfma_f32_32x32x16_bf16 v[48:63], v[84:87], v[108:111], v[48:63]
    ds_read_b64_tr_b16 v[76:77], v88 offset:32256
    ds_read_b64_tr_b16 v[78:79], v90 offset:32256
    s_waitcnt vmcnt(5) lgkmcnt(6)
    v_mfma_f32_32x32x16_bf16 v[16:31], v[64:67], v[112:115], v[16:31]
    buffer_load_dwordx4 v[104:107], v3, s[56:59], s16 offen offset:2048 sc1
    ds_read_b64_tr_b16 v[80:81], v88 offset:32288
    ds_read_b64_tr_b16 v[82:83], v90 offset:32288
    s_waitcnt lgkmcnt(6)
    v_mfma_f32_32x32x16_bf16 v[32:47], v[68:71], v[112:115], v[32:47]
    s_add_u32 s13, s24, 4096
    buffer_load_dwordx4 v[156:159], v14, s[64:67], s13 offen offset:1024 sc1
    ds_read_b64_tr_b16 v[84:85], v88 offset:32320
    ds_read_b64_tr_b16 v[86:87], v90 offset:32320
    s_waitcnt lgkmcnt(6)
    v_mfma_f32_32x32x16_bf16 v[48:63], v[72:75], v[112:115], v[48:63]
    ds_read_b64_tr_b16 v[64:65], v88 offset:36864
    ds_read_b64_tr_b16 v[66:67], v90 offset:36864
    s_waitcnt vmcnt(5) lgkmcnt(6)
    v_mfma_f32_32x32x16_bf16 v[16:31], v[76:79], v[116:119], v[16:31]
    buffer_load_dwordx4 v[108:111], v3, s[56:59], s16 offen offset:3072 sc1
    ds_read_b64_tr_b16 v[68:69], v88 offset:36896
    ds_read_b64_tr_b16 v[70:71], v90 offset:36896
    s_waitcnt lgkmcnt(6)
    v_mfma_f32_32x32x16_bf16 v[32:47], v[80:83], v[116:119], v[32:47]
    s_add_u32 s13, s24, 4096
    buffer_load_dwordx4 v[160:163], v14, s[64:67], s13 offen offset:2048 sc1
    ds_read_b64_tr_b16 v[72:73], v88 offset:36928
    ds_read_b64_tr_b16 v[74:75], v90 offset:36928
    s_waitcnt lgkmcnt(6)
    v_mfma_f32_32x32x16_bf16 v[48:63], v[84:87], v[116:119], v[48:63]
    ds_read_b64_tr_b16 v[76:77], v88 offset:38400
    ds_read_b64_tr_b16 v[78:79], v90 offset:38400
    s_waitcnt vmcnt(6) lgkmcnt(6)
    v_mfma_f32_32x32x16_bf16 v[16:31], v[64:67], v[96:99], v[16:31]
    s_add_u32 s16, s16, 4096
    buffer_load_dwordx4 v[112:115], v3, s[56:59], s16 offen offset:0 sc1
    ds_read_b64_tr_b16 v[80:81], v88 offset:38432
    ds_read_b64_tr_b16 v[82:83], v90 offset:38432
    s_waitcnt lgkmcnt(6)
    v_mfma_f32_32x32x16_bf16 v[32:47], v[68:71], v[96:99], v[32:47]
    ds_read_b64_tr_b16 v[84:85], v88 offset:38464
    ds_read_b64_tr_b16 v[86:87], v90 offset:38464
    s_waitcnt lgkmcnt(6)
    v_mfma_f32_32x32x16_bf16 v[48:63], v[72:75], v[96:99], v[48:63]
    ds_read_b64_tr_b16 v[64:65], v88 offset:43008
    ds_read_b64_tr_b16 v[66:67], v90 offset:43008
    s_waitcnt vmcnt(5) lgkmcnt(6)
    v_mfma_f32_32x32x16_bf16 v[16:31], v[76:79], v[100:103], v[16:31]
    buffer_load_dwordx4 v[116:119], v3, s[56:59], s16 offen offset:1024 sc1
    ds_read_b64_tr_b16 v[68:69], v88 offset:43040
    ds_read_b64_tr_b16 v[70:71], v90 offset:43040
    s_waitcnt lgkmcnt(6)
    v_mfma_f32_32x32x16_bf16 v[32:47], v[80:83], v[100:103], v[32:47]
    s_add_u32 s13, s24, 4096
    buffer_load_dwordx4 v[164:167], v14, s[64:67], s13 offen offset:3072 sc1
    ds_read_b64_tr_b16 v[72:73], v88 offset:43072
    ds_read_b64_tr_b16 v[74:75], v90 offset:43072
    s_waitcnt lgkmcnt(6)
    v_mfma_f32_32x32x16_bf16 v[48:63], v[84:87], v[100:103], v[48:63]
    ds_read_b64_tr_b16 v[76:77], v88 offset:44544
    ds_read_b64_tr_b16 v[78:79], v90 offset:44544
    s_waitcnt vmcnt(6) lgkmcnt(6)
    v_mfma_f32_32x32x16_bf16 v[16:31], v[64:67], v[104:107], v[16:31]
    buffer_load_dwordx4 v[96:99], v3, s[56:59], s16 offen offset:2048 sc1
    ds_read_b64_tr_b16 v[80:81], v88 offset:44576
    ds_read_b64_tr_b16 v[82:83], v90 offset:44576
    s_waitcnt lgkmcnt(6)
    v_mfma_f32_32x32x16_bf16 v[32:47], v[68:71], v[104:107], v[32:47]
    ds_read_b64_tr_b16 v[84:85], v88 offset:44608
    ds_read_b64_tr_b16 v[86:87], v90 offset:44608
    s_waitcnt lgkmcnt(6)
    v_mfma_f32_32x32x16_bf16 v[48:63], v[72:75], v[104:107], v[48:63]
    ds_read_b64_tr_b16 v[64:65], v88 offset:49152
    ds_read_b64_tr_b16 v[66:67], v90 offset:49152
    s_waitcnt vmcnt(5) lgkmcnt(6)
    v_mfma_f32_32x32x16_bf16 v[16:31], v[76:79], v[108:111], v[16:31]
    buffer_load_dwordx4 v[100:103], v3, s[56:59], s16 offen offset:3072 sc1
    ds_read_b64_tr_b16 v[68:69], v88 offset:49184
    ds_read_b64_tr_b16 v[70:71], v90 offset:49184
    s_waitcnt lgkmcnt(6)
    v_mfma_f32_32x32x16_bf16 v[32:47], v[80:83], v[108:111], v[32:47]
    s_add_u32 s13, s24, 8192
    buffer_load_dwordx4 v[168:171], v14, s[64:67], s13 offen offset:0 sc1
    ds_read_b64_tr_b16 v[72:73], v88 offset:49216
    ds_read_b64_tr_b16 v[74:75], v90 offset:49216
    s_waitcnt lgkmcnt(6)
    v_mfma_f32_32x32x16_bf16 v[48:63], v[84:87], v[108:111], v[48:63]
    ds_read_b64_tr_b16 v[76:77], v88 offset:50688
    ds_read_b64_tr_b16 v[78:79], v90 offset:50688
    s_waitcnt vmcnt(5) lgkmcnt(6)
    v_mfma_f32_32x32x16_bf16 v[16:31], v[64:67], v[112:115], v[16:31]
    s_add_u32 s16, s16, 4096
    buffer_load_dwordx4 v[104:107], v3, s[56:59], s16 offen offset:0 sc1
    ds_read_b64_tr_b16 v[80:81], v88 offset:50720
    ds_read_b64_tr_b16 v[82:83], v90 offset:50720
    s_waitcnt lgkmcnt(6)
    v_mfma_f32_32x32x16_bf16 v[32:47], v[68:71], v[112:115], v[32:47]
    ds_read_b64_tr_b16 v[84:85], v88 offset:50752
    ds_read_b64_tr_b16 v[86:87], v90 offset:50752
    s_waitcnt lgkmcnt(6)
    v_mfma_f32_32x32x16_bf16 v[48:63], v[72:75], v[112:115], v[48:63]
    v_add_f32 v120, v120, v122
    v_add_f32 v121, v121, v123
    v_add_f32 v124, v124, v126
    ds_read_b64_tr_b16 v[64:65], v88 offset:55296
    ds_read_b64_tr_b16 v[66:67], v90 offset:55296
    s_waitcnt vmcnt(5) lgkmcnt(6)
    v_mfma_f32_32x32x16_bf16 v[16:31], v[76:79], v[116:119], v[16:31]
    buffer_load_dwordx4 v[108:111], v3, s[56:59], s16 offen offset:1024 sc1
    ds_read_b64_tr_b16 v[68:69], v88 offset:55328
    ds_read_b64_tr_b16 v[70:71], v90 offset:55328
    s_waitcnt lgkmcnt(6)
    v_mfma_f32_32x32x16_bf16 v[32:47], v[80:83], v[116:119], v[32:47]
    s_add_u32 s13, s24, 8192
    buffer_load_dwordx4 v[172:175], v14, s[64:67], s13 offen offset:1024 sc1
    ds_read_b64_tr_b16 v[72:73], v88 offset:55360
    ds_read_b64_tr_b16 v[74:75], v90 offset:55360
    s_waitcnt lgkmcnt(6)
    v_mfma_f32_32x32x16_bf16 v[48:63], v[84:87], v[116:119], v[48:63]
    v_add_f32 v125, v125, v127
    v_add_f32 v128, v128, v130
    v_add_f32 v129, v129, v131
    ds_read_b64_tr_b16 v[76:77], v88 offset:56832
    ds_read_b64_tr_b16 v[78:79], v90 offset:56832
    s_waitcnt vmcnt(5) lgkmcnt(6)
    v_mfma_f32_32x32x16_bf16 v[16:31], v[64:67], v[96:99], v[16:31]
    buffer_load_dwordx4 v[112:115], v3, s[56:59], s16 offen offset:2048 sc1
    ds_read_b64_tr_b16 v[80:81], v88 offset:56864
    ds_read_b64_tr_b16 v[82:83], v90 offset:56864
    s_waitcnt lgkmcnt(6)
    v_mfma_f32_32x32x16_bf16 v[32:47], v[68:71], v[96:99], v[32:47]
    ds_read_b64_tr_b16 v[84:85], v88 offset:56896
    ds_read_b64_tr_b16 v[86:87], v90 offset:56896
    s_waitcnt lgkmcnt(6)
    v_mfma_f32_32x32x16_bf16 v[48:63], v[72:75], v[96:99], v[48:63]
    v_add_f32 v132, v132, v134
    v_add_f32 v133, v133, v135
    v_add_f32 v120, v120, v124
    ds_read_b64_tr_b16 v[64:65], v89 offset:0
    ds_read_b64_tr_b16 v[66:67], v91 offset:0
    s_waitcnt vmcnt(5) lgkmcnt(6)
    v_mfma_f32_32x32x16_bf16 v[16:31], v[76:79], v[100:103], v[16:31]
    buffer_load_dwordx4 v[116:119], v3, s[56:59], s16 offen offset:3072 sc1
    ds_read_b64_tr_b16 v[68:69], v89 offset:32
    ds_read_b64_tr_b16 v[70:71], v91 offset:32
    s_waitcnt lgkmcnt(6)
    v_mfma_f32_32x32x16_bf16 v[32:47], v[80:83], v[100:103], v[32:47]
    s_add_u32 s13, s24, 8192
    buffer_load_dwordx4 v[176:179], v14, s[64:67], s13 offen offset:2048 sc1
    ds_read_b64_tr_b16 v[72:73], v89 offset:64
    ds_read_b64_tr_b16 v[74:75], v91 offset:64
    s_waitcnt lgkmcnt(6)
    v_mfma_f32_32x32x16_bf16 v[48:63], v[84:87], v[100:103], v[48:63]
    v_add_f32 v121, v121, v125
    v_add_f32 v128, v128, v132
    v_add_f32 v129, v129, v133
    ds_read_b64_tr_b16 v[76:77], v89 offset:1536
    ds_read_b64_tr_b16 v[78:79], v91 offset:1536
    s_waitcnt vmcnt(5) lgkmcnt(6)
    v_mfma_f32_32x32x16_bf16 v[16:31], v[64:67], v[104:107], v[16:31]
    s_add_u32 s16, s16, 4096
    buffer_load_dwordx4 v[96:99], v3, s[56:59], s16 offen offset:0 sc1
    ds_read_b64_tr_b16 v[80:81], v89 offset:1568
    ds_read_b64_tr_b16 v[82:83], v91 offset:1568
    s_waitcnt lgkmcnt(6)
    v_mfma_f32_32x32x16_bf16 v[32:47], v[68:71], v[104:107], v[32:47]
    ds_read_b64_tr_b16 v[84:85], v89 offset:1600
    ds_read_b64_tr_b16 v[86:87], v91 offset:1600
    s_waitcnt lgkmcnt(6)
    v_mfma_f32_32x32x16_bf16 v[48:63], v[72:75], v[104:107], v[48:63]
    v_add_f32 v120, v120, v128
    v_add_f32 v121, v121, v129
    v_mov_b32 v122, v120
    ds_read_b64_tr_b16 v[64:65], v89 offset:6144
    ds_read_b64_tr_b16 v[66:67], v91 offset:6144
    s_waitcnt vmcnt(5) lgkmcnt(6)
    v_mfma_f32_32x32x16_bf16 v[16:31], v[76:79], v[108:111], v[16:31]
    buffer_load_dwordx4 v[100:103], v3, s[56:59], s16 offen offset:1024 sc1
    ds_read_b64_tr_b16 v[68:69], v89 offset:6176
    ds_read_b64_tr_b16 v[70:71], v91 offset:6176
    s_waitcnt lgkmcnt(6)
    v_mfma_f32_32x32x16_bf16 v[32:47], v[80:83], v[108:111], v[32:47]
    s_add_u32 s13, s24, 8192
    buffer_load_dwordx4 v[180:183], v14, s[64:67], s13 offen offset:3072 sc1
    ds_read_b64_tr_b16 v[72:73], v89 offset:6208
    ds_read_b64_tr_b16 v[74:75], v91 offset:6208
    s_waitcnt lgkmcnt(6)
    v_mfma_f32_32x32x16_bf16 v[48:63], v[84:87], v[108:111], v[48:63]
    v_mov_b32 v123, v121
    v_cmp_eq_u32 vcc, 0, v5
    v_permlane32_swap_b32 v122, v120
    ds_read_b64_tr_b16 v[76:77], v89 offset:7680
    ds_read_b64_tr_b16 v[78:79], v91 offset:7680
    s_waitcnt vmcnt(5) lgkmcnt(6)
    v_mfma_f32_32x32x16_bf16 v[16:31], v[64:67], v[112:115], v[16:31]
    buffer_load_dwordx4 v[104:107], v3, s[56:59], s16 offen offset:2048 sc1
    ds_read_b64_tr_b16 v[80:81], v89 offset:7712
    ds_read_b64_tr_b16 v[82:83], v91 offset:7712
    s_waitcnt lgkmcnt(6)
    v_mfma_f32_32x32x16_bf16 v[32:47], v[68:71], v[112:115], v[32:47]
    ds_read_b64_tr_b16 v[84:85], v89 offset:7744
    ds_read_b64_tr_b16 v[86:87], v91 offset:7744
    s_waitcnt lgkmcnt(6)
    v_mfma_f32_32x32x16_bf16 v[48:63], v[72:75], v[112:115], v[48:63]
    v_permlane32_swap_b32 v123, v121
    v_add_f32 v120, v120, v122
    v_add_f32 v121, v121, v123
    ds_read_b64_tr_b16 v[64:65], v89 offset:12288
    ds_read_b64_tr_b16 v[66:67], v91 offset:12288
    s_waitcnt vmcnt(5) lgkmcnt(6)
    v_mfma_f32_32x32x16_bf16 v[16:31], v[76:79], v[116:119], v[16:31]
    buffer_load_dwordx4 v[108:111], v3, s[56:59], s16 offen offset:3072 sc1
    ds_read_b64_tr_b16 v[68:69], v89 offset:12320
    ds_read_b64_tr_b16 v[70:71], v91 offset:12320
    s_waitcnt lgkmcnt(6)
    v_mfma_f32_32x32x16_bf16 v[32:47], v[80:83], v[116:119], v[32:47]
    s_add_u32 s13, s24, 12288
    buffer_load_dwordx4 v[184:187], v14, s[64:67], s13 offen offset:0 sc1
    ds_read_b64_tr_b16 v[72:73], v89 offset:12352
    ds_read_b64_tr_b16 v[74:75], v91 offset:12352
    s_waitcnt lgkmcnt(6)
    v_mfma_f32_32x32x16_bf16 v[48:63], v[84:87], v[116:119], v[48:63]
    v_mul_f32 v122, 0x3acccccd, v120
    v_mul_f32 v4, 0x3acccccd, v121
    v_fma_f32 v4, -v122, v122, v4
    ds_read_b64_tr_b16 v[76:77], v89 offset:13824
    ds_read_b64_tr_b16 v[78:79], v91 offset:13824
    s_waitcnt vmcnt(5) lgkmcnt(6)
    v_mfma_f32_32x32x16_bf16 v[16:31], v[64:67], v[96:99], v[16:31]
    s_add_u32 s16, s16, 4096
    buffer_load_dwordx4 v[112:115], v3, s[56:59], s16 offen offset:0 sc1
    ds_read_b64_tr_b16 v[80:81], v89 offset:13856
    ds_read_b64_tr_b16 v[82:83], v91 offset:13856
    s_waitcnt lgkmcnt(6)
    v_mfma_f32_32x32x16_bf16 v[32:47], v[68:71], v[96:99], v[32:47]
    ds_read_b64_tr_b16 v[84:85], v89 offset:13888
    ds_read_b64_tr_b16 v[86:87], v91 offset:13888
    s_waitcnt lgkmcnt(6)
    v_mfma_f32_32x32x16_bf16 v[48:63], v[72:75], v[96:99], v[48:63]
    v_max_f32 v4, 0, v4
    v_add_f32 v4, 0x3727c5ac, v4
    v_rsq_f32 v13, v4
    ds_read_b64_tr_b16 v[64:65], v89 offset:18432
    ds_read_b64_tr_b16 v[66:67], v91 offset:18432
    s_waitcnt vmcnt(5) lgkmcnt(6)
    v_mfma_f32_32x32x16_bf16 v[16:31], v[76:79], v[100:103], v[16:31]
    buffer_load_dwordx4 v[116:119], v3, s[56:59], s16 offen offset:1024 sc1
    ds_read_b64_tr_b16 v[68:69], v89 offset:18464
    ds_read_b64_tr_b16 v[70:71], v91 offset:18464
    s_waitcnt lgkmcnt(6)
    v_mfma_f32_32x32x16_bf16 v[32:47], v[80:83], v[100:103], v[32:47]
    s_add_u32 s13, s24, 12288
    buffer_load_dwordx4 v[188:191], v14, s[64:67], s13 offen offset:1024 sc1
    ds_read_b64_tr_b16 v[72:73], v89 offset:18496
    ds_read_b64_tr_b16 v[74:75], v91 offset:18496
    s_waitcnt lgkmcnt(6)
    v_mfma_f32_32x32x16_bf16 v[48:63], v[84:87], v[100:103], v[48:63]
    v_sub_f32 v122, 0, v122
    v_cndmask_b32 v122, 0, v122, vcc
    v_and_b32 v123, 0xffff0000, v122
    ds_read_b64_tr_b16 v[76:77], v89 offset:19968
    ds_read_b64_tr_b16 v[78:79], v91 offset:19968
    s_waitcnt vmcnt(5) lgkmcnt(6)
    v_mfma_f32_32x32x16_bf16 v[16:31], v[64:67], v[104:107], v[16:31]
    buffer_load_dwordx4 v[96:99], v3, s[56:59], s16 offen offset:2048 sc1
    ds_read_b64_tr_b16 v[80:81], v89 offset:20000
    ds_read_b64_tr_b16 v[82:83], v91 offset:20000
    s_waitcnt lgkmcnt(6)
    v_mfma_f32_32x32x16_bf16 v[32:47], v[68:71], v[104:107], v[32:47]
    ds_read_b64_tr_b16 v[84:85], v89 offset:20032
    ds_read_b64_tr_b16 v[86:87], v91 offset:20032
    s_waitcnt lgkmcnt(6)
    v_mfma_f32_32x32x16_bf16 v[48:63], v[72:75], v[104:107], v[48:63]
    v_sub_f32 v121, v122, v123
    v_cvt_pk_bf16_f32 v120, v123, v121
    v_lshrrev_b32 v121, 16, v122
    ds_read_b64_tr_b16 v[64:65], v89 offset:24576
    ds_read_b64_tr_b16 v[66:67], v91 offset:24576
    s_waitcnt vmcnt(5) lgkmcnt(6)
    v_mfma_f32_32x32x16_bf16 v[16:31], v[76:79], v[108:111], v[16:31]
    buffer_load_dwordx4 v[100:103], v3, s[56:59], s16 offen offset:3072 sc1
    ds_read_b64_tr_b16 v[68:69], v89 offset:24608
    ds_read_b64_tr_b16 v[70:71], v91 offset:24608
    s_waitcnt lgkmcnt(6)
    v_mfma_f32_32x32x16_bf16 v[32:47], v[80:83], v[108:111], v[32:47]
    s_add_u32 s13, s24, 12288
    buffer_load_dwordx4 v[192:195], v14, s[64:67], s13 offen offset:2048 sc1
    ds_read_b64_tr_b16 v[72:73], v89 offset:24640
    ds_read_b64_tr_b16 v[74:75], v91 offset:24640
    s_waitcnt lgkmcnt(6)
    v_mfma_f32_32x32x16_bf16 v[48:63], v[84:87], v[108:111], v[48:63]
    v_mov_b32 v122, 0
    v_mov_b32 v123, 0
    v_and_b32 v126, 0xffff0000, v94
    ds_read_b64_tr_b16 v[76:77], v89 offset:26112
    ds_read_b64_tr_b16 v[78:79], v91 offset:26112
    s_waitcnt vmcnt(5) lgkmcnt(6)
    v_mfma_f32_32x32x16_bf16 v[16:31], v[64:67], v[112:115], v[16:31]
    s_add_u32 s16, s16, 4096
    buffer_load_dwordx4 v[104:107], v3, s[56:59], s16 offen offset:0 sc1
    ds_read_b64_tr_b16 v[80:81], v89 offset:26144
    ds_read_b64_tr_b16 v[82:83], v91 offset:26144
    s_waitcnt lgkmcnt(6)
    v_mfma_f32_32x32x16_bf16 v[32:47], v[68:71], v[112:115], v[32:47]
    ds_read_b64_tr_b16 v[84:85], v89 offset:26176
    ds_read_b64_tr_b16 v[86:87], v91 offset:26176
    s_waitcnt lgkmcnt(6)
    v_mfma_f32_32x32x16_bf16 v[48:63], v[72:75], v[112:115], v[48:63]
    v_sub_f32 v126, v94, v126
    v_perm_b32 v124, v94, v94, s7
    v_cvt_pk_bf16_f32 v125, v126, 0
    ds_read_b64_tr_b16 v[64:65], v89 offset:30720
    ds_read_b64_tr_b16 v[66:67], v91 offset:30720
    s_waitcnt vmcnt(5) lgkmcnt(6)
    v_mfma_f32_32x32x16_bf16 v[16:31], v[76:79], v[116:119], v[16:31]
    buffer_load_dwordx4 v[108:111], v3, s[56:59], s16 offen offset:1024 sc1
    ds_read_b64_tr_b16 v[68:69], v89 offset:30752
    ds_read_b64_tr_b16 v[70:71], v91 offset:30752
    s_waitcnt lgkmcnt(6)
    v_mfma_f32_32x32x16_bf16 v[32:47], v[80:83], v[116:119], v[32:47]
    s_add_u32 s13, s24, 12288
    buffer_load_dwordx4 v[196:199], v14, s[64:67], s13 offen offset:3072 sc1
    ds_read_b64_tr_b16 v[72:73], v89 offset:30784
    ds_read_b64_tr_b16 v[74:75], v91 offset:30784
    s_waitcnt lgkmcnt(6)
    v_mfma_f32_32x32x16_bf16 v[48:63], v[84:87], v[116:119], v[48:63]
    v_mov_b32 v126, 0
    v_mov_b32 v127, 0
    v_and_b32 v130, 0xffff0000, v95
    ds_read_b64_tr_b16 v[76:77], v89 offset:32256
    ds_read_b64_tr_b16 v[78:79], v91 offset:32256
    s_waitcnt vmcnt(5) lgkmcnt(6)
    v_mfma_f32_32x32x16_bf16 v[16:31], v[64:67], v[96:99], v[16:31]
    buffer_load_dwordx4 v[112:115], v3, s[56:59], s16 offen offset:2048 sc1
    ds_read_b64_tr_b16 v[80:81], v89 offset:32288
    ds_read_b64_tr_b16 v[82:83], v91 offset:32288
    s_waitcnt lgkmcnt(6)
    v_mfma_f32_32x32x16_bf16 v[32:47], v[68:71], v[96:99], v[32:47]
    ds_read_b64_tr_b16 v[84:85], v89 offset:32320
    ds_read_b64_tr_b16 v[86:87], v91 offset:32320
    s_waitcnt lgkmcnt(6)
    v_mfma_f32_32x32x16_bf16 v[48:63], v[72:75], v[96:99], v[48:63]
    v_sub_f32 v130, v95, v130
    v_perm_b32 v128, v95, v95, s7
    v_cvt_pk_bf16_f32 v129, v130, 0
    ds_read_b64_tr_b16 v[64:65], v89 offset:36864
    ds_read_b64_tr_b16 v[66:67], v91 offset:36864
    s_waitcnt vmcnt(5) lgkmcnt(6)
    v_mfma_f32_32x32x16_bf16 v[16:31], v[76:79], v[100:103], v[16:31]
    buffer_load_dwordx4 v[116:119], v3, s[56:59], s16 offen offset:3072 sc1
    ds_read_b64_tr_b16 v[68:69], v89 offset:36896
    ds_read_b64_tr_b16 v[70:71], v91 offset:36896
    s_waitcnt lgkmcnt(6)
    v_mfma_f32_32x32x16_bf16 v[32:47], v[80:83], v[100:103], v[32:47]
    s_add_u32 s13, s24, 16384
    buffer_load_dwordx4 v[200:203], v14, s[64:67], s13 offen offset:0 sc1
    ds_read_b64_tr_b16 v[72:73], v89 offset:36928
    ds_read_b64_tr_b16 v[74:75], v91 offset:36928
    s_waitcnt lgkmcnt(6)
    v_mfma_f32_32x32x16_bf16 v[48:63], v[84:87], v[100:103], v[48:63]
    v_mov_b32 v130, 0
    v_mov_b32 v131, 0
    v_and_b32 v134, 0xffff0000, v15
    ds_read_b64_tr_b16 v[76:77], v89 offset:38400
    ds_read_b64_tr_b16 v[78:79], v91 offset:38400
    s_waitcnt vmcnt(5) lgkmcnt(6)
    v_mfma_f32_32x32x16_bf16 v[16:31], v[64:67], v[104:107], v[16:31]
    s_add_u32 s16, s16, 4096
    buffer_load_dwordx4 v[96:99], v3, s[56:59], s16 offen offset:0 sc1
    ds_read_b64_tr_b16 v[80:81], v89 offset:38432
    ds_read_b64_tr_b16 v[82:83], v91 offset:38432
    s_waitcnt lgkmcnt(6)
    v_mfma_f32_32x32x16_bf16 v[32:47], v[68:71], v[104:107], v[32:47]
    ds_read_b64_tr_b16 v[84:85], v89 offset:38464
    ds_read_b64_tr_b16 v[86:87], v91 offset:38464
    s_waitcnt lgkmcnt(6)
    v_mfma_f32_32x32x16_bf16 v[48:63], v[72:75], v[104:107], v[48:63]
    v_sub_f32 v134, v15, v134
    v_perm_b32 v132, v15, v15, s7
    v_cvt_pk_bf16_f32 v133, v134, 0
    ds_read_b64_tr_b16 v[64:65], v89 offset:43008
    ds_read_b64_tr_b16 v[66:67], v91 offset:43008
    s_waitcnt vmcnt(5) lgkmcnt(6)
    v_mfma_f32_32x32x16_bf16 v[16:31], v[76:79], v[108:111], v[16:31]
    buffer_load_dwordx4 v[100:103], v3, s[56:59], s16 offen offset:1024 sc1
    ds_read_b64_tr_b16 v[68:69], v89 offset:43040
    ds_read_b64_tr_b16 v[70:71], v91 offset:43040
    s_waitcnt lgkmcnt(6)
    v_mfma_f32_32x32x16_bf16 v[32:47], v[80:83], v[108:111], v[32:47]
    s_add_u32 s13, s24, 16384
    buffer_load_dwordx4 v[204:207], v14, s[64:67], s13 offen offset:1024 sc1
    ds_read_b64_tr_b16 v[72:73], v89 offset:43072
    ds_read_b64_tr_b16 v[74:75], v91 offset:43072
    s_waitcnt lgkmcnt(6)
    v_mfma_f32_32x32x16_bf16 v[48:63], v[84:87], v[108:111], v[48:63]
    v_mov_b32 v134, 0
    v_mov_b32 v135, 0
    ds_read_b64_tr_b16 v[76:77], v89 offset:44544
    ds_read_b64_tr_b16 v[78:79], v91 offset:44544
    s_waitcnt vmcnt(5) lgkmcnt(6)
    v_mfma_f32_32x32x16_bf16 v[16:31], v[64:67], v[112:115], v[16:31]
    buffer_load_dwordx4 v[104:107], v3, s[56:59], s16 offen offset:2048 sc1
    ds_read_b64_tr_b16 v[80:81], v89 offset:44576
    ds_read_b64_tr_b16 v[82:83], v91 offset:44576
    s_waitcnt lgkmcnt(6)
    v_mfma_f32_32x32x16_bf16 v[32:47], v[68:71], v[112:115], v[32:47]
    ds_read_b64_tr_b16 v[84:85], v89 offset:44608
    ds_read_b64_tr_b16 v[86:87], v91 offset:44608
    s_waitcnt lgkmcnt(6)
    v_mfma_f32_32x32x16_bf16 v[48:63], v[72:75], v[112:115], v[48:63]
    ds_read_b64_tr_b16 v[64:65], v89 offset:49152
    ds_read_b64_tr_b16 v[66:67], v91 offset:49152
    s_waitcnt vmcnt(5) lgkmcnt(6)
    v_mfma_f32_32x32x16_bf16 v[16:31], v[76:79], v[116:119], v[16:31]
    buffer_load_dwordx4 v[108:111], v3, s[56:59], s16 offen offset:3072 sc1
    ds_read_b64_tr_b16 v[68:69], v89 offset:49184
    ds_read_b64_tr_b16 v[70:71], v91 offset:49184
    s_waitcnt lgkmcnt(6)
    v_mfma_f32_32x32x16_bf16 v[32:47], v[80:83], v[116:119], v[32:47]
    s_add_u32 s13, s24, 16384
    buffer_load_dwordx4 v[208:211], v14, s[64:67], s13 offen offset:2048 sc1
    ds_read_b64_tr_b16 v[72:73], v89 offset:49216
    ds_read_b64_tr_b16 v[74:75], v91 offset:49216
    s_waitcnt lgkmcnt(6)
    v_mfma_f32_32x32x16_bf16 v[48:63], v[84:87], v[116:119], v[48:63]
    ds_read_b64_tr_b16 v[76:77], v89 offset:50688
    ds_read_b64_tr_b16 v[78:79], v91 offset:50688
    s_waitcnt vmcnt(5) lgkmcnt(6)
    v_mfma_f32_32x32x16_bf16 v[16:31], v[64:67], v[96:99], v[16:31]
    ds_read_b64_tr_b16 v[80:81], v89 offset:50720
    ds_read_b64_tr_b16 v[82:83], v91 offset:50720
    s_waitcnt lgkmcnt(6)
    v_mfma_f32_32x32x16_bf16 v[32:47], v[68:71], v[96:99], v[32:47]
    ds_read_b64_tr_b16 v[84:85], v89 offset:50752
    ds_read_b64_tr_b16 v[86:87], v91 offset:50752
    s_waitcnt lgkmcnt(6)
    v_mfma_f32_32x32x16_bf16 v[48:63], v[72:75], v[96:99], v[48:63]
    v_mfma_f32_32x32x16_bf16 v[16:31], v[124:127], v[120:123], v[16:31]
    v_mfma_f32_32x32x16_bf16 v[32:47], v[128:131], v[120:123], v[32:47]
    v_mfma_f32_32x32x16_bf16 v[48:63], v[132:135], v[120:123], v[48:63]
    ds_read_b64_tr_b16 v[64:65], v89 offset:55296
    ds_read_b64_tr_b16 v[66:67], v91 offset:55296
    s_waitcnt vmcnt(4) lgkmcnt(6)
    v_mfma_f32_32x32x16_bf16 v[16:31], v[76:79], v[100:103], v[16:31]
    ds_read_b64_tr_b16 v[68:69], v89 offset:55328
    ds_read_b64_tr_b16 v[70:71], v91 offset:55328
    s_waitcnt lgkmcnt(6)
    v_mfma_f32_32x32x16_bf16 v[32:47], v[80:83], v[100:103], v[32:47]
    s_add_u32 s13, s24, 16384
    buffer_load_dwordx4 v[212:215], v14, s[64:67], s13 offen offset:3072 sc1
    ds_read_b64_tr_b16 v[72:73], v89 offset:55360
    ds_read_b64_tr_b16 v[74:75], v91 offset:55360
    s_waitcnt lgkmcnt(6)
    v_mfma_f32_32x32x16_bf16 v[48:63], v[84:87], v[100:103], v[48:63]
    ds_read_b64_tr_b16 v[76:77], v89 offset:56832
    ds_read_b64_tr_b16 v[78:79], v91 offset:56832
    s_waitcnt vmcnt(3) lgkmcnt(6)
    v_mfma_f32_32x32x16_bf16 v[16:31], v[64:67], v[104:107], v[16:31]
    ds_read_b64_tr_b16 v[80:81], v89 offset:56864
    ds_read_b64_tr_b16 v[82:83], v91 offset:56864
    s_waitcnt lgkmcnt(6)
    v_mfma_f32_32x32x16_bf16 v[32:47], v[68:71], v[104:107], v[32:47]
    ds_read_b64_tr_b16 v[84:85], v89 offset:56896
    ds_read_b64_tr_b16 v[86:87], v91 offset:56896
    s_waitcnt lgkmcnt(6)
    v_mfma_f32_32x32x16_bf16 v[48:63], v[72:75], v[104:107], v[48:63]
    s_waitcnt vmcnt(2) lgkmcnt(4)
    v_mfma_f32_32x32x16_bf16 v[16:31], v[76:79], v[108:111], v[16:31]
    s_waitcnt lgkmcnt(2)
    v_mfma_f32_32x32x16_bf16 v[32:47], v[80:83], v[108:111], v[32:47]
    s_waitcnt lgkmcnt(0)
    v_mfma_f32_32x32x16_bf16 v[48:63], v[84:87], v[108:111], v[48:63]
    v_mul_f32 v64, 0xc0135760, v13
    v_mul_f32 v66, v13, v13
    v_mul_f32 v66, v66, v13
    v_mul_f32 v66, 0xbdd2d3c8, v66
    v_mov_b32 v65, v64
    v_mov_b32 v67, v66
    v_mov_b32 v68, v4
    v_mov_b32 v69, v4
    s_lshl_b32 s80, s15, 1
    s_mul_i32 s80, s80, 49152
    s_mul_i32 s81, s70, 1536
    s_add_u32 s80, s80, s81
    s_add_u32 s16, s80, 5767168
    v_and_b32 v70, 1, v2
    v_mul_u32_u24 v70, 49152, v70
    v_lshl_add_u32 v70, v1, 4, v70
    v_lshl_add_u32 v70, v5, 8, v70
    s_add_u32 s13, s24, 20480
    buffer_load_dwordx4 v[216:219], v14, s[64:67], s13 offen offset:0 sc1
    s_add_u32 s13, s24, 20480
    buffer_load_dwordx4 v[220:223], v14, s[64:67], s13 offen offset:1024 sc1
    s_add_u32 s13, s24, 20480
    buffer_load_dwordx4 v[224:227], v14, s[64:67], s13 offen offset:2048 sc1
    v_pk_mul_f32 v[72:73], v[16:17], v[16:17]
    v_pk_mul_f32 v[74:75], v[18:19], v[18:19]
    v_pk_mul_f32 v[76:77], v[20:21], v[20:21]
    v_pk_mul_f32 v[78:79], v[22:23], v[22:23]
    v_pk_fma_f32 v[72:73], v[72:73], v[66:67], v[64:65]
    v_pk_fma_f32 v[74:75], v[74:75], v[66:67], v[64:65]
    v_pk_fma_f32 v[76:77], v[76:77], v[66:67], v[64:65]
    v_pk_fma_f32 v[78:79], v[78:79], v[66:67], v[64:65]
    v_pk_mul_f32 v[72:73], v[72:73], v[16:17]
    v_pk_mul_f32 v[74:75], v[74:75], v[18:19]
    v_pk_mul_f32 v[76:77], v[76:77], v[20:21]
    v_pk_mul_f32 v[78:79], v[78:79], v[22:23]
    v_exp_f32 v72, v72
    v_exp_f32 v73, v73
    v_exp_f32 v74, v74
    v_exp_f32 v75, v75
    v_exp_f32 v76, v76
    v_exp_f32 v77, v77
    v_exp_f32 v78, v78
    v_exp_f32 v79, v79
    v_pk_mul_f32 v[16:17], v[16:17], v[24:25]
    v_pk_mul_f32 v[18:19], v[18:19], v[26:27]
    v_pk_mul_f32 v[20:21], v[20:21], v[28:29]
    v_pk_mul_f32 v[22:23], v[22:23], v[30:31]
    v_pk_fma_f32 v[72:73], v[72:73], v[68:69], v[68:69]
    v_pk_fma_f32 v[74:75], v[74:75], v[68:69], v[68:69]
    v_pk_fma_f32 v[76:77], v[76:77], v[68:69], v[68:69]
    v_pk_fma_f32 v[78:79], v[78:79], v[68:69], v[68:69]
    v_rcp_f32 v72, v72
    v_rcp_f32 v73, v73
    v_rcp_f32 v74, v74
    v_rcp_f32 v75, v75
    v_rcp_f32 v76, v76
    v_rcp_f32 v77, v77
    v_rcp_f32 v78, v78
    v_rcp_f32 v79, v79
    v_pk_mul_f32 v[16:17], v[16:17], v[72:73]
    v_pk_mul_f32 v[18:19], v[18:19], v[74:75]
    v_pk_mul_f32 v[20:21], v[20:21], v[76:77]
    v_pk_mul_f32 v[22:23], v[22:23], v[78:79]
    v_cvt_pk_bf16_f32 v16, v16, v17
    v_cvt_pk_bf16_f32 v17, v18, v19
    v_cvt_pk_bf16_f32 v18, v20, v21
    v_cvt_pk_bf16_f32 v19, v22, v23
    s_add_u32 s13, s24, 20480
    buffer_load_dwordx4 v[228:231], v14, s[64:67], s13 offen offset:3072 sc1
    s_add_u32 s13, s24, 24576
    buffer_load_dwordx4 v[232:235], v14, s[64:67], s13 offen offset:0 sc1
    s_add_u32 s13, s24, 24576
    buffer_load_dwordx4 v[236:239], v14, s[64:67], s13 offen offset:1024 sc1
    v_pk_mul_f32 v[72:73], v[32:33], v[32:33]
    v_pk_mul_f32 v[74:75], v[34:35], v[34:35]
    v_pk_mul_f32 v[76:77], v[36:37], v[36:37]
    v_pk_mul_f32 v[78:79], v[38:39], v[38:39]
    v_pk_fma_f32 v[72:73], v[72:73], v[66:67], v[64:65]
    v_pk_fma_f32 v[74:75], v[74:75], v[66:67], v[64:65]
    v_pk_fma_f32 v[76:77], v[76:77], v[66:67], v[64:65]
    v_pk_fma_f32 v[78:79], v[78:79], v[66:67], v[64:65]
    v_pk_mul_f32 v[72:73], v[72:73], v[32:33]
    v_pk_mul_f32 v[74:75], v[74:75], v[34:35]
    v_pk_mul_f32 v[76:77], v[76:77], v[36:37]
    v_pk_mul_f32 v[78:79], v[78:79], v[38:39]
    v_exp_f32 v72, v72
    v_exp_f32 v73, v73
    v_exp_f32 v74, v74
    v_exp_f32 v75, v75
    v_exp_f32 v76, v76
    v_exp_f32 v77, v77
    v_exp_f32 v78, v78
    v_exp_f32 v79, v79
    v_pk_mul_f32 v[32:33], v[32:33], v[40:41]
    v_pk_mul_f32 v[34:35], v[34:35], v[42:43]
    v_pk_mul_f32 v[36:37], v[36:37], v[44:45]
    v_pk_mul_f32 v[38:39], v[38:39], v[46:47]
    v_pk_fma_f32 v[72:73], v[72:73], v[68:69], v[68:69]
    v_pk_fma_f32 v[74:75], v[74:75], v[68:69], v[68:69]
    v_pk_fma_f32 v[76:77], v[76:77], v[68:69], v[68:69]
    v_pk_fma_f32 v[78:79], v[78:79], v[68:69], v[68:69]
    v_rcp_f32 v72, v72
    v_rcp_f32 v73, v73
    v_rcp_f32 v74, v74
    v_rcp_f32 v75, v75
    v_rcp_f32 v76, v76
    v_rcp_f32 v77, v77
    v_rcp_f32 v78, v78
    v_rcp_f32 v79, v79
    v_pk_mul_f32 v[32:33], v[32:33], v[72:73]
    v_pk_mul_f32 v[34:35], v[34:35], v[74:75]
    v_pk_mul_f32 v[36:37], v[36:37], v[76:77]
    v_pk_mul_f32 v[38:39], v[38:39], v[78:79]
    v_cvt_pk_bf16_f32 v32, v32, v33
    v_cvt_pk_bf16_f32 v33, v34, v35
    v_cvt_pk_bf16_f32 v34, v36, v37
    v_cvt_pk_bf16_f32 v35, v38, v39
    s_add_u32 s13, s24, 24576
    buffer_load_dwordx4 v[240:243], v14, s[64:67], s13 offen offset:2048 sc1
    s_add_u32 s13, s24, 24576
    buffer_load_dwordx4 v[244:247], v14, s[64:67], s13 offen offset:3072 sc1
    s_add_u32 s13, s24, 28672
    buffer_load_dwordx4 v[248:251], v14, s[64:67], s13 offen offset:0 sc1
    v_pk_mul_f32 v[72:73], v[48:49], v[48:49]
    v_pk_mul_f32 v[74:75], v[50:51], v[50:51]
    v_pk_mul_f32 v[76:77], v[52:53], v[52:53]
    v_pk_mul_f32 v[78:79], v[54:55], v[54:55]
    v_pk_fma_f32 v[72:73], v[72:73], v[66:67], v[64:65]
    v_pk_fma_f32 v[74:75], v[74:75], v[66:67], v[64:65]
    v_pk_fma_f32 v[76:77], v[76:77], v[66:67], v[64:65]
    v_pk_fma_f32 v[78:79], v[78:79], v[66:67], v[64:65]
    v_pk_mul_f32 v[72:73], v[72:73], v[48:49]
    v_pk_mul_f32 v[74:75], v[74:75], v[50:51]
    v_pk_mul_f32 v[76:77], v[76:77], v[52:53]
    v_pk_mul_f32 v[78:79], v[78:79], v[54:55]
    v_exp_f32 v72, v72
    v_exp_f32 v73, v73
    v_exp_f32 v74, v74
    v_exp_f32 v75, v75
    v_exp_f32 v76, v76
    v_exp_f32 v77, v77
    v_exp_f32 v78, v78
    v_exp_f32 v79, v79
    v_pk_mul_f32 v[48:49], v[48:49], v[56:57]
    v_pk_mul_f32 v[50:51], v[50:51], v[58:59]
    v_pk_mul_f32 v[52:53], v[52:53], v[60:61]
    v_pk_mul_f32 v[54:55], v[54:55], v[62:63]
    v_pk_fma_f32 v[72:73], v[72:73], v[68:69], v[68:69]
    v_pk_fma_f32 v[74:75], v[74:75], v[68:69], v[68:69]
    v_pk_fma_f32 v[76:77], v[76:77], v[68:69], v[68:69]
    v_pk_fma_f32 v[78:79], v[78:79], v[68:69], v[68:69]
    v_rcp_f32 v72, v72
    v_rcp_f32 v73, v73
    v_rcp_f32 v74, v74
    v_rcp_f32 v75, v75
    v_rcp_f32 v76, v76
    v_rcp_f32 v77, v77
    v_rcp_f32 v78, v78
    v_rcp_f32 v79, v79
    v_pk_mul_f32 v[48:49], v[48:49], v[72:73]
    v_pk_mul_f32 v[50:51], v[50:51], v[74:75]
    v_pk_mul_f32 v[52:53], v[52:53], v[76:77]
    v_pk_mul_f32 v[54:55], v[54:55], v[78:79]
    v_cvt_pk_bf16_f32 v48, v48, v49
    v_cvt_pk_bf16_f32 v49, v50, v51
    v_cvt_pk_bf16_f32 v50, v52, v53
    v_cvt_pk_bf16_f32 v51, v54, v55
    v_mov_b32 v72, 0
    v_mov_b32 v73, 4
    s_cmp_eq_u32 s75, 0
    s_cbranch_scc1 L_sts_23
    buffer_store_dwordx4 v[16:19], v70, s[64:67], s16 offen offset:0
    buffer_store_dwordx4 v[32:35], v70, s[64:67], s16 offen offset:512
    buffer_store_dwordx4 v[48:51], v70, s[64:67], s16 offen offset:1024
    s_mov_b64 exec, 1
    s_waitcnt vmcnt(0)
    buffer_store_dword v73, v72, s[64:67], s27 offen
    s_mov_b64 exec, -1
    s_branch L_ste_24
L_sts_23:
    buffer_store_dwordx4 v[16:19], v70, s[64:67], s16 offen offset:0 sc1
    buffer_store_dwordx4 v[32:35], v70, s[64:67], s16 offen offset:512 sc1
    buffer_store_dwordx4 v[48:51], v70, s[64:67], s16 offen offset:1024 sc1
    s_mov_b64 exec, 1
    s_waitcnt vmcnt(0)
    buffer_store_dword v73, v72, s[64:67], s27 offen sc1
    s_mov_b64 exec, -1
L_ste_24:
    s_add_u32 s13, s24, 28672
    buffer_load_dwordx4 v[252:255], v14, s[64:67], s13 offen offset:1024 sc1
    s_add_u32 s13, s24, 0
    buffer_load_dwordx4 v[136:139], v14, s[64:67], s13 offen offset:0 sc1
    s_add_u32 s13, s24, 0
    buffer_load_dwordx4 v[140:143], v14, s[64:67], s13 offen offset:1024 sc1
    s_add_u32 s13, s24, 0
    buffer_load_dwordx4 v[144:147], v14, s[64:67], s13 offen offset:2048 sc1
    s_add_u32 s13, s24, 0
    buffer_load_dwordx4 v[148:151], v14, s[64:67], s13 offen offset:3072 sc1
    s_add_u32 s13, s24, 4096
    buffer_load_dwordx4 v[152:155], v14, s[64:67], s13 offen offset:0 sc1
    s_lshl_b32 s80, s69, 5
    s_lshl_b32 s81, s68, 2
    s_add_u32 s80, s80, s81
    s_lshl_b32 s80, s80, 3
    s_add_u32 s80, s80, s71
    s_lshl_b32 s80, s80, 2
    s_add_u32 s80, s80, 4096
    v_and_b32 v84, 7, v0
    v_lshl_add_u32 v84, v84, 4, s80
    s_lshl_b32 s80, s73, 2
    s_lshr_b32 s81, s68, 1
    s_add_u32 s80, s80, s81
    s_mul_i32 s82, s68, 6144
    s_add_u32 s82, s82, 5767168
    v_lshlrev_b32 v86, 3, v0
    s_xor_b32 s81, s80, 0
    s_mul_i32 s81, s81, 49152
    s_add_u32 s16, s81, s82
    s_add_u32 s17, s16, 4096
    s_xor_b32 s81, s80, 1
    s_mul_i32 s81, s81, 49152
    s_add_u32 s18, s81, s82
    s_add_u32 s19, s18, 4096
    s_xor_b32 s81, s80, 2
    s_mul_i32 s81, s81, 49152
    s_add_u32 s20, s81, s82
    s_add_u32 s21, s20, 4096
    s_xor_b32 s81, s80, 3
    s_mul_i32 s81, s81, 49152
    s_add_u32 s22, s81, s82
    s_add_u32 s23, s22, 4096
    s_xor_b32 s81, s68, 0
    s_mul_i32 s24, s81, 17920
    s_xor_b32 s81, s68, 1
    s_mul_i32 s25, s81, 17920
    s_xor_b32 s81, s68, 2
    s_mul_i32 s26, s81, 17920
    s_xor_b32 s81, s68, 3
    s_mul_i32 s27, s81, 17920
    s_xor_b32 s81, s68, 4
    s_mul_i32 s28, s81, 17920
    s_xor_b32 s81, s68, 5
    s_mul_i32 s29, s81, 17920
    s_xor_b32 s81, s68, 6
    s_mul_i32 s30, s81, 17920
    s_xor_b32 s81, s68, 7
    s_mul_i32 s31, s81, 17920
    s_barrier
    s_movk_i32 s85, 0x7fff
L_poll_25:
    buffer_load_dword v85, v84, s[64:67], 0 offen offset:0 sc1
    s_sub_u32 s85, s85, 1
    s_waitcnt vmcnt(0)
    s_cbranch_scc1 L_pdone_26
    v_cmp_le_u32 vcc, 4, v85
    s_nop 0
    s_cmp_eq_u64 vcc, exec
    s_nop 1
    s_cbranch_scc0 L_poll_25
L_pdone_26:
    buffer_load_dwordx4 v[96:99], v3, s[64:67], s18 offen offset:0 sc1
    buffer_load_dwordx4 v[100:103], v3, s[64:67], s18 offen offset:1024 sc1
    buffer_load_dwordx4 v[104:107], v3, s[64:67], s18 offen offset:2048 sc1
    buffer_load_dwordx4 v[108:111], v3, s[64:67], s18 offen offset:3072 sc1
    buffer_load_dwordx4 v[112:115], v3, s[64:67], s19 offen offset:0 sc1
    v_lshlrev_b32 v56, 16, v8
    v_and_b32 v57, 0xffff0000, v8
    v_lshlrev_b32 v58, 16, v9
    v_and_b32 v59, 0xffff0000, v9
    v_lshlrev_b32 v60, 16, v10
    v_and_b32 v61, 0xffff0000, v10
    v_lshlrev_b32 v62, 16, v11
    v_and_b32 v63, 0xffff0000, v11
    v_lshlrev_b32 v64, 16, v12
    v_and_b32 v65, 0xffff0000, v12
    v_add_u32 v87, s24, v3
    v_add_u32 v86, s24, v86
    s_waitcnt vmcnt(4)
    v_mfma_f32_16x16x32_bf16 v[16:19], v[136:139], v[96:99], 0
    buffer_load_dwordx4 v[116:119], v3, s[64:67], s19 offen offset:1024 sc1
    v_mfma_f32_16x16x32_bf16 v[20:23], v[140:143], v[96:99], 0
    v_mfma_f32_16x16x32_bf16 v[24:27], v[144:147], v[96:99], 0
    v_mfma_f32_16x16x32_bf16 v[28:31], v[148:151], v[96:99], 0
    v_mfma_f32_16x16x32_bf16 v[32:35], v[152:155], v[96:99], 0
    s_waitcnt vmcnt(4)
    v_mfma_f32_16x16x32_bf16 v[16:19], v[156:159], v[100:103], v[16:19]
    buffer_load_dwordx4 v[96:99], v3, s[64:67], s20 offen offset:0 sc1
    v_mfma_f32_16x16x32_bf16 v[20:23], v[160:163], v[100:103], v[20:23]
    v_mfma_f32_16x16x32_bf16 v[24:27], v[164:167], v[100:103], v[24:27]
    v_mfma_f32_16x16x32_bf16 v[28:31], v[168:171], v[100:103], v[28:31]
    v_mfma_f32_16x16x32_bf16 v[32:35], v[172:175], v[100:103], v[32:35]
    s_waitcnt vmcnt(4)
    v_mfma_f32_16x16x32_bf16 v[16:19], v[176:179], v[104:107], v[16:19]
    buffer_load_dwordx4 v[100:103], v3, s[64:67], s20 offen offset:1024 sc1
    v_mfma_f32_16x16x32_bf16 v[20:23], v[180:183], v[104:107], v[20:23]
    v_mfma_f32_16x16x32_bf16 v[24:27], v[184:187], v[104:107], v[24:27]
    v_mfma_f32_16x16x32_bf16 v[28:31], v[188:191], v[104:107], v[28:31]
    v_mfma_f32_16x16x32_bf16 v[32:35], v[192:195], v[104:107], v[32:35]
    s_waitcnt vmcnt(4)
    v_mfma_f32_16x16x32_bf16 v[16:19], v[196:199], v[108:111], v[16:19]
    buffer_load_dwordx4 v[104:107], v3, s[64:67], s20 offen offset:2048 sc1
    v_mfma_f32_16x16x32_bf16 v[20:23], v[200:203], v[108:111], v[20:23]
    v_mfma_f32_16x16x32_bf16 v[24:27], v[204:207], v[108:111], v[24:27]
    v_mfma_f32_16x16x32_bf16 v[28:31], v[208:211], v[108:111], v[28:31]
    v_mfma_f32_16x16x32_bf16 v[32:35], v[212:215], v[108:111], v[32:35]
    s_waitcnt vmcnt(4)
    v_mfma_f32_16x16x32_bf16 v[16:19], v[216:219], v[112:115], v[16:19]
    buffer_load_dwordx4 v[108:111], v3, s[64:67], s20 offen offset:3072 sc1
    v_mfma_f32_16x16x32_bf16 v[20:23], v[220:223], v[112:115], v[20:23]
    v_mfma_f32_16x16x32_bf16 v[24:27], v[224:227], v[112:115], v[24:27]
    v_mfma_f32_16x16x32_bf16 v[28:31], v[228:231], v[112:115], v[28:31]
    v_mfma_f32_16x16x32_bf16 v[32:35], v[232:235], v[112:115], v[32:35]
    s_waitcnt vmcnt(4)
    v_mfma_f32_16x16x32_bf16 v[16:19], v[236:239], v[116:119], v[16:19]
    buffer_load_dwordx4 v[112:115], v3, s[64:67], s21 offen offset:0 sc1
    v_mfma_f32_16x16x32_bf16 v[20:23], v[240:243], v[116:119], v[20:23]
    v_mfma_f32_16x16x32_bf16 v[24:27], v[244:247], v[116:119], v[24:27]
    v_mfma_f32_16x16x32_bf16 v[28:31], v[248:251], v[116:119], v[28:31]
    v_mfma_f32_16x16x32_bf16 v[32:35], v[252:255], v[116:119], v[32:35]
    s_add_u32 s26, s26, 2560
    v_add_u32 v88, s26, v3
    v_lshl_add_u32 v89, v0, 3, s26
    s_add_u32 s27, s27, 5120
    v_add_u32 v90, s27, v3
    v_lshl_add_u32 v91, v0, 3, s27
    s_waitcnt vmcnt(4)
    v_mfma_f32_16x16x32_bf16 v[36:39], v[136:139], v[96:99], 0
    buffer_load_dwordx4 v[116:119], v3, s[64:67], s21 offen offset:1024 sc1
    v_mfma_f32_16x16x32_bf16 v[40:43], v[140:143], v[96:99], 0
    v_mfma_f32_16x16x32_bf16 v[44:47], v[144:147], v[96:99], 0
    v_mfma_f32_16x16x32_bf16 v[48:51], v[148:151], v[96:99], 0
    ds_write2_b64 v88, v[16:17], v[20:21] offset0:0 offset1:1
    v_mfma_f32_16x16x32_bf16 v[52:55], v[152:155], v[96:99], 0
    s_waitcnt vmcnt(4)
    v_mfma_f32_16x16x32_bf16 v[36:39], v[156:159], v[100:103], v[36:39]
    buffer_load_dwordx4 v[96:99], v3, s[64:67], s22 offen offset:0 sc1
    v_mfma_f32_16x16x32_bf16 v[40:43], v[160:163], v[100:103], v[40:43]
    ds_write2_b64 v88, v[24:25], v[28:29] offset0:128 offset1:129
    v_mfma_f32_16x16x32_bf16 v[44:47], v[164:167], v[100:103], v[44:47]
    v_mfma_f32_16x16x32_bf16 v[48:51], v[168:171], v[100:103], v[48:51]
    ds_write_b64 v89, v[32:33] offset:2048
    v_mfma_f32_16x16x32_bf16 v[52:55], v[172:175], v[100:103], v[52:55]
    s_waitcnt vmcnt(4)
    v_mfma_f32_16x16x32_bf16 v[36:39], v[176:179], v[104:107], v[36:39]
    buffer_load_dwordx4 v[100:103], v3, s[64:67], s22 offen offset:1024 sc1
    v_mfma_f32_16x16x32_bf16 v[40:43], v[180:183], v[104:107], v[40:43]
    ds_write2_b64 v90, v[18:19], v[22:23] offset0:0 offset1:1
    v_mfma_f32_16x16x32_bf16 v[44:47], v[184:187], v[104:107], v[44:47]
    v_mfma_f32_16x16x32_bf16 v[48:51], v[188:191], v[104:107], v[48:51]
    ds_write2_b64 v90, v[26:27], v[30:31] offset0:128 offset1:129
    v_mfma_f32_16x16x32_bf16 v[52:55], v[192:195], v[104:107], v[52:55]
    s_waitcnt vmcnt(4)
    v_mfma_f32_16x16x32_bf16 v[36:39], v[196:199], v[108:111], v[36:39]
    buffer_load_dwordx4 v[104:107], v3, s[64:67], s22 offen offset:2048 sc1
    v_mfma_f32_16x16x32_bf16 v[40:43], v[200:203], v[108:111], v[40:43]
    ds_write_b64 v91, v[34:35] offset:2048
    v_mfma_f32_16x16x32_bf16 v[44:47], v[204:207], v[108:111], v[44:47]
    v_mfma_f32_16x16x32_bf16 v[48:51], v[208:211], v[108:111], v[48:51]
    v_mfma_f32_16x16x32_bf16 v[52:55], v[212:215], v[108:111], v[52:55]
    s_waitcnt vmcnt(4)
    v_mfma_f32_16x16x32_bf16 v[36:39], v[216:219], v[112:115], v[36:39]
    buffer_load_dwordx4 v[108:111], v3, s[64:67], s22 offen offset:3072 sc1
    v_mfma_f32_16x16x32_bf16 v[40:43], v[220:223], v[112:115], v[40:43]
    v_mfma_f32_16x16x32_bf16 v[44:47], v[224:227], v[112:115], v[44:47]
    v_mfma_f32_16x16x32_bf16 v[48:51], v[228:231], v[112:115], v[48:51]
    v_mfma_f32_16x16x32_bf16 v[52:55], v[232:235], v[112:115], v[52:55]
    s_waitcnt vmcnt(4)
    v_mfma_f32_16x16x32_bf16 v[36:39], v[236:239], v[116:119], v[36:39]
    buffer_load_dwordx4 v[112:115], v3, s[64:67], s23 offen offset:0 sc1
    v_mfma_f32_16x16x32_bf16 v[40:43], v[240:243], v[116:119], v[40:43]
    v_mfma_f32_16x16x32_bf16 v[44:47], v[244:247], v[116:119], v[44:47]
    v_mfma_f32_16x16x32_bf16 v[48:51], v[248:251], v[116:119], v[48:51]
    v_mfma_f32_16x16x32_bf16 v[52:55], v[252:255], v[116:119], v[52:55]
    s_add_u32 s28, s28, 7680
    v_add_u32 v92, s28, v3
    v_lshl_add_u32 v93, v0, 3, s28
    s_add_u32 s29, s29, 10240
    v_add_u32 v94, s29, v3
    v_lshl_add_u32 v95, v0, 3, s29
    s_waitcnt vmcnt(4)
    v_mfma_f32_16x16x32_bf16 v[16:19], v[136:139], v[96:99], 0
    buffer_load_dwordx4 v[116:119], v3, s[64:67], s23 offen offset:1024 sc1
    v_mfma_f32_16x16x32_bf16 v[20:23], v[140:143], v[96:99], 0
    v_mfma_f32_16x16x32_bf16 v[24:27], v[144:147], v[96:99], 0
    v_mfma_f32_16x16x32_bf16 v[28:31], v[148:151], v[96:99], 0
    ds_write2_b64 v92, v[36:37], v[40:41] offset0:0 offset1:1
    v_mfma_f32_16x16x32_bf16 v[32:35], v[152:155], v[96:99], 0
    s_waitcnt vmcnt(4)
    v_mfma_f32_16x16x32_bf16 v[16:19], v[156:159], v[100:103], v[16:19]
    buffer_load_dwordx4 v[96:99], v3, s[64:67], s16 offen offset:0 sc1
    v_mfma_f32_16x16x32_bf16 v[20:23], v[160:163], v[100:103], v[20:23]
    ds_write2_b64 v92, v[44:45], v[48:49] offset0:128 offset1:129
    v_mfma_f32_16x16x32_bf16 v[24:27], v[164:167], v[100:103], v[24:27]
    v_mfma_f32_16x16x32_bf16 v[28:31], v[168:171], v[100:103], v[28:31]
    ds_write_b64 v93, v[52:53] offset:2048
    v_mfma_f32_16x16x32_bf16 v[32:35], v[172:175], v[100:103], v[32:35]
    s_waitcnt vmcnt(4)
    v_mfma_f32_16x16x32_bf16 v[16:19], v[176:179], v[104:107], v[16:19]
    buffer_load_dwordx4 v[100:103], v3, s[64:67], s16 offen offset:1024 sc1
    v_mfma_f32_16x16x32_bf16 v[20:23], v[180:183], v[104:107], v[20:23]
    ds_write2_b64 v94, v[38:39], v[42:43] offset0:0 offset1:1
    v_mfma_f32_16x16x32_bf16 v[24:27], v[184:187], v[104:107], v[24:27]
    v_mfma_f32_16x16x32_bf16 v[28:31], v[188:191], v[104:107], v[28:31]
    ds_write2_b64 v94, v[46:47], v[50:51] offset0:128 offset1:129
    v_mfma_f32_16x16x32_bf16 v[32:35], v[192:195], v[104:107], v[32:35]
    s_waitcnt vmcnt(4)
    v_mfma_f32_16x16x32_bf16 v[16:19], v[196:199], v[108:111], v[16:19]
    buffer_load_dwordx4 v[104:107], v3, s[64:67], s16 offen offset:2048 sc1
    v_mfma_f32_16x16x32_bf16 v[20:23], v[200:203], v[108:111], v[20:23]
    ds_write_b64 v95, v[54:55] offset:2048
    v_mfma_f32_16x16x32_bf16 v[24:27], v[204:207], v[108:111], v[24:27]
    v_mfma_f32_16x16x32_bf16 v[28:31], v[208:211], v[108:111], v[28:31]
    v_mfma_f32_16x16x32_bf16 v[32:35], v[212:215], v[108:111], v[32:35]
    s_waitcnt vmcnt(4)
    v_mfma_f32_16x16x32_bf16 v[16:19], v[216:219], v[112:115], v[16:19]
    buffer_load_dwordx4 v[108:111], v3, s[64:67], s16 offen offset:3072 sc1
    v_mfma_f32_16x16x32_bf16 v[20:23], v[220:223], v[112:115], v[20:23]
    v_mfma_f32_16x16x32_bf16 v[24:27], v[224:227], v[112:115], v[24:27]
    v_mfma_f32_16x16x32_bf16 v[28:31], v[228:231], v[112:115], v[28:31]
    v_mfma_f32_16x16x32_bf16 v[32:35], v[232:235], v[112:115], v[32:35]
    s_waitcnt vmcnt(4)
    v_mfma_f32_16x16x32_bf16 v[16:19], v[236:239], v[116:119], v[16:19]
    buffer_load_dwordx4 v[112:115], v3, s[64:67], s17 offen offset:0 sc1
    v_mfma_f32_16x16x32_bf16 v[20:23], v[240:243], v[116:119], v[20:23]
    v_mfma_f32_16x16x32_bf16 v[24:27], v[244:247], v[116:119], v[24:27]
    v_mfma_f32_16x16x32_bf16 v[28:31], v[248:251], v[116:119], v[28:31]
    v_mfma_f32_16x16x32_bf16 v[32:35], v[252:255], v[116:119], v[32:35]
    s_add_u32 s30, s30, 12800
    v_add_u32 v88, s30, v3
    v_lshl_add_u32 v89, v0, 3, s30
    s_add_u32 s31, s31, 15360
    v_add_u32 v90, s31, v3
    v_lshl_add_u32 v91, v0, 3, s31
    s_waitcnt vmcnt(4)
    v_mfma_f32_16x16x32_bf16 v[36:39], v[136:139], v[96:99], 0
    buffer_load_dwordx4 v[116:119], v3, s[64:67], s17 offen offset:1024 sc1
    v_mfma_f32_16x16x32_bf16 v[40:43], v[140:143], v[96:99], 0
    v_mfma_f32_16x16x32_bf16 v[44:47], v[144:147], v[96:99], 0
    v_mfma_f32_16x16x32_bf16 v[48:51], v[148:151], v[96:99], 0
    ds_write2_b64 v88, v[16:17], v[20:21] offset0:0 offset1:1
    v_mfma_f32_16x16x32_bf16 v[52:55], v[152:155], v[96:99], 0
    ds_write2_b64 v88, v[24:25], v[28:29] offset0:128 offset1:129
    s_waitcnt vmcnt(4)
    v_mfma_f32_16x16x32_bf16 v[36:39], v[156:159], v[100:103], v[36:39]
    ds_write_b64 v89, v[32:33] offset:2048
    v_mfma_f32_16x16x32_bf16 v[40:43], v[160:163], v[100:103], v[40:43]
    ds_write2_b64 v90, v[18:19], v[22:23] offset0:0 offset1:1
    v_mfma_f32_16x16x32_bf16 v[44:47], v[164:167], v[100:103], v[44:47]
    ds_write2_b64 v90, v[26:27], v[30:31] offset0:128 offset1:129
    v_mfma_f32_16x16x32_bf16 v[48:51], v[168:171], v[100:103], v[48:51]
    ds_write_b64 v91, v[34:35] offset:2048
    v_mfma_f32_16x16x32_bf16 v[52:55], v[172:175], v[100:103], v[52:55]
    s_waitcnt vmcnt(3)
    s_waitcnt lgkmcnt(0)
    s_barrier
    v_mfma_f32_16x16x32_bf16 v[36:39], v[176:179], v[104:107], v[36:39]
    ds_read_b128 v[76:79], v87 offset:2560
    ds_read_b128 v[80:83], v87 offset:3584
    v_mfma_f32_16x16x32_bf16 v[40:43], v[180:183], v[104:107], v[40:43]
    ds_read_b64 v[84:85], v86 offset:4608
    ds_read_b128 v[16:19], v87 offset:5120
    v_mfma_f32_16x16x32_bf16 v[44:47], v[184:187], v[104:107], v[44:47]
    ds_read_b128 v[20:23], v87 offset:6144
    ds_read_b64 v[24:25], v86 offset:7168
    v_mfma_f32_16x16x32_bf16 v[48:51], v[188:191], v[104:107], v[48:51]
    ds_read_b128 v[26:29], v87 offset:7680
    ds_read_b128 v[30:33], v87 offset:8704
    v_mfma_f32_16x16x32_bf16 v[52:55], v[192:195], v[104:107], v[52:55]
    ds_read_b64 v[34:35], v86 offset:9728
    ds_read_b128 v[120:123], v87 offset:10240
    s_waitcnt vmcnt(2)
    v_mfma_f32_16x16x32_bf16 v[36:39], v[196:199], v[108:111], v[36:39]
    ds_read_b128 v[124:127], v87 offset:11264
    ds_read_b64 v[128:129], v86 offset:12288
    v_mfma_f32_16x16x32_bf16 v[40:43], v[200:203], v[108:111], v[40:43]
    ds_read_b128 v[136:139], v87 offset:12800
    ds_read_b128 v[140:143], v87 offset:13824
    v_mfma_f32_16x16x32_bf16 v[44:47], v[204:207], v[108:111], v[44:47]
    s_waitcnt lgkmcnt(8)
    ds_read_b64 v[144:145], v86 offset:14848
    ds_read_b128 v[146:149], v87 offset:15360
    v_mfma_f32_16x16x32_bf16 v[48:51], v[208:211], v[108:111], v[48:51]
    ds_read_b128 v[150:153], v87 offset:16384
    ds_read_b64 v[154:155], v86 offset:17408
    v_mfma_f32_16x16x32_bf16 v[52:55], v[212:215], v[108:111], v[52:55]
    s_waitcnt vmcnt(1)
    v_mfma_f32_16x16x32_bf16 v[36:39], v[216:219], v[112:115], v[36:39]
    v_mfma_f32_16x16x32_bf16 v[40:43], v[220:223], v[112:115], v[40:43]
    v_mfma_f32_16x16x32_bf16 v[44:47], v[224:227], v[112:115], v[44:47]
    v_mfma_f32_16x16x32_bf16 v[48:51], v[228:231], v[112:115], v[48:51]
    v_mfma_f32_16x16x32_bf16 v[52:55], v[232:235], v[112:115], v[52:55]
    s_waitcnt vmcnt(0)
    v_mfma_f32_16x16x32_bf16 v[36:39], v[236:239], v[116:119], v[36:39]
    v_mfma_f32_16x16x32_bf16 v[40:43], v[240:243], v[116:119], v[40:43]
    v_mfma_f32_16x16x32_bf16 v[44:47], v[244:247], v[116:119], v[44:47]
    v_mfma_f32_16x16x32_bf16 v[48:51], v[248:251], v[116:119], v[48:51]
    v_mfma_f32_16x16x32_bf16 v[52:55], v[252:255], v[116:119], v[52:55]
    s_add_u32 s25, s25, 0
    v_add_u32 v94, s25, v3
    v_lshl_add_u32 v95, v0, 3, s25
    s_waitcnt lgkmcnt(0)
    v_pk_add_f32 v[76:77], v[76:77], v[16:17]
    v_pk_add_f32 v[78:79], v[78:79], v[18:19]
    v_pk_add_f32 v[80:81], v[80:81], v[20:21]
    v_pk_add_f32 v[82:83], v[82:83], v[22:23]
    v_pk_add_f32 v[84:85], v[84:85], v[24:25]
    ds_write2_b64 v94, v[38:39], v[42:43] offset0:0 offset1:1
    ds_write2_b64 v94, v[46:47], v[50:51] offset0:128 offset1:129
    ds_write_b64 v95, v[54:55] offset:2048
    v_pk_add_f32 v[26:27], v[26:27], v[120:121]
    v_pk_add_f32 v[28:29], v[28:29], v[122:123]
    v_pk_add_f32 v[30:31], v[30:31], v[124:125]
    v_pk_add_f32 v[32:33], v[32:33], v[126:127]
    v_pk_add_f32 v[34:35], v[34:35], v[128:129]
    v_pk_add_f32 v[136:137], v[136:137], v[146:147]
    v_pk_add_f32 v[138:139], v[138:139], v[148:149]
    v_pk_add_f32 v[140:141], v[140:141], v[150:151]
    v_pk_add_f32 v[142:143], v[142:143], v[152:153]
    v_pk_add_f32 v[144:145], v[144:145], v[154:155]
    v_pk_add_f32 v[76:77], v[76:77], v[26:27]
    v_pk_add_f32 v[78:79], v[78:79], v[28:29]
    v_pk_add_f32 v[80:81], v[80:81], v[30:31]
    v_pk_add_f32 v[82:83], v[82:83], v[32:33]
    v_pk_add_f32 v[84:85], v[84:85], v[34:35]
    v_pk_add_f32 v[76:77], v[76:77], v[136:137]
    v_pk_add_f32 v[78:79], v[78:79], v[138:139]
    v_pk_add_f32 v[80:81], v[80:81], v[140:141]
    v_pk_add_f32 v[82:83], v[82:83], v[142:143]
    v_pk_add_f32 v[84:85], v[84:85], v[144:145]
    s_waitcnt lgkmcnt(0)
    s_barrier
    ds_read_b128 v[66:69], v87 offset:0
    ds_read_b128 v[70:73], v87 offset:1024
    ds_read_b64 v[74:75], v86 offset:2048
    v_pk_add_f32 v[76:77], v[76:77], v[36:37]
    v_pk_add_f32 v[78:79], v[78:79], v[40:41]
    v_pk_add_f32 v[80:81], v[80:81], v[44:45]
    v_pk_add_f32 v[82:83], v[82:83], v[48:49]
    v_pk_add_f32 v[84:85], v[84:85], v[52:53]
    v_add_f32 v56, v56, v76
    v_add_f32 v60, v60, v77
    v_add_f32 v57, v57, v78
    v_add_f32 v61, v61, v79
    v_add_f32 v58, v58, v80
    v_add_f32 v62, v62, v81
    v_add_f32 v59, v59, v82
    v_add_f32 v63, v63, v83
    v_add_f32 v64, v64, v84
    v_add_f32 v65, v65, v85
    s_waitcnt lgkmcnt(0)
    v_add_f32 v56, v56, v66
    v_add_f32 v60, v60, v67
    v_add_f32 v57, v57, v68
    v_add_f32 v61, v61, v69
    v_add_f32 v58, v58, v70
    v_add_f32 v62, v62, v71
    v_add_f32 v59, v59, v72
    v_add_f32 v63, v63, v73
    v_add_f32 v64, v64, v74
    v_add_f32 v65, v65, v75
    v_cvt_pk_bf16_f32 v8, v56, v57
    v_cvt_pk_bf16_f32 v9, v58, v59
    v_cvt_pk_bf16_f32 v10, v60, v61
    v_cvt_pk_bf16_f32 v11, v62, v63
    v_cvt_pk_bf16_f32 v12, v64, v65
    s_cmp_eq_u32 s75, 0
    s_cbranch_scc1 L_sts_27
    buffer_store_dwordx4 v[8:11], v6, s[56:59], 0 offen
    buffer_store_dword v12, v7, s[56:59], 0 offen
    s_branch L_ste_28
L_sts_27:
    buffer_store_dwordx4 v[8:11], v6, s[56:59], 0 offen sc1
    buffer_store_dword v12, v7, s[56:59], 0 offen sc1
L_ste_28:
L_end:
s_endpgm
.section .rodata,"a"
.p2align 6
.amdhsa_kernel sequential_preLN__grouped_kv_mqa__glu_gated_geglu__prompt_kernel
  .amdhsa_next_free_vgpr 256
  .amdhsa_next_free_sgpr 102
  .amdhsa_accum_offset 256
  .amdhsa_group_segment_fixed_size 0
  .amdhsa_kernarg_size 96
  .amdhsa_user_sgpr_count 2
  .amdhsa_user_sgpr_kernarg_segment_ptr 1
  .amdhsa_system_sgpr_workgroup_id_x 1
.end_amdhsa_kernel
```
